```python
import torch

def _softmax(x, axis=-1):
    return torch.softmax(x, dim=axis)
def _gelu(x):
    return torch.nn.functional.gelu(x, approximate="tanh")
def _silu(x):
    return torch.nn.functional.silu(x)
def _sigmoid(x):
    return torch.sigmoid(x)
def _layernorm(x, axis=-1, eps=1e-5):
    m = x.mean(dim=axis, keepdim=True)
    v = x.var(dim=axis, keepdim=True, unbiased=False)
    return (x - m) / torch.sqrt(v + eps)
def _scatter_add(tgt, idx, src, axis=0):
    return tgt.clone().index_add_(axis, idx, src)
def _segment_sum(src, seg, n):
    out = torch.zeros((n,) + src.shape[1:], dtype=src.dtype)
    return out.index_add_(0, seg, src)
def _pad(x, pw):
    flat = tuple(v for pair in reversed(pw) for v in pair)
    return torch.nn.functional.pad(x, flat)

kernel_name = 'interleave_layers__sliding_local_dilated__dense_activation_gelu__prompt'

def setup_inputs():

    _w = (lambda a: (lambda t: t.to(torch.bfloat16) if t.is_floating_point() else t)(torch.as_tensor(a)))
    def _A_setup():
        B, S, D = 1, 2048, 512
        return {
            "x": _w((lambda *s: torch.randn(*s, dtype=torch.bfloat16) * 0.05)(B, S, D)),
            "wqkv": _w((lambda *s: torch.randn(*s, dtype=torch.bfloat16) * 0.05)(D, 3 * D)),
            "wo": _w((lambda *s: torch.randn(*s, dtype=torch.bfloat16) * 0.05)(D, D)),
        }
    _A_in = _A_setup()

    def _B_setup():
        B, S, D, F = 1, 2048, 512, 1376
        return {
            "x": _w((lambda *s: torch.randn(*s, dtype=torch.bfloat16) * 0.05)(B, S, D)),
            "w1": _w((lambda *s: torch.randn(*s, dtype=torch.bfloat16) * 0.8)(D, F) * (D ** -0.5)),
            "b1": _w((lambda *s: torch.randn(*s, dtype=torch.bfloat16) * 0.8)(F) * 0.01),
            "w2": _w((lambda *s: torch.randn(*s, dtype=torch.bfloat16) * 0.8)(F, D) * (F ** -0.5)),
            "b2": _w((lambda *s: torch.randn(*s, dtype=torch.bfloat16) * 0.8)(D) * 0.01),
        }
    _B_in = _B_setup()

    return {
        "A_x": _A_in["x"],
        "A_wqkv": _A_in["wqkv"],
        "A_wo": _A_in["wo"],
        "B_x": _B_in["x"],
        "B_w1": _B_in["w1"],
        "B_b1": _B_in["b1"],
        "B_w2": _B_in["w2"],
        "B_b2": _B_in["b2"],
    }

def reference(A_x, A_wqkv, A_wo, B_x, B_w1, B_b1, B_w2, B_b2):
    def _A_ref(x, wqkv, wo):
        B, S, D = x.shape
        H = 32; Dh = D // H
        W, dil = 8, 2
        qkv = (lambda x, *d: x.permute(*d))((x @ wqkv).reshape(B, S, 3, H, Dh), 2, 0, 3, 1, 4)
        q, k, v = qkv[0], qkv[1], qkv[2]
        scale = Dh ** -0.5
        pos = torch.arange(S)
        off = torch.arange(W) * dil
        idx = pos[:, None] - off[None, :]
        mask = idx >= 0
        idx_c = torch.where(mask, idx, 0).reshape(-1)
        kg = k[:, :, idx_c, :].reshape(B, H, S, W, Dh)
        vg = v[:, :, idx_c, :].reshape(B, H, S, W, Dh)
        logits = torch.einsum("bhsd,bhswd->bhsw", q, kg) * scale
        logits = torch.where(mask[None, None, :, :], logits, -1e9)
        attn = _softmax(logits, axis=-1)
        o = torch.einsum("bhsw,bhswd->bhsd", attn, vg)
        return (lambda x, *d: x.permute(*d))(o, 0, 2, 1, 3).reshape(B, S, D) @ wo

    def _B_ref(x, w1, b1, w2, b2):
        h = torch.einsum("bsd,df->bsf", x, w1) + b1
        h = _gelu(h)
        return torch.einsum("bsf,fd->bsd", h, w2) + b2

    x = A_x
    x = x + _A_ref(_layernorm(x, axis=-1), A_wqkv, A_wo)
    x = x + _B_ref(_layernorm(x, axis=-1), B_w1, B_b1, B_w2, B_b2)
    x = x + _A_ref(_layernorm(x, axis=-1), A_wqkv, A_wo)
    x = x + _B_ref(_layernorm(x, axis=-1), B_w1, B_b1, B_w2, B_b2)
    return x
```

```asm
; @launch grid=(256,1,1) block=(256,1,1) lds=159744
.amdgcn_target "amdgcn-amd-amdhsa--gfx950"
.text
.globl interleave_layers__sliding_local_dilated__dense_activation_gelu__prompt_kernel
.p2align 8
.type interleave_layers__sliding_local_dilated__dense_activation_gelu__prompt_kernel,@function
interleave_layers__sliding_local_dilated__dense_activation_gelu__prompt_kernel:
s_cmp_ge_u32 s2, 256
s_cbranch_scc1 K1_last
s_getpc_b64 s[64:65]
K1_pc:
s_lshr_b32 s62, s2, 3
s_lshl_b32 s62, s62, 12
v_lshlrev_b32 v1, 4, v0
s_and_b32 s65, s65, 0xffff
s_mov_b32 s66, K1_last-K1_pc
s_mov_b32 s67, 0x20000
v_add_u32 v1, s62, v1
buffer_load_dwordx4 v[4:7], v1, s[64:67], 0 offen
s_load_dwordx2 s[8:9], s[0:1], 0
s_load_dwordx2 s[84:85], s[0:1], 8
s_load_dwordx2 s[96:97], s[0:1], 16
s_load_dwordx2 s[98:99], s[0:1], 32
s_load_dwordx2 s[20:21], s[0:1], 40
s_load_dwordx2 s[100:101], s[0:1], 48
s_load_dwordx2 s[92:93], s[0:1], 56
s_load_dwordx2 s[12:13], s[0:1], 64
s_load_dwordx2 s[16:17], s[0:1], 72
s_load_dwordx2 s[4:5], s[0:1], 80
s_memrealtime s[82:83]
v_lshrrev_b32 v128, 6, v0
v_and_b32 v129, 63, v0
v_readfirstlane_b32 s24, v128
s_getreg_b32 s75, hwreg(HW_REG_XCC_ID)
s_lshr_b32 s25, s2, 3
s_and_b32 s25, s25, 7
s_and_b32 s28, s2, 1
s_lshr_b32 s27, s2, 1
s_and_b32 s27, s27, 3
s_lshl_b32 s27, s27, 2
s_lshr_b32 s60, s2, 6
s_add_u32 s27, s27, s60
s_lshl_b32 s26, s28, 4
s_add_u32 s26, s26, s27
v_lshlrev_b32 v0, 4, v129
v_and_b32 v130, 15, v129
v_lshrrev_b32 v131, 4, v129
v_and_b32 v132, 7, v129
v_lshrrev_b32 v133, 3, v129
v_mov_b32 v134, 0x40000000
s_waitcnt lgkmcnt(0)
s_and_b32 s5, s5, 0xffff
s_mov_b32 s6, 0x1200000
s_mov_b32 s7, 0x20000
s_and_b32 s9, s9, 0xffff
s_mov_b32 s10, 0x200000
s_mov_b32 s11, 0x20000
s_and_b32 s85, s85, 0xffff
s_mov_b32 s86, 0x180000
s_mov_b32 s87, 0x20000
s_and_b32 s13, s13, 0xffff
s_mov_b32 s14, 0x200000
s_mov_b32 s15, 0x20000
s_and_b32 s17, s17, 0xffff
s_mov_b32 s18, 0x100
s_mov_b32 s19, 0x20000
s_and_b32 s21, s21, 0xffff
s_mov_b32 s22, 0xac0
s_mov_b32 s23, 0x20000
s_and_b32 s93, s93, 0xffff
s_mov_b32 s94, 0x400
s_mov_b32 s95, 0x20000
s_mov_b32 s91, 0x20000
s_and_b32 s50, s2, 7
s_lshl_b32 s50, s50, 1
s_mul_i32 s62, s25, 4080
s_lshl_b32 s63, s26, 7
s_lshr_b32 s64, s24, 1
s_lshl1_add_u32 s65, s25, s64
s_and_b32 s66, s24, 1
s_lshl_b32 s67, s65, 10
s_lshl_b32 s68, s66, 3
s_add_u32 s69, s67, s68
s_mul_i32 s78, s26, 180224
v_min_u32 v142, 11, v129
s_lshr_b32 s79, s2, 3
s_lshl2_add_u32 s64, s79, s24
s_mul_i32 s65, s64, 12
v_add_u32 v142, s65, v142
v_min_u32 v142, 1535, v142
s_mul_i32 s66, s50, 96
s_add_u32 s67, s66, 0
v_add_u32 v142, s67, v142
v_subrev_u32 v143, 1536, v142
v_min_u32 v142, v143, v142
v_lshlrev_b32 v142, 10, v142
s_sub_u32 s68, 384, s84
s_and_b32 s79, s68, 0x380
buffer_load_dword v8, v142, s[84:87], s79 offen
s_lshl_b32 s60, s82, 4
s_or_b32 s60, s60, 8
v_mov_b32 v135, s60
s_and_b32 s60, s24, 1
s_lshl_b32 s56, s60, 6
s_or_b32 s60, s2, s24
v_or_b32 v141, s60, v129
v_mov_b32 v101, 0
v_cmp_eq_u32_e64 vcc, 0, v141
s_mul_i32 s82, s24, 24576
s_lshl_b32 s3, s25, 7
v_cndmask_b32_e64 v141, v134, v101, vcc
s_add_u32 s82, s82, s3
buffer_store_dword v135, v141, s[16:19], 0 offen sc1
s_mul_i32 s83, s24, 3072
s_lshl_b32 s43, s27, 17
v_add_u32 v139, s50, v129
v_and_b32 v136, 6, v133
v_and_b32 v139, 15, v139
v_xor_b32 v136, v136, v132
v_mul_u32_u24 v139, 98304, v139
v_lshlrev_b32 v136, 4, v136
v_mul_u32_u24 v137, 3072, v133
v_add_u32 v139, s82, v139
v_xad_u32 v138, v136, s56, v137
s_add_u32 m0, s83, 0x0
v_readlane_b32 s64, v139, 0
s_lshl_b32 s57, s28, 10
s_lshr_b32 s61, s24, 1
s_add_u32 s43, s43, s57
s_lshl_b32 s57, s61, 14
s_add_u32 s61, s43, s57
buffer_load_dwordx4 v138, s[84:87], s64 offen offset:0 lds
s_lshl_b32 s57, s24, 3
s_add_u32 s57, s57, s50
buffer_load_dwordx4 v138, s[84:87], s64 offen offset:1024 lds
s_lshl_b32 s57, s57, 6
s_add_u32 s0, s57, 0
buffer_load_dwordx4 v138, s[84:87], s64 offen offset:2048 lds
s_add_u32 m0, s83, 0x3000
s_and_b32 s0, s0, 0x380
v_readlane_b32 s65, v139, 1
s_lshl_b32 s38, s24, 12
s_add_u32 s0, s0, s61
v_xor_b32 v140, v132, v133
v_lshlrev_b32 v140, 4, v140
s_nop 0
buffer_load_dwordx4 v138, s[84:87], s65 offen offset:0 lds
s_add_u32 s1, s57, 128
s_and_b32 s1, s1, 0x380
buffer_load_dwordx4 v138, s[84:87], s65 offen offset:1024 lds
s_add_u32 s1, s1, s61
s_add_u32 s28, s57, 256
buffer_load_dwordx4 v138, s[84:87], s65 offen offset:2048 lds
s_and_b32 s28, s28, 0x380
s_add_u32 s28, s28, s61
v_lshl_add_u32 v100, v133, 11, v140
s_add_u32 s66, s0, 0x18000
s_add_u32 m0, s38, 0x18000
s_add_u32 s70, s57, 384
buffer_load_dwordx4 v100, s[8:11], s66 offen lds
s_add_u32 s67, s1, 0x18000
s_add_u32 m0, s38, 0x18400
s_and_b32 s70, s70, 0x380
buffer_load_dwordx4 v100, s[8:11], s67 offen lds
s_add_u32 s68, s28, 0x18000
s_add_u32 m0, s38, 0x18800
s_add_u32 s70, s70, s61
buffer_load_dwordx4 v100, s[8:11], s68 offen lds
s_add_u32 s79, s70, 0x18000
s_add_u32 m0, s38, 0x18c00
s_sub_u32 s33, s25, 5
buffer_load_dwordx4 v100, s[8:11], s79 offen lds
s_lshl_b32 s41, s26, 2
s_mul_i32 s32, s25, 5
s_max_i32 s33, s33, 0
s_add_u32 s41, s41, s24
s_add_u32 s60, s32, s33
s_and_b32 s32, s41, 15
s_mul_i32 s40, s32, 88064
s_lshl_b32 s33, s60, 6
s_lshr_b32 s34, s41, 4
s_add_u32 s40, s40, s33
s_lshl_b32 s33, s34, 7
s_add_u32 s40, s40, s33
s_mul_i32 s33, s34, 98304
s_mul_i32 s39, s25, 196608
s_mul_i32 s54, s32, 3072
s_cmp_lt_u32 s34, 2
s_cselect_b32 s33, s33, 2048
s_cselect_b32 s55, 1024, 0
s_cselect_b32 s37, 0, 49152
s_cselect_b32 s44, 0, 0x40000000
s_add_u32 s54, s54, s39
s_add_u32 s54, s54, 0x200000
s_add_u32 s54, s54, s33
s_add_u32 s33, s55, s37
s_lshl_b32 s32, s25, 16
s_mul_i32 s53, s25, 180224
s_mov_b32 s55, s33
s_sub_u32 s34, s41, 48
s_add_u32 s32, s32, 0x180000
s_sub_u32 s33, s41, 64
s_add_u32 s53, s53, 0x380000
s_and_b32 s97, s97, 0xffff
s_and_b32 s101, s101, 0xffff
s_cmp_lt_u32 s41, 64
s_cselect_b32 s34, s34, s33
s_cselect_b32 s32, s32, s53
s_cselect_b32 s96, s96, s100
s_cselect_b32 s97, s97, s101
s_cselect_b32 s53, 16, 43
s_lshl_b32 s33, s34, 12
s_lshl_b32 s34, s34, 15
s_cmp_lt_u32 s25, 5
s_cselect_b32 s44, s44, 0
s_add_u32 s37, s37, 49152
s_movk_i32 s42, 2752
s_movk_i32 s46, 1024
s_mov_b32 s49, 0
s_mov_b32 s88, s98
s_and_b32 s89, s99, 0xffff
s_mov_b32 s90, 1409024
s_lshl_b32 s53, s53, 15
s_add_u32 s32, s32, s33
s_add_u32 s34, s34, s3
s_cmp_ge_u32 s41, 48
s_cselect_b32 s40, s34, s40
s_cselect_b32 s54, s32, s54
s_cselect_b32 s55, 1024, s55
s_cselect_b32 s37, 2048, s37
s_cselect_b32 s42, 1024, s42
s_cselect_b32 s46, 512, s46
s_cselect_b32 s49, 1, s49
s_cselect_b32 s44, 0, s44
s_cselect_b32 s88, s96, s88
s_cselect_b32 s89, s97, s89
s_cselect_b32 s90, s53, s90
s_sub_u32 s33, s41, 108
s_mul_hi_u32 s53, s33, 0x55555556
s_mul_i32 s34, s53, 95232
s_lshl_b32 s53, s33, 10
s_add_u32 s34, s34, s53
s_add_u32 s34, s34, s3
s_add_u32 s32, s39, s53
s_cmp_ge_u32 s41, 108
s_cselect_b32 s40, s34, s40
s_cselect_b32 s54, s32, s54
s_cselect_b32 s55, 49152, s55
s_cselect_b32 s37, 98304, s37
s_cselect_b32 s42, 3072, s42
s_cselect_b32 s46, 1024, s46
s_cselect_b32 s49, 0, s49
s_cselect_b32 s88, s84, s88
s_cselect_b32 s89, s85, s89
s_cselect_b32 s90, s86, s90
s_mov_b32 s52, 0x40000000
s_cmp_eq_u32 s41, 107
s_cselect_b32 s52, 0, s52
s_cselect_b32 s53, 0x40000000, 0
s_add_u32 s64, s60, s24
s_lshl1_add_u32 s65, s60, s24
s_add_u32 s66, s65, 8
v_mul_u32_u24 v148, s42, v133
v_add_u32 v148, s53, v148
v_add_u32 v147, v148, v136
s_add_u32 m0, s38, 0x20000
s_lshl_b32 s42, s42, 3
buffer_load_dwordx4 v147, s[88:91], s40 offen offset:0 lds
s_sub_u32 s42, s42, 1024
s_lshl_b32 s67, s25, 4
s_lshl2_add_u32 s68, s25, s24
s_lshl_b32 s79, s68, 14
v_xad_u32 v148, v136, 64, v148
s_add_u32 s65, s40, s42
v_cmp_eq_u32_e64 vcc, 0, v129
v_lshlrev_b32 v149, 1, v129
s_lshl_b32 s68, s24, 2
v_add_u32 v196, s68, v131
v_lshlrev_b32 v192, 6, v196
s_lshl_b32 s68, s25, 3
v_xor_b32 v193, v131, v132
s_lshl_b32 s71, s24, 11
v_add_u32 v192, s68, v192
v_lshrrev_b32 v195, 1, v130
v_lshlrev_b32 v193, 4, v193
v_add_u32 v192, v192, v195
v_lshl_add_u32 v194, v132, 7, v193
v_lshrrev_b32 v195, 3, v130
v_lshl_add_u32 v194, v195, 13, v194
v_add_u32 v12, 0x18000, v194
v_add_u32 v220, s71, v12
v_xor_b32 v221, 64, v220
v_and_b32 v156, 3, v130
s_lshl_b32 s57, s24, 5
v_lshrrev_b32 v155, 2, v130
v_lshlrev_b32 v154, 3, v156
v_lshl_add_u32 v154, v155, 7, v154
v_lshrrev_b32 v155, 1, v155
v_lshl_add_u32 v154, v155, 5, v154
v_and_b32 v157, 1, v131
v_lshl_add_u32 v158, v157, 6, v154
v_mul_u32_u24 v155, 3072, v131
v_xad_u32 v158, v158, s57, v155
v_xor_b32 v159, 64, v158
v_mov_b32 v240, 0x3f803f80
v_mov_b32 v241, 0x3f803f80
v_mov_b32 v242, 0x3f803f80
v_mov_b32 v243, 0x3f803f80
s_cmp_eq_u32 s49, 0
s_cselect_b32 s56, 64, 0
s_cselect_b32 s57, 1, 4
v_lshrrev_b32 v170, 1, v131
v_and_b32 v170, s49, v170
s_lshl_b32 s57, s57, 9
v_xor_b32 v170, v170, v157
v_lshl_add_u32 v170, v170, 6, v154
v_mul_u32_u24 v155, s46, v131
v_lshlrev_b32 v200, 2, v131
v_add_u32 v170, v170, v155
s_add_u32 s68, s38, 0x20000
v_sub_u32 v200, v200, v130
v_add_u32 v162, s68, v170
v_add_u32 v202, 0, v200
v_xor_b32 v163, 32, v162
v_xor_b32 v164, 64, v162
v_xor_b32 v165, 96, v162
v_mov_b32 v155, s57
s_lshl_b32 s29, s26, 16
v_xad_u32 v166, v162, s56, v155
v_xad_u32 v167, v163, s56, v155
v_xad_u32 v168, v164, s56, v155
v_xad_u32 v169, v165, s56, v155
v_mov_b32 v201, 0xf149f2ca
v_lshrrev_b32 v223, 1, v0
v_add_u32 v223, 0x26000, v223
s_lshl_b32 s68, s24, 9
v_add_u32 v222, s68, v223
v_add_u32 v160, 49152, v158
v_add_u32 v161, 49152, v159
s_add_u32 s34, s55, s37
s_add_u32 s34, s34, s54
s_add_u32 s55, s55, s54
s_add_u32 s37, s37, s54
v_add_u32 v188, s44, v0
s_add_u32 s45, s62, s63
s_lshl_b32 s68, s24, 2
s_add_u32 s63, s67, s68
s_lshl2_add_u32 s62, s25, s24
v_mov_b32 v144, s63
v_cndmask_b32_e64 v2, v134, v144, vcc
v_cmp_gt_u32_e64 vcc, 16, v129
s_mul_i32 s67, s24, 45056
s_cmp_eq_u32 s24, 0
s_cselect_b32 s68, 0, 0x40000000
v_cndmask_b32_e64 v149, v134, v149, vcc
v_add_u32 v149, s52, v149
v_cmp_gt_u32_e64 vcc, 16, v129
s_add_u32 s45, s45, 0xac0000
v_add_u32 v102, s68, v2
v_mov_b32 v145, v102
s_lshl_b32 s82, s25, 12
s_add_u32 s82, s82, 0xac0000
v_and_b32 v3, 31, v129
v_lshlrev_b32 v146, 7, v3
v_xor_b32 v13, 64, v12
s_lshl_b32 s36, s26, 13
s_and_b32 s75, s75, 7
s_add_u32 s36, s36, 0x5c0000
s_add_u32 s61, s36, 4096
v_lshl_add_u32 v194, v130, 8, v193
v_lshlrev_b32 v193, 4, v131
s_lshl_b32 s35, s26, 12
s_mov_b32 s52, s45
v_mov_b32 v36, 0x3b000000
s_mov_b32 s46, 0x3eb8aa3b
s_add_u32 s41, s41, 20
s_mul_hi_u32 s53, s41, 0x55555556
s_mul_i32 s33, s53, 95232
s_lshl_b32 s53, s41, 10
s_add_u32 s33, s33, s53
s_add_u32 s33, s33, s3
s_add_u32 s32, s39, s53
s_cmp_lt_u32 s41, 48
s_cselect_b32 s53, 0, 0x40000000
s_lshl2_add_u32 s63, s25, s24
v_add3_u32 v212, v137, v136, s53
v_xor_b32 v213, 64, v212
v_lshlrev_b32 v3, 2, v3
s_lshl_b32 s101, s24, 10
s_add_u32 s101, s101, 0x24000
v_lshlrev_b32 v198, 3, v131
v_lshl_add_u32 v14, v130, 6, v193
v_lshl_add_u32 v189, v157, 6, v154
v_lshl_add_u32 v189, v131, 10, v189
s_add_u32 s68, s38, 0x10000
v_add_u32 v208, s68, v189
v_xor_b32 v209, 32, v208
v_xor_b32 v210, 64, v208
v_xor_b32 v211, 96, v208
s_mov_b32 s49, 0xffff0000
v_mov_b32 v24, 0x3f803f80
v_mov_b32 v25, 0x3f803f80
v_add_u32 v214, s53, v0
s_add_u32 s31, s69, s78
s_lshl_b32 s68, s25, 11
s_lshl_b32 s78, s24, 14
s_cmp_eq_u32 s27, 0
s_cselect_b32 s81, 131072, 0
v_lshlrev_b32 v191, 11, v196
v_add_u32 v37, s78, v0
s_add_u32 s81, s81, s43
v_lshl_add_u32 v191, v130, 3, v191
s_sub_u32 s81, s81, 32768
v_add_u32 v38, s3, v191
s_add_u32 s51, s81, 16384
s_add_u32 s40, s79, 0x180000
s_lshl2_add_u32 s69, s25, s24
s_lshl_b32 s72, s24, 14
s_mul_i32 s78, s26, 180224
s_add_u32 s72, s78, s38
v_or_b32 v124, 0x2000, v12
v_or_b32 v125, 0x2000, v13
s_add_u32 s79, s38, 0x10000
v_add_u32 v18, s79, v194
v_xor_b32 v19, 64, v18
v_and_b32 v197, 7, v196
v_lshrrev_b32 v194, 3, v196
s_lshl_b32 s47, s64, 6
s_add_u32 s78, s67, s68
s_mul_i32 s79, s26, 180224
s_lshl_b32 s64, s69, 11
s_add_u32 s68, s78, s79
s_add_u32 s67, s64, s29
s_add_u32 s69, s68, 0xb00000
s_add_u32 s78, s67, 0x800000
v_mov_b32 v112, s69
v_mov_b32 v113, s78
v_cndmask_b32_e64 v112, v113, v112, vcc
v_lshl_add_u32 v112, v130, 7, v112
v_cmp_gt_u32_e64 vcc, 16, v129
s_lshl_b32 s79, s24, 10
s_add_u32 s64, s79, 0x25000
v_cndmask_b32_e64 v112, v134, v112, vcc
v_cmp_eq_u32_e64 vcc, 0, v132
v_add_u32 v15, s64, v193
s_lshl2_add_u32 s68, s25, s24
v_cndmask_b32_e64 v22, v134, v192, vcc
s_lshl_b32 s67, s68, 7
s_add_u32 s69, s67, s35
s_add_u32 s78, s69, 0x520000
v_writelane_b32 v112, s78, 32
s_add_u32 s79, s67, s36
v_writelane_b32 v112, s79, 33
s_add_u32 s64, s67, s35
s_add_u32 s68, s64, 0x500000
v_writelane_b32 v112, s68, 34
v_lshl_add_u32 v193, v130, 5, v198
v_add_u32 v16, s101, v193
v_lshlrev_b32 v193, 3, v129
v_add_u32 v17, s101, v193
v_xor_b32 v193, v130, v197
v_lshlrev_b32 v193, 4, v193
v_lshl_add_u32 v193, v196, 8, v193
v_add_u32 v20, 0x10000, v193
v_lshrrev_b32 v193, 1, v130
v_xor_b32 v193, v193, v197
v_lshlrev_b32 v193, 4, v193
v_lshl_add_u32 v193, v197, 7, v193
v_lshl_add_u32 v193, v194, 13, v193
v_and_b32 v194, 1, v130
v_lshl_add_u32 v193, v194, 3, v193
s_lshl_b32 s69, s25, 10
v_add_u32 v21, s69, v193
s_cmp_lt_u32 s25, 5
s_cselect_b32 s80, 0x40000000, 0
s_cmp_lt_u32 s24, 2
s_cselect_b32 s80, 0, s80
s_lshl_b32 s48, s66, 5
v_add_u32 v199, s80, v198
s_add_u32 s30, s29, s38
s_mul_i32 s39, s63, 49152
s_add_u32 s41, s39, 0x200000
v_add_u32 v1, s80, v0
s_mov_b32 s44, 0x3eeff558
v_lshlrev_b32 v204, 16, v0
s_mul_i32 s78, s24, 45056
buffer_load_dword v206, v204, s[4:7], 0 offen
s_mul_i32 s79, s26, 180224
buffer_load_dword v207, v204, s[12:15], 0 offen
s_add_u32 s67, s78, s79
s_add_u32 s100, s67, 0xb0ac00
s_lshl_b32 s73, s26, 14
s_lshl_b32 s74, s26, 10
s_cmp_lt_u32 s24, 2
s_cselect_b32 s53, 0x40000000, 0
buffer_load_dwordx4 v148, s[88:91], s65 offen offset:1024 lds
s_add_u32 s64, s65, s42
s_mul_i32 s68, s62, 45056
buffer_load_dwordx4 v147, s[88:91], s64 offen offset:2048 lds
s_add_u32 s69, s64, s42
s_add_u32 s42, s68, 0x380000
buffer_load_dwordx4 v148, s[88:91], s69 offen offset:3072 lds
buffer_load_ushort v150, v149, s[92:95], s3 offen offset:0
buffer_load_ushort v151, v149, s[92:95], s3 offen offset:32
buffer_load_ushort v152, v149, s[92:95], s3 offen offset:64
buffer_load_ushort v153, v149, s[92:95], s3 offen offset:96
s_add_u32 s66, s0, 0x10000
s_add_u32 m0, s38, 0x1c000
v_cmp_lt_i32_e64 s[92:93], 8, v202
v_add_u32 v202, 7, v202
v_cmp_gt_u32_e64 s[56:57], 8, v202
v_add_u32 v202, 1, v200
v_cmp_lt_i32_e64 s[94:95], 8, v202
v_add_u32 v202, 7, v202
buffer_load_dwordx4 v100, s[8:11], s66 offen lds
s_add_u32 s63, s1, 0x10000
s_add_u32 m0, s38, 0x1c400
v_cndmask_b32_e64 v32, v201, 0, s[56:57]
v_cmp_gt_u32_e64 s[56:57], 8, v202
v_add_u32 v202, 2, v200
v_cmp_lt_i32_e64 s[96:97], 8, v202
v_add_u32 v202, 7, v202
v_cndmask_b32_e64 v33, v201, 0, s[56:57]
v_cmp_gt_u32_e64 s[56:57], 8, v202
v_add_u32 v202, 3, v200
v_cmp_lt_i32_e64 s[98:99], 8, v202
v_add_u32 v202, 7, v202
v_cndmask_b32_e64 v34, v201, 0, s[56:57]
v_cmp_gt_u32_e64 s[56:57], 8, v202
v_add_u32 v202, 0, v200
v_cmp_eq_u32_e64 vcc, 0, v202
v_add_u32 v202, 1, v200
buffer_load_dwordx4 v100, s[8:11], s63 offen lds
s_add_u32 s78, s28, 0x10000
s_add_u32 m0, s38, 0x1c800
v_cndmask_b32_e64 v216, 0, 1.0, vcc
v_cmp_eq_u32_e64 vcc, 0, v202
v_add_u32 v202, 2, v200
v_cndmask_b32_e64 v35, v201, 0, s[56:57]
v_cndmask_b32_e64 v217, 0, 1.0, vcc
v_cmp_eq_u32_e64 vcc, 0, v202
v_add_u32 v202, 3, v200
v_cndmask_b32_e64 v203, 0, -1, s[92:93]
v_cndmask_b32_e64 v218, 0, 1.0, vcc
v_cmp_eq_u32_e64 vcc, 0, v202
v_lshrrev_b32 v26, 16, v203
v_cndmask_b32_e64 v203, 0, -1, s[94:95]
v_cndmask_b32_e64 v219, 0, 1.0, vcc
v_and_or_b32 v26, v203, s49, v26
v_cndmask_b32_e64 v203, 0, -1, s[96:97]
buffer_load_dwordx4 v100, s[8:11], s78 offen lds
s_add_u32 s79, s70, 0x10000
s_add_u32 m0, s38, 0x1cc00
v_lshrrev_b32 v27, 16, v203
v_cndmask_b32_e64 v203, 0, -1, s[98:99]
v_and_or_b32 v27, v203, s49, v27
s_mov_b32 s3, s50
s_cmp_eq_u32 s27, 0
s_cselect_b32 s50, 0xf149f2ca, 0
buffer_load_dwordx4 v100, s[8:11], s79 offen lds
s_add_u32 m0, s83, 0x6000
v_readlane_b32 s67, v139, 2
s_nop 4
buffer_load_dwordx4 v138, s[84:87], s67 offen offset:0 lds
buffer_load_dwordx4 v138, s[84:87], s67 offen offset:1024 lds
buffer_load_dwordx4 v138, s[84:87], s67 offen offset:2048 lds
s_add_u32 m0, s83, 0x9000
v_readlane_b32 s65, v139, 3
s_nop 4
buffer_load_dwordx4 v138, s[84:87], s65 offen offset:0 lds
buffer_load_dwordx4 v138, s[84:87], s65 offen offset:1024 lds
s_waitcnt vmcnt(23)
s_barrier
buffer_load_dwordx4 v138, s[84:87], s65 offen offset:2048 lds
s_add_u32 m0, s83, 0xc000
v_readlane_b32 s62, v139, 4
ds_read_b64_tr_b16 a[0:1], v158 offset:0
ds_read_b64_tr_b16 a[2:3], v159 offset:512
ds_read_b64_tr_b16 a[4:5], v158 offset:1024
ds_read_b64_tr_b16 a[6:7], v159 offset:1536
s_nop 0
buffer_load_dwordx4 v138, s[84:87], s62 offen offset:0 lds
ds_read_b64_tr_b16 a[8:9], v158 offset:2048
ds_read_b64_tr_b16 a[10:11], v159 offset:2560
ds_read_b64_tr_b16 a[12:13], v158 offset:12288
ds_read_b64_tr_b16 a[14:15], v159 offset:12800
ds_read_b64_tr_b16 a[16:17], v158 offset:13312
ds_read_b64_tr_b16 a[18:19], v159 offset:13824
ds_read_b64_tr_b16 a[20:21], v158 offset:14336
ds_read_b64_tr_b16 a[22:23], v159 offset:14848
buffer_load_dword v126, v101, s[16:19], 0 offen sc1
s_waitcnt lgkmcnt(10)
v_mfma_f32_16x16x32_bf16 v[244:247], a[0:3], v[240:243], 0
buffer_load_dwordx4 v138, s[84:87], s62 offen offset:1024 lds
s_waitcnt lgkmcnt(8)
buffer_load_dwordx4 v138, s[84:87], s62 offen offset:2048 lds
s_add_u32 m0, s83, 0xf000
v_readlane_b32 s64, v139, 5
v_mfma_f32_16x16x32_bf16 v[248:251], a[4:7], v[240:243], 0
s_waitcnt lgkmcnt(6)
v_mfma_f32_16x16x32_bf16 v[252:255], a[8:11], v[240:243], 0
s_nop 1
buffer_load_dwordx4 v138, s[84:87], s64 offen offset:0 lds
s_waitcnt lgkmcnt(4)
v_mfma_f32_16x16x32_bf16 v[244:247], a[12:15], v[240:243], v[244:247]
buffer_load_dwordx4 v138, s[84:87], s64 offen offset:1024 lds
s_waitcnt vmcnt(26)
s_barrier
s_waitcnt lgkmcnt(2)
v_mfma_f32_16x16x32_bf16 v[248:251], a[16:19], v[240:243], v[248:251]
s_waitcnt vmcnt(20)
ds_read_b64_tr_b16 v[172:173], v162 offset:0
ds_read_b128 v[232:235], v220 offset:0
s_waitcnt lgkmcnt(2)
v_mfma_f32_16x16x32_bf16 v[252:255], a[20:23], v[240:243], v[252:255]
ds_read_b128 v[236:239], v221 offset:0
ds_read_b64_tr_b16 v[176:177], v163 offset:0
ds_read_b64_tr_b16 v[180:181], v164 offset:0
buffer_load_dwordx4 v138, s[84:87], s64 offen offset:2048 lds
s_add_u32 m0, s83, 0x12000
v_readlane_b32 s68, v139, 6
ds_read_b64_tr_b16 v[184:185], v165 offset:0
ds_read_b64_tr_b16 v[174:175], v166 offset:0
ds_read_b64_tr_b16 v[178:179], v167 offset:0
ds_read_b64_tr_b16 v[182:183], v168 offset:0
ds_read_b64_tr_b16 v[186:187], v169 offset:0
ds_read_b128 v[72:75], v12 offset:0
ds_read_b128 v[80:83], v13 offset:0
buffer_load_dwordx4 v138, s[84:87], s68 offen offset:0 lds
s_waitcnt lgkmcnt(10)
v_mfma_f32_16x16x32_bf16 v[224:227], v[240:243], v[232:235], 0
v_mfma_f32_16x16x32_bf16 v[228:231], v[232:235], v[232:235], 0
s_waitcnt lgkmcnt(9)
ds_read_b128 v[232:235], v220 offset:1024
v_mfma_f32_16x16x32_bf16 v[224:227], v[240:243], v[236:239], v[224:227]
buffer_load_dwordx4 v138, s[84:87], s68 offen offset:1024 lds
v_mfma_f32_16x16x32_bf16 v[228:231], v[236:239], v[236:239], v[228:231]
s_waitcnt vmcnt(22)
ds_read_b128 v[236:239], v221 offset:1024
s_waitcnt vmcnt(21) lgkmcnt(10)
v_or_b32 v172, v150, v172
v_or_b32 v176, v151, v176
s_waitcnt vmcnt(20) lgkmcnt(9)
v_or_b32 v180, v152, v180
s_waitcnt vmcnt(19) lgkmcnt(8)
v_or_b32 v184, v153, v184
buffer_load_dwordx4 v138, s[84:87], s68 offen offset:2048 lds
s_add_u32 m0, s83, 0x15000
v_readlane_b32 s69, v139, 7
s_waitcnt lgkmcnt(3)
v_mfma_f32_16x16x32_bf16 v[40:43], a[0:3], v[72:75], 0
v_mfma_f32_16x16x32_bf16 v[44:47], a[4:7], v[72:75], 0
s_waitcnt lgkmcnt(2)
s_waitcnt vmcnt(16)
s_barrier
s_waitcnt lgkmcnt(1)
v_mfma_f32_16x16x32_bf16 v[224:227], v[240:243], v[232:235], v[224:227]
buffer_load_dwordx4 v138, s[84:87], s69 offen offset:0 lds
s_waitcnt lgkmcnt(0)
v_mfma_f32_16x16x32_bf16 v[228:231], v[232:235], v[232:235], v[228:231]
ds_read_b128 v[232:235], v220 offset:16384
ds_read_b128 v[76:79], v12 offset:16384
v_mfma_f32_16x16x32_bf16 v[224:227], v[240:243], v[236:239], v[224:227]
ds_read_b128 v[84:87], v13 offset:16384
v_mfma_f32_16x16x32_bf16 v[228:231], v[236:239], v[236:239], v[228:231]
ds_read_b128 v[236:239], v221 offset:16384
v_mfma_f32_16x16x32_bf16 v[48:51], a[8:11], v[72:75], 0
ds_read_b128 v[72:75], v12 offset:1024
buffer_load_dwordx4 v138, s[84:87], s69 offen offset:1024 lds
v_mfma_f32_16x16x32_bf16 v[40:43], a[12:15], v[80:83], v[40:43]
s_nop 2
v_mul_f32 v225, v228, v216
v_fmac_f32 v225, v229, v217
v_fmac_f32 v225, v230, v218
v_fmac_f32 v225, v231, v219
v_mfma_f32_16x16x32_bf16 v[44:47], a[16:19], v[80:83], v[44:47]
ds_write_b64 v222, v[224:225] offset:0
v_mfma_f32_16x16x32_bf16 v[48:51], a[20:23], v[80:83], v[48:51]
s_waitcnt lgkmcnt(5)
ds_read_b128 v[80:83], v13 offset:1024
s_waitcnt lgkmcnt(5)
v_mfma_f32_16x16x32_bf16 v[224:227], v[240:243], v[232:235], 0
buffer_load_dwordx4 v138, s[84:87], s69 offen offset:2048 lds
v_mfma_f32_16x16x32_bf16 v[228:231], v[232:235], v[232:235], 0
ds_read_b128 v[232:235], v220 offset:17408
v_mfma_f32_16x16x32_bf16 v[56:59], a[0:3], v[76:79], 0
s_waitcnt lgkmcnt(4)
v_mfma_f32_16x16x32_bf16 v[224:227], v[240:243], v[236:239], v[224:227]
v_mfma_f32_16x16x32_bf16 v[228:231], v[236:239], v[236:239], v[228:231]
ds_read_b128 v[236:239], v221 offset:17408
buffer_store_dwordx4 v[172:175], v0, s[4:7], s54 offen sc1
v_mfma_f32_16x16x32_bf16 v[60:63], a[4:7], v[76:79], 0
v_mfma_f32_16x16x32_bf16 v[64:67], a[8:11], v[76:79], 0
ds_read_b128 v[76:79], v12 offset:17408
s_waitcnt lgkmcnt(2)
v_mfma_f32_16x16x32_bf16 v[224:227], v[240:243], v[232:235], v[224:227]
v_mfma_f32_16x16x32_bf16 v[228:231], v[232:235], v[232:235], v[228:231]
v_mfma_f32_16x16x32_bf16 v[56:59], a[12:15], v[84:87], v[56:59]
s_waitcnt lgkmcnt(1)
v_mfma_f32_16x16x32_bf16 v[224:227], v[240:243], v[236:239], v[224:227]
v_mfma_f32_16x16x32_bf16 v[228:231], v[236:239], v[236:239], v[228:231]
v_mfma_f32_16x16x32_bf16 v[60:63], a[16:19], v[84:87], v[60:63]
v_mfma_f32_16x16x32_bf16 v[64:67], a[20:23], v[84:87], v[64:67]
ds_read_b128 v[84:87], v13 offset:17408
s_waitcnt vmcnt(14)
s_barrier
s_add_u32 m0, s83, 0x0
v_readlane_b32 s66, v139, 8
s_nop 0
v_mul_f32 v225, v228, v216
v_fmac_f32 v225, v229, v217
ds_read_b64_tr_b16 a[24:25], v158 offset:24576
s_nop 0
buffer_load_dwordx4 v138, s[84:87], s66 offen offset:0 lds
buffer_load_dwordx4 v138, s[84:87], s66 offen offset:1024 lds
buffer_load_dwordx4 v138, s[84:87], s66 offen offset:2048 lds
s_add_u32 m0, s83, 0x3000
v_readlane_b32 s63, v139, 9
ds_read_b64_tr_b16 a[26:27], v159 offset:25088
v_fmac_f32 v225, v230, v218
ds_read_b64_tr_b16 a[28:29], v158 offset:25600
v_fmac_f32 v225, v231, v219
s_nop 0
buffer_load_dwordx4 v138, s[84:87], s63 offen offset:0 lds
ds_write_b64 v222, v[224:225] offset:2048
ds_read_b64_tr_b16 a[30:31], v159 offset:26112
ds_read_b64_tr_b16 a[32:33], v158 offset:26624
ds_read_b64_tr_b16 a[34:35], v159 offset:27136
ds_read_b64_tr_b16 a[36:37], v158 offset:36864
buffer_load_dwordx4 v138, s[84:87], s63 offen offset:1024 lds
ds_read_b64_tr_b16 a[38:39], v159 offset:37376
ds_read_b64_tr_b16 a[40:41], v158 offset:37888
ds_read_b64_tr_b16 a[42:43], v159 offset:38400
s_waitcnt lgkmcnt(9)
v_mfma_f32_16x16x32_bf16 v[244:247], a[24:27], v[240:243], v[244:247]
ds_read_b64_tr_b16 a[44:45], v158 offset:38912
ds_read_b64_tr_b16 a[46:47], v159 offset:39424
v_mfma_f32_16x16x32_bf16 v[40:43], a[24:27], v[72:75], v[40:43]
buffer_load_dwordx4 v138, s[84:87], s63 offen offset:2048 lds
v_mfma_f32_16x16x32_bf16 v[56:59], a[24:27], v[76:79], v[56:59]
s_waitcnt lgkmcnt(8)
v_mfma_f32_16x16x32_bf16 v[44:47], a[28:31], v[72:75], v[44:47]
v_mfma_f32_16x16x32_bf16 v[248:251], a[28:31], v[240:243], v[248:251]
s_waitcnt lgkmcnt(6)
v_mfma_f32_16x16x32_bf16 v[48:51], a[32:35], v[72:75], v[48:51]
ds_read_b128 v[72:75], v12 offset:2048
buffer_store_dwordx4 v[176:179], v0, s[4:7], s55 offen sc1
s_waitcnt lgkmcnt(5)
v_mfma_f32_16x16x32_bf16 v[244:247], a[36:39], v[240:243], v[244:247]
s_waitcnt lgkmcnt(3)
v_mfma_f32_16x16x32_bf16 v[40:43], a[36:39], v[80:83], v[40:43]
v_mfma_f32_16x16x32_bf16 v[44:47], a[40:43], v[80:83], v[44:47]
s_waitcnt lgkmcnt(1)
v_mfma_f32_16x16x32_bf16 v[48:51], a[44:47], v[80:83], v[48:51]
ds_read_b128 v[80:83], v13 offset:2048
v_mfma_f32_16x16x32_bf16 v[248:251], a[40:43], v[240:243], v[248:251]
v_mfma_f32_16x16x32_bf16 v[60:63], a[28:31], v[76:79], v[60:63]
s_waitcnt vmcnt(14)
s_barrier
v_readlane_b32 s78, v139, 10
s_add_u32 m0, s83, 0x6000
v_cmp_ne_u32_e64 vcc, 0, v126
s_cmp_eq_u64 vcc, -1
s_cbranch_scc0 NC
NCR:
v_or_b32 v103, s75, v126
v_mfma_f32_16x16x32_bf16 v[64:67], a[32:35], v[76:79], v[64:67]
buffer_load_dwordx4 v138, s[84:87], s78 offen offset:0 lds
buffer_load_dwordx4 v138, s[84:87], s78 offen offset:1024 lds
ds_read_b64_tr_b16 a[48:49], v160 offset:0
ds_read_b64_tr_b16 a[50:51], v161 offset:512
ds_read_b64_tr_b16 a[52:53], v160 offset:1024
ds_read_b64_tr_b16 a[54:55], v161 offset:1536
ds_read_b64_tr_b16 a[56:57], v160 offset:2048
buffer_load_dwordx4 v138, s[84:87], s78 offen offset:2048 lds
s_add_u32 m0, s83, 0x9000
ds_read_b64_tr_b16 a[58:59], v161 offset:2560
ds_read_b64_tr_b16 a[60:61], v160 offset:12288
ds_read_b64_tr_b16 a[62:63], v161 offset:12800
ds_read_b64_tr_b16 a[64:65], v160 offset:13312
ds_read_b64_tr_b16 a[66:67], v161 offset:13824
ds_read_b64_tr_b16 a[68:69], v160 offset:14336
ds_read_b64_tr_b16 a[70:71], v161 offset:14848
s_waitcnt lgkmcnt(10)
v_readlane_b32 s79, v139, 11
v_mfma_f32_16x16x32_bf16 v[56:59], a[36:39], v[84:87], v[56:59]
buffer_store_dword v103, v2, s[4:7], s61 offen offset:128
ds_read_b128 v[76:79], v12 offset:18432
v_mfma_f32_16x16x32_bf16 v[60:63], a[40:43], v[84:87], v[60:63]
ds_read2st64_b64 v[52:55], v223 offset0:0 offset1:1
ds_read2st64_b64 v[68:71], v223 offset0:4 offset1:5
v_mfma_f32_16x16x32_bf16 v[244:247], a[48:51], v[240:243], v[244:247]
buffer_store_dword v103, v102, s[4:7], s61 offen offset:256 sc1
v_mfma_f32_16x16x32_bf16 v[40:43], a[48:51], v[72:75], v[40:43]
s_waitcnt lgkmcnt(11)
v_mfma_f32_16x16x32_bf16 v[44:47], a[52:55], v[72:75], v[44:47]
v_mfma_f32_16x16x32_bf16 v[248:251], a[52:55], v[240:243], v[248:251]
s_waitcnt lgkmcnt(9)
v_mfma_f32_16x16x32_bf16 v[48:51], a[56:59], v[72:75], v[48:51]
ds_read_b128 v[72:75], v12 offset:3072
v_mfma_f32_16x16x32_bf16 v[64:67], a[44:47], v[84:87], v[64:67]
s_waitcnt lgkmcnt(8)
ds_read_b128 v[84:87], v13 offset:18432
v_mfma_f32_16x16x32_bf16 v[244:247], a[60:63], v[240:243], v[244:247]
v_mfma_f32_16x16x32_bf16 v[40:43], a[60:63], v[80:83], v[40:43]
s_waitcnt lgkmcnt(7)
v_mfma_f32_16x16x32_bf16 v[44:47], a[64:67], v[80:83], v[44:47]
v_mfma_f32_16x16x32_bf16 v[248:251], a[64:67], v[240:243], v[248:251]
s_waitcnt lgkmcnt(5)
v_mfma_f32_16x16x32_bf16 v[48:51], a[68:71], v[80:83], v[48:51]
s_waitcnt lgkmcnt(4)
ds_read_b128 v[80:83], v13 offset:3072
s_waitcnt lgkmcnt(4)
v_mfma_f32_16x16x32_bf16 v[252:255], a[32:35], v[240:243], v[252:255]
v_add_f32 v52, v52, v54
v_add_f32 v53, v53, v55
v_mfma_f32_16x16x32_bf16 v[252:255], a[44:47], v[240:243], v[252:255]
s_waitcnt lgkmcnt(3)
v_add_f32 v69, v69, v71
v_add_f32 v68, v68, v70
v_mfma_f32_16x16x32_bf16 v[252:255], a[56:59], v[240:243], v[252:255]
v_mfma_f32_16x16x32_bf16 v[56:59], a[48:51], v[76:79], v[56:59]
s_waitcnt vmcnt(13)
s_barrier
v_mfma_f32_16x16x32_bf16 v[60:63], a[52:55], v[76:79], v[60:63]
s_waitcnt lgkmcnt(1)
v_mfma_f32_16x16x32_bf16 v[64:67], a[56:59], v[76:79], v[64:67]
ds_read_b128 v[76:79], v12 offset:19456
ds_read_b64_tr_b16 a[72:73], v160 offset:24576
ds_read_b64_tr_b16 a[74:75], v161 offset:25088
ds_read_b64_tr_b16 a[76:77], v160 offset:25600
ds_read_b64_tr_b16 a[78:79], v161 offset:26112
ds_read_b64_tr_b16 a[80:81], v160 offset:26624
ds_read_b64_tr_b16 a[82:83], v161 offset:27136
ds_read_b64_tr_b16 a[84:85], v160 offset:36864
ds_read_b64_tr_b16 a[86:87], v161 offset:37376
ds_read_b64_tr_b16 a[88:89], v160 offset:37888
ds_read_b64_tr_b16 a[90:91], v161 offset:38400
buffer_load_dwordx4 v138, s[84:87], s79 offen offset:0 lds
buffer_load_dwordx4 v138, s[84:87], s79 offen offset:1024 lds
buffer_load_dwordx4 v138, s[84:87], s79 offen offset:2048 lds
s_add_u32 m0, s83, 0xc000
v_readlane_b32 s67, v139, 12
v_mfma_f32_16x16x32_bf16 v[252:255], a[68:71], v[240:243], v[252:255]
ds_read_b64_tr_b16 a[92:93], v160 offset:38912
ds_read_b64_tr_b16 a[94:95], v161 offset:39424
buffer_store_dwordx4 v[180:183], v188, s[4:7], s37 offen sc1
s_add_u32 s65, s29, 0x80e000
s_add_u32 s62, s73, 0x9fe000
s_add_u32 s64, s35, 0x520c00
s_add_u32 s68, s74, 0x53fc00
s_cmp_eq_u32 s27, 0
s_cselect_b32 s54, s65, s62
s_cselect_b32 s55, s64, s68
s_cselect_b32 s37, 4096, 0
s_waitcnt lgkmcnt(10)
v_mfma_f32_16x16x32_bf16 v[244:247], a[72:75], v[240:243], v[244:247]
s_waitcnt lgkmcnt(8)
buffer_load_dwordx4 v138, s[84:87], s67 offen offset:0 lds
s_lshr_b32 s27, s3, 1
s_sub_u32 s27, s25, s27
v_mfma_f32_16x16x32_bf16 v[248:251], a[76:79], v[240:243], v[248:251]
buffer_load_dwordx4 v138, s[84:87], s67 offen offset:1024 lds
s_waitcnt lgkmcnt(6)
s_and_b32 s27, s27, 7
v_mfma_f32_16x16x32_bf16 v[40:43], a[72:75], v[72:75], v[40:43]
buffer_load_dwordx4 v138, s[84:87], s67 offen offset:2048 lds
s_add_u32 m0, s83, 0xf000
s_sub_u32 s27, s27, s25
v_readlane_b32 s69, v139, 13
v_mfma_f32_16x16x32_bf16 v[44:47], a[76:79], v[72:75], v[44:47]
s_waitcnt lgkmcnt(4)
s_lshl_b32 s27, s27, 10
s_add_u32 s27, s27, s29
v_mfma_f32_16x16x32_bf16 v[244:247], a[84:87], v[240:243], v[244:247]
s_add_u32 s37, s37, s35
s_add_u32 s37, s37, 0xa7f000
v_mfma_f32_16x16x32_bf16 v[48:51], a[80:83], v[72:75], v[48:51]
s_waitcnt lgkmcnt(2)
ds_read_b128 v[72:75], v12 offset:4096
v_mfma_f32_16x16x32_bf16 v[248:251], a[88:91], v[240:243], v[248:251]
v_mfma_f32_16x16x32_bf16 v[40:43], a[84:87], v[80:83], v[40:43]
s_waitcnt lgkmcnt(1)
v_mfma_f32_16x16x32_bf16 v[44:47], a[88:91], v[80:83], v[44:47]
v_mfma_f32_16x16x32_bf16 v[48:51], a[92:95], v[80:83], v[48:51]
ds_read_b128 v[80:83], v13 offset:4096
v_mfma_f32_16x16x32_bf16 v[56:59], a[60:63], v[84:87], v[56:59]
v_mfma_f32_16x16x32_bf16 v[60:63], a[64:67], v[84:87], v[60:63]
v_mfma_f32_16x16x32_bf16 v[64:67], a[68:71], v[84:87], v[64:67]
ds_read_b128 v[84:87], v13 offset:19456
v_mfma_f32_16x16x32_bf16 v[252:255], a[80:83], v[240:243], v[252:255]
v_mfma_f32_16x16x32_bf16 v[252:255], a[92:95], v[240:243], v[252:255]
v_mfma_f32_16x16x32_bf16 v[56:59], a[72:75], v[76:79], v[56:59]
v_mfma_f32_16x16x32_bf16 v[60:63], a[76:79], v[76:79], v[60:63]
v_mfma_f32_16x16x32_bf16 v[64:67], a[80:83], v[76:79], v[64:67]
ds_read_b128 v[76:79], v12 offset:20480
s_waitcnt vmcnt(13)
s_barrier
ds_read_b64_tr_b16 a[96:97], v158 offset:0
s_waitcnt lgkmcnt(2)
v_mfma_f32_16x16x32_bf16 v[56:59], a[84:87], v[84:87], v[56:59]
ds_read_b64_tr_b16 a[98:99], v159 offset:512
ds_read_b64_tr_b16 a[100:101], v158 offset:1024
ds_read_b64_tr_b16 a[102:103], v159 offset:1536
ds_read_b64_tr_b16 a[104:105], v158 offset:2048
ds_read_b64_tr_b16 a[106:107], v159 offset:2560
ds_read_b64_tr_b16 a[108:109], v158 offset:12288
ds_read_b64_tr_b16 a[110:111], v159 offset:12800
ds_read_b64_tr_b16 a[112:113], v158 offset:13312
ds_read_b64_tr_b16 a[114:115], v159 offset:13824
buffer_load_dwordx4 v138, s[84:87], s69 offen offset:0 lds
buffer_load_dwordx4 v138, s[84:87], s69 offen offset:1024 lds
buffer_load_dwordx4 v138, s[84:87], s69 offen offset:2048 lds
s_add_u32 m0, s83, 0x12000
v_readlane_b32 s66, v139, 14
v_mfma_f32_16x16x32_bf16 v[60:63], a[88:91], v[84:87], v[60:63]
buffer_store_dwordx4 v[184:187], v188, s[4:7], s34 offen sc1
s_mul_i32 s63, s24, 11264
s_mul_i32 s78, s26, 180224
s_add_u32 s34, s63, s78
s_waitcnt lgkmcnt(8)
buffer_load_dwordx4 v138, s[84:87], s66 offen offset:0 lds
s_waitcnt lgkmcnt(6)
buffer_load_dwordx4 v138, s[84:87], s66 offen offset:1024 lds
ds_read_b64_tr_b16 a[116:117], v158 offset:14336
ds_read_b64_tr_b16 a[118:119], v159 offset:14848
s_waitcnt lgkmcnt(6)
v_mfma_f32_16x16x32_bf16 v[244:247], a[96:99], v[240:243], v[244:247]
buffer_load_dword v99, v3, s[4:7], s61 offen offset:128 sc1
v_mfma_f32_16x16x32_bf16 v[248:251], a[100:103], v[240:243], v[248:251]
s_waitcnt lgkmcnt(4)
v_mfma_f32_16x16x32_bf16 v[244:247], a[108:111], v[240:243], v[244:247]
buffer_load_dwordx4 v138, s[84:87], s66 offen offset:2048 lds
s_add_u32 m0, s83, 0x15000
v_readlane_b32 s79, v139, 15
v_mfma_f32_16x16x32_bf16 v[252:255], a[104:107], v[240:243], v[252:255]
s_waitcnt lgkmcnt(2)
v_mfma_f32_16x16x32_bf16 v[248:251], a[112:115], v[240:243], v[248:251]
v_mfma_f32_16x16x32_bf16 v[40:43], a[96:99], v[72:75], v[40:43]
v_mfma_f32_16x16x32_bf16 v[44:47], a[100:103], v[72:75], v[44:47]
v_mfma_f32_16x16x32_bf16 v[48:51], a[104:107], v[72:75], v[48:51]
s_waitcnt lgkmcnt(0)
ds_read_b128 v[72:75], v12 offset:5120
v_mfma_f32_16x16x32_bf16 v[252:255], a[116:119], v[240:243], v[252:255]
v_mfma_f32_16x16x32_bf16 v[40:43], a[108:111], v[80:83], v[40:43]
v_mfma_f32_16x16x32_bf16 v[44:47], a[112:115], v[80:83], v[44:47]
v_mfma_f32_16x16x32_bf16 v[48:51], a[116:119], v[80:83], v[48:51]
ds_read_b128 v[80:83], v13 offset:5120
v_mfma_f32_16x16x32_bf16 v[64:67], a[92:95], v[84:87], v[64:67]
ds_read_b128 v[84:87], v13 offset:20480
v_mfma_f32_16x16x32_bf16 v[56:59], a[96:99], v[76:79], v[56:59]
v_mfma_f32_16x16x32_bf16 v[60:63], a[100:103], v[76:79], v[60:63]
v_mfma_f32_16x16x32_bf16 v[64:67], a[104:107], v[76:79], v[64:67]
ds_read_b128 v[76:79], v12 offset:21504
s_waitcnt lgkmcnt(1)
v_mfma_f32_16x16x32_bf16 v[56:59], a[108:111], v[84:87], v[56:59]
v_mfma_f32_16x16x32_bf16 v[60:63], a[112:115], v[84:87], v[60:63]
v_mfma_f32_16x16x32_bf16 v[64:67], a[116:119], v[84:87], v[64:67]
ds_read_b128 v[84:87], v13 offset:21504
s_waitcnt vmcnt(12)
s_barrier
ds_read_b64_tr_b16 a[120:121], v158 offset:24576
ds_read_b64_tr_b16 a[122:123], v159 offset:25088
ds_read_b64_tr_b16 a[124:125], v158 offset:25600
ds_read_b64_tr_b16 a[126:127], v159 offset:26112
ds_read_b64_tr_b16 a[128:129], v158 offset:26624
ds_read_b64_tr_b16 a[130:131], v159 offset:27136
ds_read_b64_tr_b16 a[132:133], v158 offset:36864
ds_read_b64_tr_b16 a[134:135], v159 offset:37376
ds_read_b64_tr_b16 a[136:137], v158 offset:37888
ds_read_b64_tr_b16 a[138:139], v159 offset:38400
ds_read_b64_tr_b16 a[140:141], v158 offset:38912
buffer_load_dwordx4 v138, s[84:87], s79 offen offset:0 lds
buffer_load_dwordx4 v138, s[84:87], s79 offen offset:1024 lds
buffer_load_dwordx4 v138, s[84:87], s79 offen offset:2048 lds
s_add_u32 s64, s0, 0x8000
s_add_u32 m0, s38, 0x20000
ds_read_b64_tr_b16 a[142:143], v159 offset:39424
buffer_load_dwordx4 v100, s[8:11], s64 offen lds
s_waitcnt lgkmcnt(10)
s_add_u32 s62, s1, 0x8000
v_mfma_f32_16x16x32_bf16 v[244:247], a[120:123], v[240:243], v[244:247]
s_add_u32 m0, s38, 0x20400
s_nop 0
buffer_load_dwordx4 v100, s[8:11], s62 offen lds
s_add_u32 s65, s28, 0x8000
s_add_u32 m0, s38, 0x20800
v_mfma_f32_16x16x32_bf16 v[40:43], a[120:123], v[72:75], v[40:43]
s_waitcnt lgkmcnt(8)
buffer_load_dwordx4 v100, s[8:11], s65 offen lds
s_add_u32 s68, s70, 0x8000
s_add_u32 m0, s38, 0x20c00
v_mfma_f32_16x16x32_bf16 v[248:251], a[124:127], v[240:243], v[248:251]
buffer_load_dwordx4 v100, s[8:11], s68 offen lds
v_mfma_f32_16x16x32_bf16 v[44:47], a[124:127], v[72:75], v[44:47]
s_waitcnt lgkmcnt(6)
v_mfma_f32_16x16x32_bf16 v[252:255], a[128:131], v[240:243], v[252:255]
v_mfma_f32_16x16x32_bf16 v[48:51], a[128:131], v[72:75], v[48:51]
s_waitcnt lgkmcnt(4)
ds_read_b128 v[72:75], v12 offset:6144
v_mfma_f32_16x16x32_bf16 v[244:247], a[132:135], v[240:243], v[244:247]
v_mfma_f32_16x16x32_bf16 v[40:43], a[132:135], v[80:83], v[40:43]
s_waitcnt lgkmcnt(3)
v_mfma_f32_16x16x32_bf16 v[248:251], a[136:139], v[240:243], v[248:251]
v_mfma_f32_16x16x32_bf16 v[44:47], a[136:139], v[80:83], v[44:47]
s_waitcnt lgkmcnt(1)
v_mfma_f32_16x16x32_bf16 v[252:255], a[140:143], v[240:243], v[252:255]
v_mfma_f32_16x16x32_bf16 v[48:51], a[140:143], v[80:83], v[48:51]
ds_read_b128 v[80:83], v13 offset:6144
v_mfma_f32_16x16x32_bf16 v[56:59], a[120:123], v[76:79], v[56:59]
v_mfma_f32_16x16x32_bf16 v[60:63], a[124:127], v[76:79], v[60:63]
v_mfma_f32_16x16x32_bf16 v[64:67], a[128:131], v[76:79], v[64:67]
ds_read_b128 v[76:79], v12 offset:22528
v_mfma_f32_16x16x32_bf16 v[56:59], a[132:135], v[84:87], v[56:59]
v_mfma_f32_16x16x32_bf16 v[60:63], a[136:139], v[84:87], v[60:63]
v_mfma_f32_16x16x32_bf16 v[64:67], a[140:143], v[84:87], v[64:67]
ds_read_b128 v[84:87], v13 offset:22528
s_waitcnt vmcnt(11)
s_barrier
s_waitcnt vmcnt(8)
v_cmp_eq_u32_e64 vcc, v103, v99
s_cmp_eq_u64 vcc, -1
s_cbranch_scc0 HS
HSF:
s_mov_b64 vcc, 0
s_mov_b64 s[56:57], -1
HSR:
buffer_store_dword v126, v145, s[4:7], s45 offen sc1
s_mov_b32 s45, 0x3727c5ac
ds_read_b64_tr_b16 a[144:145], v160 offset:0
ds_read_b64_tr_b16 a[146:147], v161 offset:512
ds_read_b64_tr_b16 a[148:149], v160 offset:1024
ds_read_b64_tr_b16 a[150:151], v161 offset:1536
ds_read_b64_tr_b16 a[152:153], v160 offset:2048
ds_read_b64_tr_b16 a[154:155], v161 offset:2560
ds_read_b64_tr_b16 a[156:157], v160 offset:12288
ds_read_b64_tr_b16 a[158:159], v161 offset:12800
ds_read_b64_tr_b16 a[160:161], v160 offset:13312
ds_read_b64_tr_b16 a[162:163], v161 offset:13824
s_waitcnt lgkmcnt(10)
ds_read_b64_tr_b16 a[164:165], v160 offset:14336
ds_read_b64_tr_b16 a[166:167], v161 offset:14848
s_waitcnt lgkmcnt(10)
v_mfma_f32_16x16x32_bf16 v[244:247], a[144:147], v[240:243], v[244:247]
v_mfma_f32_16x16x32_bf16 v[40:43], a[144:147], v[72:75], v[40:43]
s_waitcnt lgkmcnt(8)
v_mfma_f32_16x16x32_bf16 v[248:251], a[148:151], v[240:243], v[248:251]
v_mfma_f32_16x16x32_bf16 v[44:47], a[148:151], v[72:75], v[44:47]
s_waitcnt lgkmcnt(6)
v_mfma_f32_16x16x32_bf16 v[252:255], a[152:155], v[240:243], v[252:255]
v_mfma_f32_16x16x32_bf16 v[48:51], a[152:155], v[72:75], v[48:51]
ds_read_b128 v[72:75], v12 offset:7168
s_waitcnt lgkmcnt(5)
v_mfma_f32_16x16x32_bf16 v[244:247], a[156:159], v[240:243], v[244:247]
v_mfma_f32_16x16x32_bf16 v[40:43], a[156:159], v[80:83], v[40:43]
s_waitcnt lgkmcnt(3)
v_mfma_f32_16x16x32_bf16 v[248:251], a[160:163], v[240:243], v[248:251]
v_mfma_f32_16x16x32_bf16 v[44:47], a[160:163], v[80:83], v[44:47]
s_waitcnt vmcnt(5) lgkmcnt(1)
s_barrier
v_mfma_f32_16x16x32_bf16 v[252:255], a[164:167], v[240:243], v[252:255]
buffer_load_dword v4, v112, s[4:7], 0 offen
s_add_u32 s67, s43, 0x18000
ds_read2st64_b64 v[112:115], v223 offset0:2 offset1:3
s_add_u32 s69, s43, 0x10000
v_mfma_f32_16x16x32_bf16 v[48:51], a[164:167], v[80:83], v[48:51]
ds_read_b64_tr_b16 a[168:169], v160 offset:24576
s_add_u32 s78, s43, 0x8000
ds_read_b64_tr_b16 a[170:171], v161 offset:25088
s_add_u32 s63, s43, 0x0
v_mfma_f32_16x16x32_bf16 v[56:59], a[144:147], v[76:79], v[56:59]
ds_read_b64_tr_b16 a[180:181], v160 offset:36864
ds_read_b64_tr_b16 a[182:183], v161 offset:37376
ds_read_b64_tr_b16 a[172:173], v160 offset:25600
ds_read_b64_tr_b16 a[174:175], v161 offset:26112
ds_read_b64_tr_b16 a[184:185], v160 offset:37888
ds_read_b64_tr_b16 a[186:187], v161 offset:38400
ds_read_b64_tr_b16 a[176:177], v160 offset:26624
ds_read_b64_tr_b16 a[178:179], v161 offset:27136
ds_read_b64_tr_b16 a[188:189], v160 offset:38912
ds_read_b64_tr_b16 a[190:191], v161 offset:39424
s_waitcnt lgkmcnt(10)
v_mfma_f32_16x16x32_bf16 v[60:63], a[148:151], v[76:79], v[60:63]
ds_read_b128 v[80:83], v13 offset:7168
buffer_load_dwordx2 v[10:11], v38, s[8:11], s67 offen
v_add_f32 v112, v112, v114
v_add_f32 v113, v113, v115
v_add_f32 v52, v52, v112
v_add_f32 v53, v53, v113
v_mov_b32 v54, v53
v_mul_f32 v104, v36, v52
v_mfma_f32_16x16x32_bf16 v[64:67], a[152:155], v[76:79], v[64:67]
ds_read_b128 v[76:79], v12 offset:23552
v_permlane32_swap_b32 v53, v54
v_mfma_f32_16x16x32_bf16 v[244:247], a[168:171], v[240:243], v[244:247]
buffer_load_dwordx2 v[8:9], v38, s[8:11], s69 offen
s_waitcnt lgkmcnt(10)
v_add_f32 v53, v53, v54
v_mfma_f32_16x16x32_bf16 v[244:247], a[180:183], v[240:243], v[244:247]
buffer_load_dwordx2 v[6:7], v38, s[8:11], s78 offen
v_mov_b32 v54, v53
v_mfma_f32_16x16x32_bf16 v[40:43], a[168:171], v[72:75], v[40:43]
buffer_load_dwordx2 v[4:5], v38, s[8:11], s63 offen
s_waitcnt lgkmcnt(8)
v_permlane16_swap_b32 v53, v54
v_mfma_f32_16x16x32_bf16 v[248:251], a[172:175], v[240:243], v[248:251]
buffer_store_dwordx4 v[240:243], v0, s[4:7], s100 offen
ds_write_b128 v15, v[244:247] offset:0
s_waitcnt lgkmcnt(7)
s_waitcnt lgkmcnt(5)
v_mfma_f32_16x16x32_bf16 v[248:251], a[184:187], v[240:243], v[248:251]
buffer_load_dwordx2 v[244:245], v198, s[20:23], s47 offen
v_add_f32 v53, v53, v54
v_mfma_f32_16x16x32_bf16 v[252:255], a[176:179], v[240:243], v[252:255]
buffer_load_dwordx2 v[246:247], v198, s[20:23], s47 offen offset:32
s_waitcnt lgkmcnt(3)
v_mul_f32 v108, v36, v53
v_mfma_f32_16x16x32_bf16 v[252:255], a[188:191], v[240:243], v[252:255]
s_waitcnt lgkmcnt(2)
v_fma_f32 v108, -v104, v104, v108
v_max_f32 v108, 0, v108
v_mfma_f32_16x16x32_bf16 v[40:43], a[180:183], v[80:83], v[40:43]
v_add_f32 v108, s45, v108
v_rsq_f32 v108, v108
v_mfma_f32_16x16x32_bf16 v[56:59], a[156:159], v[84:87], v[56:59]
v_mul_f32_e64 v104, -v104, v108
v_mul_f32 v105, s46, v104
v_mul_f32 v109, s46, v108
v_mfma_f32_16x16x32_bf16 v[60:63], a[160:163], v[84:87], v[60:63]
s_waitcnt lgkmcnt(1)
ds_write_b128 v15, v[248:251] offset:64
v_mfma_f32_16x16x32_bf16 v[64:67], a[164:167], v[84:87], v[64:67]
ds_read_b128 v[84:87], v13 offset:23552
buffer_load_dwordx2 v[248:249], v199, s[20:23], s48 offen
v_mfma_f32_16x16x32_bf16 v[48:51], a[176:179], v[72:75], v[48:51]
v_mfma_f32_16x16x32_bf16 v[48:51], a[188:191], v[80:83], v[48:51]
v_mfma_f32_16x16x32_bf16 v[44:47], a[172:175], v[72:75], v[44:47]
v_mfma_f32_16x16x32_bf16 v[44:47], a[184:187], v[80:83], v[44:47]
v_mfma_f32_16x16x32_bf16 v[64:67], a[176:179], v[76:79], v[64:67]
v_mfma_f32_16x16x32_bf16 v[60:63], a[172:175], v[76:79], v[60:63]
ds_write_b128 v15, v[252:255] offset:128
v_mfma_f32_16x16x32_bf16 v[56:59], a[168:171], v[76:79], v[56:59]
s_waitcnt lgkmcnt(1)
v_mfma_f32_16x16x32_bf16 v[64:67], a[188:191], v[84:87], v[64:67]
v_mfma_f32_16x16x32_bf16 v[60:63], a[184:187], v[84:87], v[60:63]
v_mfma_f32_16x16x32_bf16 v[56:59], a[180:183], v[84:87], v[56:59]
ds_read_b128 v[112:115], v15 offset:0
ds_read_b128 v[120:123], v15 offset:128
ds_read_b128 v[116:119], v15 offset:64
s_waitcnt lgkmcnt(2)
v_mul_f32 v112, v105, v112
v_mul_f32 v113, v105, v113
v_mul_f32 v114, v105, v114
v_mul_f32 v115, v105, v115
v_fmac_f32 v112, v40, v109
v_fmac_f32 v113, v41, v109
v_fmac_f32 v114, v42, v109
v_fmac_f32 v115, v43, v109
v_cvt_pk_bf16_f32 v88, v112, v113
v_cvt_pk_bf16_f32 v89, v114, v115
ds_read2st64_b64 v[112:115], v223 offset0:6 offset1:7
s_waitcnt lgkmcnt(2)
v_mul_f32 v120, v104, v120
v_mul_f32 v121, v104, v121
v_mul_f32 v122, v104, v122
v_mul_f32 v123, v104, v123
v_fmac_f32 v120, v48, v108
v_fmac_f32 v121, v49, v108
v_fmac_f32 v122, v50, v108
v_fmac_f32 v123, v51, v108
v_cvt_pk_bf16_f32 v92, v120, v121
v_cvt_pk_bf16_f32 v93, v122, v123
ds_write_b64 v16, v[92:93] offset:0
s_waitcnt lgkmcnt(2)
ds_read_b128 v[120:123], v15 offset:128
v_mul_f32 v116, v104, v116
v_mul_f32 v117, v104, v117
v_mul_f32 v118, v104, v118
v_mul_f32 v119, v104, v119
v_fmac_f32 v116, v44, v108
v_fmac_f32 v117, v45, v108
v_fmac_f32 v118, v46, v108
v_fmac_f32 v119, v47, v108
v_cvt_pk_bf16_f32 v90, v116, v117
v_cvt_pk_bf16_f32 v91, v118, v119
ds_read_b128 v[116:119], v15 offset:64
s_waitcnt lgkmcnt(3)
s_waitcnt vmcnt(10)
s_barrier
s_add_u32 s66, s33, 23552
s_add_u32 s79, s66, 23552
s_add_u32 m0, s38, 0x10000
s_add_u32 s64, s79, 23552
v_add_f32 v113, v113, v115
buffer_load_dwordx4 v212, s[84:87], s33 offen offset:0 lds
s_lshr_b32 s62, s48, 6
s_and_b32 s65, s24, 1
buffer_load_dwordx4 v213, s[84:87], s66 offen offset:1024 lds
s_lshl_b32 s68, s62, 10
s_lshl_b32 s67, s65, 3
buffer_load_dwordx4 v212, s[84:87], s79 offen offset:2048 lds
s_add_u32 s69, s68, s67
s_mul_i32 s78, s26, 180224
buffer_load_dwordx4 v213, s[84:87], s64 offen offset:3072 lds
s_add_u32 s63, s0, 0x0
s_add_u32 m0, s38, 0x18000
ds_read_b64_tr_b16 v[92:93], v17 offset:0
s_add_u32 s33, s69, s78
buffer_load_dwordx4 v100, s[8:11], s63 offen lds
s_add_u32 s66, s1, 0x0
s_add_u32 m0, s38, 0x18400
ds_read_b128 v[72:75], v12 offset:32768
v_add_f32 v69, v69, v113
ds_read_b128 v[76:79], v13 offset:32768
v_mov_b32 v70, v69
ds_read_b128 v[80:83], v12 offset:33792
s_nop 0
v_permlane32_swap_b32 v69, v70
ds_write_b128 v37, a[128:131] offset:0
v_add_f32 v69, v69, v70
ds_read_b128 v[84:87], v13 offset:33792
v_mov_b32 v70, v69
ds_read_b128 v[232:235], v220 offset:32768
buffer_load_dword v39, v146, s[4:7], s82 offen sc1
v_add_f32 v112, v112, v114
v_permlane16_swap_b32 v69, v70
v_add_f32 v68, v68, v112
v_add_f32 v69, v69, v70
v_mul_f32 v104, v36, v68
v_mul_f32 v108, v36, v69
v_fma_f32 v108, -v104, v104, v108
v_max_f32 v108, 0, v108
v_add_f32 v108, s45, v108
v_rsq_f32 v108, v108
s_waitcnt lgkmcnt(5)
v_mfma_f32_16x16x32_bf16 v[40:43], a[0:3], v[72:75], 0
ds_read_b128 v[112:115], v15 offset:0
s_waitcnt lgkmcnt(5)
v_mul_f32_e64 v104, -v104, v108
v_mul_f32 v120, v104, v120
v_mul_f32 v121, v104, v121
v_mul_f32 v122, v104, v122
v_mul_f32 v123, v104, v123
v_fmac_f32 v120, v64, v108
v_fmac_f32 v121, v65, v108
v_fmac_f32 v122, v66, v108
v_fmac_f32 v123, v67, v108
v_cvt_pk_bf16_f32 v98, v120, v121
v_cvt_pk_bf16_f32 v99, v122, v123
v_mul_f32 v116, v104, v116
v_mul_f32 v117, v104, v117
v_mul_f32 v118, v104, v118
v_mul_f32 v119, v104, v119
v_mul_f32 v105, s46, v104
v_fmac_f32 v116, v60, v108
v_fmac_f32 v117, v61, v108
v_fmac_f32 v118, v62, v108
v_fmac_f32 v119, v63, v108
v_mul_f32 v109, s46, v108
v_cvt_pk_bf16_f32 v96, v116, v117
v_cvt_pk_bf16_f32 v97, v118, v119
v_mfma_f32_16x16x16_bf16 v[60:63], v[90:91], v[88:89], v[32:35]
s_waitcnt lgkmcnt(1)
ds_write_b64 v16, v[98:99] offset:512
v_mfma_f32_16x16x32_bf16 v[44:47], a[4:7], v[72:75], 0
s_waitcnt lgkmcnt(1)
v_mul_f32 v112, v105, v112
v_mul_f32 v113, v105, v113
v_mul_f32 v114, v105, v114
v_mul_f32 v115, v105, v115
v_fmac_f32 v112, v56, v109
v_fmac_f32 v113, v57, v109
v_fmac_f32 v114, v58, v109
v_fmac_f32 v115, v59, v109
v_mfma_f32_16x16x16_bf16 v[56:59], v[96:97], v[88:89], 0
ds_read_b128 v[236:239], v221 offset:32768
v_cvt_pk_bf16_f32 v94, v112, v113
v_cvt_pk_bf16_f32 v95, v114, v115
v_mfma_f32_16x16x32_bf16 v[48:51], a[8:11], v[72:75], 0
ds_read_b128 v[72:75], v12 offset:34816
ds_write_b128 v37, a[132:135] offset:1024
s_nop 1
v_cndmask_b32_e64 v56, v60, v56, s[92:93]
v_cndmask_b32_e64 v57, v61, v57, s[94:95]
v_cndmask_b32_e64 v58, v62, v58, s[96:97]
v_cndmask_b32_e64 v59, v63, v59, s[98:99]
v_max3_f32 v112, v56, v57, v58
v_max_f32 v112, v112, v59
v_mov_b32 v113, v112
v_mfma_f32_16x16x32_bf16 v[40:43], a[12:15], v[76:79], v[40:43]
ds_read_b64_tr_b16 v[98:99], v17 offset:512
v_permlane32_swap_b32 v112, v113
v_max_f32 v112, v112, v113
v_mov_b32 v113, v112
v_mfma_f32_16x16x32_bf16 v[44:47], a[16:19], v[76:79], v[44:47]
ds_read_b128 v[120:123], v15 offset:128
v_permlane16_swap_b32 v112, v113
v_max_f32 v112, v112, v113
v_sub_f32 v56, v56, v112
v_sub_f32 v57, v57, v112
v_sub_f32 v58, v58, v112
v_sub_f32 v59, v59, v112
v_exp_f32 v56, v56
v_exp_f32 v57, v57
v_exp_f32 v58, v58
v_exp_f32 v59, v59
v_cvt_pk_bf16_f32 v114, v56, v57
v_cvt_pk_bf16_f32 v115, v58, v59
v_and_b32 v116, v26, v114
v_and_b32 v117, v27, v115
v_mfma_f32_16x16x16_bf16 v[68:71], v[24:25], v[114:115], 0
ds_write_b128 v37, a[136:139] offset:2048
s_waitcnt lgkmcnt(2)
v_mfma_f32_16x16x16_bf16 v[64:67], v[98:99], v[116:117], 0
v_xor_b32 v118, v116, v114
v_xor_b32 v119, v117, v115
v_mfma_f32_16x16x32_bf16 v[48:51], a[20:23], v[76:79], v[48:51]
buffer_load_dwordx4 v100, s[8:11], s66 offen lds
s_add_u32 s62, s28, 0x0
s_add_u32 m0, s38, 0x18800
v_mfma_f32_16x16x16_bf16 v[64:67], v[92:93], v[118:119], v[64:67]
buffer_load_dwordx4 v100, s[8:11], s62 offen lds
s_add_u32 s65, s70, 0x0
s_add_u32 m0, s38, 0x18c00
v_rcp_f32 v68, v68
v_mfma_f32_16x16x32_bf16 v[40:43], a[24:27], v[80:83], v[40:43]
buffer_load_dwordx4 v100, s[8:11], s65 offen lds
s_lshl2_add_u32 s79, s24, s3
s_lshl2_add_u32 s67, s24, s3
v_mul_f32 v64, v64, v68
v_mul_f32 v65, v65, v68
v_mul_f32 v66, v66, v68
v_mul_f32 v67, v67, v68
v_cvt_pk_bf16_f32 v60, v64, v65
v_cvt_pk_bf16_f32 v61, v66, v67
v_mfma_f32_16x16x32_bf16 v[44:47], a[28:31], v[80:83], v[44:47]
s_add_u32 s68, s31, 0xb21000
buffer_store_dwordx2 v[60:61], v0, s[4:7], s68 offen
s_add_u32 s64, s79, 0
s_add_u32 s69, s67, 2
s_and_b32 s78, s64, 14
s_and_b32 s63, s69, 14
s_lshl_b32 s66, s78, 6
s_lshl_b32 s62, s63, 6
s_add_u32 s65, s66, s51
v_mfma_f32_16x16x32_bf16 v[48:51], a[32:35], v[80:83], v[48:51]
ds_read_b128 v[76:79], v13 offset:34816
s_add_u32 m0, s71, 0x1e000
ds_read_b128 v[80:83], v12 offset:35840
v_mfma_f32_16x16x32_bf16 v[40:43], a[36:39], v[84:87], v[40:43]
ds_write_b128 v37, a[140:143] offset:3072
v_mfma_f32_16x16x32_bf16 v[44:47], a[40:43], v[84:87], v[44:47]
buffer_load_dwordx4 v100, s[8:11], s65 offen lds
s_add_u32 s68, s62, s51
s_add_u32 m0, s71, 0x1e400
v_mfma_f32_16x16x32_bf16 v[48:51], a[44:47], v[84:87], v[48:51]
ds_read_b128 v[84:87], v13 offset:35840
buffer_load_dwordx4 v100, s[8:11], s68 offen lds
v_mfma_f32_16x16x32_bf16 v[224:227], v[240:243], v[232:235], 0
ds_read_b128 v[116:119], v15 offset:64
v_mfma_f32_16x16x32_bf16 v[228:231], v[232:235], v[232:235], 0
ds_read_b128 v[232:235], v220 offset:33792
v_mfma_f32_16x16x32_bf16 v[224:227], v[240:243], v[236:239], v[224:227]
v_mfma_f32_16x16x32_bf16 v[228:231], v[236:239], v[236:239], v[228:231]
ds_read_b128 v[236:239], v221 offset:33792
v_mfma_f32_16x16x32_bf16 v[40:43], a[48:51], v[72:75], v[40:43]
ds_write_b128 v37, a[144:147] offset:4096
s_waitcnt lgkmcnt(7)
v_mfma_f32_16x16x32_bf16 v[44:47], a[52:55], v[72:75], v[44:47]
v_mfma_f32_16x16x32_bf16 v[48:51], a[56:59], v[72:75], v[48:51]
ds_read_b128 v[72:75], v12 offset:36864
v_mfma_f32_16x16x32_bf16 v[40:43], a[60:63], v[76:79], v[40:43]
v_mfma_f32_16x16x32_bf16 v[44:47], a[64:67], v[76:79], v[44:47]
s_waitcnt vmcnt(14)
v_lshlrev_b32 v252, 16, v244
v_and_b32 v253, s49, v244
v_mfma_f32_16x16x32_bf16 v[48:51], a[68:71], v[76:79], v[48:51]
s_waitcnt lgkmcnt(5)
ds_read_b128 v[76:79], v13 offset:36864
s_waitcnt lgkmcnt(4)
v_mfma_f32_16x16x32_bf16 v[40:43], a[72:75], v[80:83], v[40:43]
v_lshlrev_b32 v254, 16, v245
v_and_b32 v255, s49, v245
v_mfma_f32_16x16x32_bf16 v[44:47], a[76:79], v[80:83], v[44:47]
ds_write_b128 v37, a[148:151] offset:5120
v_mfma_f32_16x16x32_bf16 v[48:51], a[80:83], v[80:83], v[48:51]
ds_read_b128 v[80:83], v12 offset:37888
v_mul_f32 v252, s44, v252
v_mfma_f32_16x16x32_bf16 v[40:43], a[84:87], v[84:87], v[40:43]
s_waitcnt vmcnt(6)
v_cmp_eq_u32_e64 s[58:59], v126, v39
v_mul_f32 v253, s44, v253
v_mfma_f32_16x16x32_bf16 v[44:47], a[88:91], v[84:87], v[44:47]
s_waitcnt lgkmcnt(3)
ds_read_b64_tr_b16 a[240:241], v208 offset:0
ds_read_b64_tr_b16 a[242:243], v210 offset:512
ds_read_b64_tr_b16 a[244:245], v209 offset:0
ds_read_b64_tr_b16 a[246:247], v211 offset:512
s_cmp_eq_u64 s[58:59], -1
s_cbranch_scc0 CHK_0
CRET_0:
v_mfma_f32_16x16x32_bf16 v[48:51], a[92:95], v[84:87], v[48:51]
ds_read_b64_tr_b16 a[248:249], v210 offset:0
s_add_u32 s79, s41, 0x1000
ds_read_b64_tr_b16 a[250:251], v208 offset:512
s_add_u32 s67, s41, 0x2000
v_mfma_f32_16x16x32_bf16 v[224:227], v[240:243], v[232:235], v[224:227]
ds_read_b64_tr_b16 a[252:253], v211 offset:0
s_add_u32 s64, s41, 0x4000
ds_read_b64_tr_b16 a[254:255], v209 offset:512
ds_read_b128 v[84:87], v13 offset:37888
v_mfma_f32_16x16x32_bf16 v[228:231], v[232:235], v[232:235], v[228:231]
ds_write_b128 v37, a[152:155] offset:6144
v_mfma_f32_16x16x32_bf16 v[224:227], v[240:243], v[236:239], v[224:227]
s_add_u32 s69, s32, 49152
v_mul_f32 v254, s44, v254
v_mul_f32 v255, s44, v255
v_mfma_f32_16x16x32_bf16 v[228:231], v[236:239], v[236:239], v[228:231]
ds_write_b128 v15, v[252:255] offset:384
s_waitcnt lgkmcnt(9)
s_add_u32 s78, s32, 98304
buffer_store_dwordx4 a[240:243], v214, s[4:7], s32 offen sc1
s_lshl_b32 s63, s47, 4
s_mul_i32 s66, s26, 180224
s_waitcnt lgkmcnt(7)
s_add_u32 s65, s32, 147456
s_add_u32 s32, s63, s66
buffer_store_dwordx4 a[244:247], v214, s[4:7], s69 offen sc1
s_waitcnt lgkmcnt(5)
s_waitcnt lgkmcnt(3)
s_nop 0
v_mfma_f32_16x16x32_bf16 v[40:43], a[96:99], v[72:75], v[40:43]
buffer_store_dwordx4 a[248:251], v214, s[4:7], s78 offen sc1
buffer_store_dwordx4 a[252:255], v214, s[4:7], s65 offen sc1
s_waitcnt vmcnt(6)
s_cbranch_vccnz SIG_1
buffer_store_dword v126, v2, s[4:7], s36 offen offset:384
SRET_1:
v_mfma_f32_16x16x32_bf16 v[44:47], a[100:103], v[72:75], v[44:47]
ds_write_b128 v37, a[156:159] offset:7168
v_mfma_f32_16x16x32_bf16 v[48:51], a[104:107], v[72:75], v[48:51]
ds_read_b128 v[72:75], v12 offset:38912
v_mul_f32 v225, v228, v216
v_mfma_f32_16x16x32_bf16 v[40:43], a[108:111], v[76:79], v[40:43]
buffer_load_dwordx4 a[192:195], v0, s[4:7], s41 offen offset:0
v_mfma_f32_16x16x32_bf16 v[44:47], a[112:115], v[76:79], v[44:47]
buffer_load_dwordx4 a[196:199], v0, s[4:7], s41 offen offset:1024
v_mfma_f32_16x16x32_bf16 v[48:51], a[116:119], v[76:79], v[48:51]
ds_read_b128 v[76:79], v13 offset:38912
s_add_u32 s62, s41, 0x5000
v_fmac_f32 v225, v229, v217
v_mfma_f32_16x16x32_bf16 v[40:43], a[120:123], v[80:83], v[40:43]
buffer_load_dwordx4 a[200:203], v1, s[4:7], s41 offen offset:2048
s_waitcnt lgkmcnt(3)
v_mfma_f32_16x16x32_bf16 v[44:47], a[124:127], v[80:83], v[44:47]
buffer_load_dwordx4 a[204:207], v0, s[4:7], s41 offen offset:3072
v_mfma_f32_16x16x32_bf16 v[48:51], a[128:131], v[80:83], v[48:51]
ds_read_b128 v[80:83], v12 offset:39936
v_fmac_f32 v225, v230, v218
v_fmac_f32 v225, v231, v219
v_mfma_f32_16x16x32_bf16 v[40:43], a[132:135], v[84:87], v[40:43]
ds_write_b64 v222, v[224:225] offset:0
s_waitcnt lgkmcnt(3)
v_mfma_f32_16x16x32_bf16 v[44:47], a[136:139], v[84:87], v[44:47]
ds_write_b128 v37, a[160:163] offset:8192
v_mfma_f32_16x16x32_bf16 v[48:51], a[140:143], v[84:87], v[48:51]
ds_read_b128 v[84:87], v13 offset:39936
v_lshlrev_b32 v252, 16, v246
v_mfma_f32_16x16x32_bf16 v[40:43], a[144:147], v[72:75], v[40:43]
buffer_load_dwordx4 a[208:211], v0, s[4:7], s79 offen offset:0
s_waitcnt lgkmcnt(4)
v_mfma_f32_16x16x32_bf16 v[44:47], a[148:151], v[72:75], v[44:47]
buffer_load_dwordx4 a[212:215], v1, s[4:7], s79 offen offset:1024
v_mfma_f32_16x16x32_bf16 v[48:51], a[152:155], v[72:75], v[48:51]
buffer_load_dwordx4 a[216:219], v0, s[4:7], s79 offen offset:2048
v_mfma_f32_16x16x32_bf16 v[40:43], a[156:159], v[76:79], v[40:43]
v_and_b32 v253, s49, v246
v_lshlrev_b32 v254, 16, v247
v_mfma_f32_16x16x32_bf16 v[44:47], a[160:163], v[76:79], v[44:47]
s_waitcnt lgkmcnt(3)
v_and_b32 v255, s49, v247
v_mul_f32 v252, s44, v252
v_mfma_f32_16x16x32_bf16 v[48:51], a[164:167], v[76:79], v[48:51]
ds_write_b128 v37, a[164:167] offset:9216
v_mfma_f32_16x16x32_bf16 v[40:43], a[168:171], v[80:83], v[40:43]
s_waitcnt lgkmcnt(1)
s_barrier
v_mfma_f32_16x16x32_bf16 v[44:47], a[172:175], v[80:83], v[44:47]
v_mul_f32 v253, s44, v253
v_mul_f32 v254, s44, v254
v_mfma_f32_16x16x32_bf16 v[48:51], a[176:179], v[80:83], v[48:51]
s_add_u32 s68, s41, 0x6000
ds_read_b128 v[72:75], v12 offset:0
ds_read_b128 v[76:79], v13 offset:0
ds_read_b128 v[80:83], v12 offset:1024
ds_read2st64_b64 v[52:55], v223 offset0:0 offset1:1
ds_read2st64_b64 v[112:115], v223 offset0:2 offset1:3
v_mfma_f32_16x16x32_bf16 v[40:43], a[180:183], v[84:87], v[40:43]
ds_read_b128 v[232:235], v220 offset:0
ds_read_b128 v[236:239], v221 offset:0
v_mfma_f32_16x16x32_bf16 v[44:47], a[184:187], v[84:87], v[44:47]
ds_write_b128 v37, a[168:171] offset:10240
v_mfma_f32_16x16x32_bf16 v[48:51], a[188:191], v[84:87], v[48:51]
ds_read_b128 v[84:87], v13 offset:1024
v_mul_f32 v255, s44, v255
ds_write_b128 v15, v[252:255] offset:448
s_waitcnt lgkmcnt(9)
v_mfma_f32_16x16x32_bf16 v[56:59], a[0:3], v[72:75], 0
v_lshlrev_b32 v252, 16, v248
v_and_b32 v253, s49, v248
v_mfma_f32_16x16x32_bf16 v[60:63], a[4:7], v[72:75], 0
s_waitcnt lgkmcnt(8)
v_lshlrev_b32 v254, 16, v249
v_and_b32 v255, s49, v249
v_mfma_f32_16x16x32_bf16 v[64:67], a[8:11], v[72:75], 0
s_waitcnt lgkmcnt(6)
ds_read_b128 v[72:75], v12 offset:2048
v_mfma_f32_16x16x32_bf16 v[56:59], a[12:15], v[76:79], v[56:59]
s_waitcnt lgkmcnt(6)
v_add_f32 v53, v53, v55
v_add_f32 v113, v113, v115
v_mfma_f32_16x16x32_bf16 v[60:63], a[16:19], v[76:79], v[60:63]
s_waitcnt lgkmcnt(5)
v_add_f32 v53, v53, v113
v_add_f32 v52, v52, v54
v_mfma_f32_16x16x32_bf16 v[64:67], a[20:23], v[76:79], v[64:67]
ds_read_b128 v[76:79], v13 offset:2048
buffer_load_dword v23, v3, s[4:7], s36 offen offset:384 sc1
v_mfma_f32_16x16x32_bf16 v[56:59], a[24:27], v[80:83], v[56:59]
ds_write_b128 v37, a[172:175] offset:11264
v_mfma_f32_16x16x32_bf16 v[60:63], a[28:31], v[80:83], v[60:63]
s_waitcnt lgkmcnt(4)
v_mov_b32 v54, v53
v_add_f32 v112, v112, v114
v_mfma_f32_16x16x32_bf16 v[64:67], a[32:35], v[80:83], v[64:67]
ds_read_b128 v[80:83], v12 offset:3072
v_permlane32_swap_b32 v53, v54
v_mfma_f32_16x16x32_bf16 v[56:59], a[36:39], v[84:87], v[56:59]
v_add_f32 v53, v53, v54
v_mov_b32 v54, v53
v_mfma_f32_16x16x32_bf16 v[60:63], a[40:43], v[84:87], v[60:63]
s_waitcnt lgkmcnt(3)
v_permlane16_swap_b32 v53, v54
v_mfma_f32_16x16x32_bf16 v[64:67], a[44:47], v[84:87], v[64:67]
ds_read_b128 v[84:87], v13 offset:3072
v_add_f32 v52, v52, v112
v_mfma_f32_16x16x32_bf16 v[224:227], v[240:243], v[232:235], 0
ds_read_b128 v[112:115], v15 offset:0
v_add_f32 v53, v53, v54
v_mfma_f32_16x16x32_bf16 v[228:231], v[232:235], v[232:235], 0
ds_read_b128 v[232:235], v220 offset:1024
v_mul_f32 v104, v36, v52
v_mul_f32 v108, v36, v53
v_fma_f32 v108, -v104, v104, v108
v_mfma_f32_16x16x32_bf16 v[224:227], v[240:243], v[236:239], v[224:227]
ds_write_b128 v37, a[176:179] offset:12288
v_mfma_f32_16x16x32_bf16 v[228:231], v[236:239], v[236:239], v[228:231]
ds_read_b128 v[236:239], v221 offset:1024
v_max_f32 v108, 0, v108
v_mfma_f32_16x16x32_bf16 v[56:59], a[48:51], v[72:75], v[56:59]
buffer_load_dwordx4 a[0:3], v0, s[4:7], s40 offen offset:0
s_waitcnt lgkmcnt(6)
s_add_u32 s66, s40, 0x1000
v_mfma_f32_16x16x32_bf16 v[60:63], a[52:55], v[72:75], v[60:63]
v_add_f32 v108, s45, v108
v_rsq_f32 v108, v108
v_mfma_f32_16x16x32_bf16 v[64:67], a[56:59], v[72:75], v[64:67]
ds_read_b128 v[72:75], v12 offset:4096
v_mul_f32_e64 v104, -v104, v108
v_mfma_f32_16x16x32_bf16 v[56:59], a[60:63], v[76:79], v[56:59]
s_waitcnt lgkmcnt(3)
v_mul_f32 v120, v104, v120
v_mul_f32 v121, v104, v121
v_mfma_f32_16x16x32_bf16 v[60:63], a[64:67], v[76:79], v[60:63]
buffer_load_dwordx4 a[12:15], v0, s[4:7], s40 offen offset:1024
v_mfma_f32_16x16x32_bf16 v[64:67], a[68:71], v[76:79], v[64:67]
ds_read_b128 v[76:79], v13 offset:4096
v_mul_f32 v122, v104, v122
v_mul_f32 v123, v104, v123
v_mfma_f32_16x16x32_bf16 v[56:59], a[72:75], v[80:83], v[56:59]
ds_write_b128 v37, a[180:183] offset:13312
v_mfma_f32_16x16x32_bf16 v[60:63], a[76:79], v[80:83], v[60:63]
buffer_load_dwordx4 a[24:27], v0, s[4:7], s40 offen offset:2048
v_mfma_f32_16x16x32_bf16 v[64:67], a[80:83], v[80:83], v[64:67]
ds_read_b128 v[80:83], v12 offset:5120
v_fmac_f32 v120, v48, v108
v_fmac_f32 v121, v49, v108
v_fmac_f32 v122, v50, v108
v_fmac_f32 v123, v51, v108
v_cvt_pk_bf16_f32 v92, v120, v121
v_cvt_pk_bf16_f32 v93, v122, v123
v_mfma_f32_16x16x32_bf16 v[56:59], a[84:87], v[84:87], v[56:59]
ds_write_b64 v16, v[92:93] offset:0
s_waitcnt lgkmcnt(4)
v_mfma_f32_16x16x32_bf16 v[60:63], a[88:91], v[84:87], v[60:63]
ds_read_b128 v[120:123], v15 offset:128
v_mul_f32 v116, v104, v116
v_mfma_f32_16x16x32_bf16 v[64:67], a[92:95], v[84:87], v[64:67]
ds_read_b128 v[84:87], v13 offset:5120
v_mul_f32 v117, v104, v117
v_mfma_f32_16x16x32_bf16 v[224:227], v[240:243], v[232:235], v[224:227]
buffer_load_dwordx4 a[36:39], v0, s[4:7], s40 offen offset:3072
v_mfma_f32_16x16x32_bf16 v[228:231], v[232:235], v[232:235], v[228:231]
buffer_load_dwordx4 a[48:51], v0, s[4:7], s66 offen offset:0
v_mfma_f32_16x16x32_bf16 v[224:227], v[240:243], v[236:239], v[224:227]
buffer_load_dwordx4 a[60:63], v0, s[4:7], s66 offen offset:1024
v_mfma_f32_16x16x32_bf16 v[228:231], v[236:239], v[236:239], v[228:231]
buffer_load_dwordx4 a[72:75], v0, s[4:7], s66 offen offset:2048
v_mfma_f32_16x16x32_bf16 v[56:59], a[96:99], v[72:75], v[56:59]
buffer_load_dwordx4 a[84:87], v0, s[4:7], s66 offen offset:3072
s_waitcnt lgkmcnt(4)
s_add_u32 s63, s40, 0x2000
v_mfma_f32_16x16x32_bf16 v[60:63], a[100:103], v[72:75], v[60:63]
ds_read_b64_tr_b16 v[92:93], v17 offset:0
v_mul_f32 v118, v104, v118
v_mfma_f32_16x16x32_bf16 v[64:67], a[104:107], v[72:75], v[64:67]
ds_read_b128 v[72:75], v12 offset:6144
v_mul_f32 v119, v104, v119
v_mul_f32 v105, s46, v104
v_fmac_f32 v116, v44, v108
v_fmac_f32 v117, v45, v108
v_fmac_f32 v118, v46, v108
v_fmac_f32 v119, v47, v108
v_mul_f32 v109, s46, v108
v_mul_f32 v112, v105, v112
v_mul_f32 v113, v105, v113
v_mul_f32 v114, v105, v114
v_mul_f32 v115, v105, v115
v_cvt_pk_bf16_f32 v90, v116, v117
v_cvt_pk_bf16_f32 v91, v118, v119
v_mfma_f32_16x16x32_bf16 v[56:59], a[108:111], v[76:79], v[56:59]
buffer_load_dwordx4 a[96:99], v0, s[4:7], s63 offen offset:0
s_waitcnt lgkmcnt(2)
v_mfma_f32_16x16x32_bf16 v[60:63], a[112:115], v[76:79], v[60:63]
buffer_load_dwordx4 a[108:111], v0, s[4:7], s63 offen offset:1024
v_mfma_f32_16x16x32_bf16 v[64:67], a[116:119], v[76:79], v[64:67]
ds_read_b128 v[76:79], v13 offset:6144
v_fmac_f32 v112, v40, v109
v_fmac_f32 v113, v41, v109
v_fmac_f32 v114, v42, v109
v_fmac_f32 v115, v43, v109
v_mfma_f32_16x16x16_bf16 v[44:47], v[96:97], v[94:95], v[32:35]
ds_write_b128 v37, a[184:187] offset:14336
v_mfma_f32_16x16x16_bf16 v[40:43], v[90:91], v[94:95], 0
s_waitcnt vmcnt(10)
v_cmp_eq_u32_e64 s[76:77], v126, v23
v_mul_f32 v225, v228, v216
v_mfma_f32_16x16x32_bf16 v[56:59], a[120:123], v[80:83], v[56:59]
buffer_load_dwordx4 a[120:123], v0, s[4:7], s63 offen offset:2048
v_mfma_f32_16x16x32_bf16 v[60:63], a[124:127], v[80:83], v[60:63]
buffer_load_dwordx4 a[220:223], v0, s[4:7], s79 offen offset:3072
v_mfma_f32_16x16x32_bf16 v[64:67], a[128:131], v[80:83], v[64:67]
ds_read_b128 v[80:83], v12 offset:7168
s_cmp_eq_u64 s[76:77], s[56:57]
s_cbranch_scc0 CHK_5
CRET_5:
s_add_u32 s69, s72, 0xb21000
buffer_load_dwordx4 v[28:31], v0, s[4:7], s69 offen offset:0 sc1
buffer_load_dwordx4 v[100:103], v0, s[4:7], s69 offen offset:1024 sc1
v_fmac_f32 v225, v229, v217
v_fmac_f32 v225, v230, v218
v_fmac_f32 v225, v231, v219
v_mfma_f32_16x16x32_bf16 v[56:59], a[132:135], v[84:87], v[56:59]
ds_write_b64 v222, v[224:225] offset:2048
s_waitcnt lgkmcnt(3)
v_mfma_f32_16x16x32_bf16 v[60:63], a[136:139], v[84:87], v[60:63]
buffer_load_dwordx4 a[132:135], v0, s[4:7], s63 offen offset:3072
v_mfma_f32_16x16x32_bf16 v[64:67], a[140:143], v[84:87], v[64:67]
ds_read_b128 v[84:87], v13 offset:7168
v_cndmask_b32_e64 v40, v44, v40, s[92:93]
v_cndmask_b32_e64 v41, v45, v41, s[94:95]
v_cndmask_b32_e64 v42, v46, v42, s[96:97]
v_cvt_pk_bf16_f32 v88, v112, v113
v_cndmask_b32_e64 v43, v47, v43, s[98:99]
v_max3_f32 v112, v40, v41, v42
v_max_f32 v112, v112, v43
v_mov_b32 v113, v112
v_cvt_pk_bf16_f32 v89, v114, v115
v_or_b32 v220, 0x2000, v220
v_permlane32_swap_b32 v112, v113
v_max_f32 v112, v112, v113
v_mov_b32 v113, v112
v_or_b32 v221, 0x2000, v221
v_mfma_f32_16x16x32_bf16 v[56:59], a[144:147], v[72:75], v[56:59]
s_add_u32 s78, s40, 0x3000
v_permlane16_swap_b32 v112, v113
v_max_f32 v112, v112, v113
v_sub_f32 v40, v40, v112
v_sub_f32 v41, v41, v112
v_sub_f32 v42, v42, v112
v_sub_f32 v43, v43, v112
v_exp_f32 v40, v40
v_exp_f32 v41, v41
v_exp_f32 v42, v42
v_exp_f32 v43, v43
v_cvt_pk_bf16_f32 v114, v40, v41
v_cvt_pk_bf16_f32 v115, v42, v43
v_and_b32 v116, v26, v114
v_and_b32 v117, v27, v115
v_mfma_f32_16x16x16_bf16 v[52:55], v[24:25], v[114:115], 0
s_waitcnt lgkmcnt(0)
s_barrier
v_mfma_f32_16x16x16_bf16 v[48:51], v[92:93], v[116:117], 0
buffer_load_dwordx4 a[144:147], v0, s[4:7], s78 offen offset:0
v_xor_b32 v118, v116, v114
v_xor_b32 v119, v117, v115
v_mfma_f32_16x16x32_bf16 v[60:63], a[148:151], v[72:75], v[60:63]
ds_read_b128 v[232:235], v220 offset:16384
v_rcp_f32 v52, v52
v_mfma_f32_16x16x16_bf16 v[48:51], v[98:99], v[118:119], v[48:51]
ds_read_b128 v[236:239], v221 offset:16384
ds_read2st64_b64 v[68:71], v223 offset0:4 offset1:5
v_mfma_f32_16x16x32_bf16 v[64:67], a[152:155], v[72:75], v[64:67]
ds_read_b128 v[72:75], v124 offset:16384
ds_read2st64_b64 v[112:115], v223 offset0:6 offset1:7
v_mfma_f32_16x16x32_bf16 v[56:59], a[156:159], v[76:79], v[56:59]
ds_read_b128 v[116:119], v15 offset:64
s_nop 0
v_mul_f32 v48, v48, v52
v_mul_f32 v49, v49, v52
v_mul_f32 v50, v50, v52
v_mul_f32 v51, v51, v52
v_cvt_pk_bf16_f32 v44, v48, v49
v_cvt_pk_bf16_f32 v45, v50, v51
v_mfma_f32_16x16x32_bf16 v[60:63], a[160:163], v[76:79], v[60:63]
s_add_u32 s65, s31, 0xb16000
buffer_store_dwordx2 v[44:45], v0, s[4:7], s65 offen
s_waitcnt lgkmcnt(5)
v_mfma_f32_16x16x32_bf16 v[224:227], v[240:243], v[232:235], 0
buffer_load_dwordx4 a[156:159], v0, s[4:7], s78 offen offset:1024
s_waitcnt lgkmcnt(4)
v_mfma_f32_16x16x32_bf16 v[228:231], v[232:235], v[232:235], 0
ds_read_b128 v[232:235], v220 offset:17408
s_waitcnt lgkmcnt(4)
v_mul_f32 v252, s44, v252
v_mfma_f32_16x16x32_bf16 v[64:67], a[164:167], v[76:79], v[64:67]
ds_read_b128 v[76:79], v125 offset:16384
s_waitcnt lgkmcnt(4)
v_add_f32 v69, v69, v71
v_mfma_f32_16x16x32_bf16 v[224:227], v[240:243], v[236:239], v[224:227]
ds_write_b128 v37, a[188:191] offset:15360
s_cmp_eq_u32 s24, 0
s_cselect_b32 s66, 0, 0x40000000
s_waitcnt lgkmcnt(4)
v_mfma_f32_16x16x32_bf16 v[228:231], v[236:239], v[236:239], v[228:231]
ds_read_b128 v[236:239], v221 offset:17408
v_add_f32 v113, v113, v115
v_mfma_f32_16x16x32_bf16 v[56:59], a[168:171], v[80:83], v[56:59]
buffer_load_dwordx4 a[168:171], v0, s[4:7], s78 offen offset:2048
v_mfma_f32_16x16x32_bf16 v[60:63], a[172:175], v[80:83], v[60:63]
buffer_load_dwordx4 a[224:227], v1, s[4:7], s67 offen offset:0
v_mfma_f32_16x16x32_bf16 v[64:67], a[176:179], v[80:83], v[64:67]
ds_read_b128 v[80:83], v124 offset:17408
v_add_f32 v68, v68, v70
v_mfma_f32_16x16x32_bf16 v[56:59], a[180:183], v[84:87], v[56:59]
s_waitcnt lgkmcnt(4)
v_add_f32 v112, v112, v114
v_add_f32 v69, v69, v113
v_mfma_f32_16x16x32_bf16 v[60:63], a[184:187], v[84:87], v[60:63]
buffer_load_dwordx4 a[180:183], v0, s[4:7], s78 offen offset:3072
v_mfma_f32_16x16x32_bf16 v[64:67], a[188:191], v[84:87], v[64:67]
ds_read_b128 v[84:87], v125 offset:17408
v_add_f32 v68, v68, v112
v_mfma_f32_16x16x32_bf16 v[44:47], a[4:7], v[72:75], 0
ds_read_b128 v[112:115], v15 offset:0
s_waitcnt lgkmcnt(5)
v_mov_b32 v70, v69
v_mfma_f32_16x16x32_bf16 v[48:51], a[8:11], v[72:75], 0
ds_read_b128 v[72:75], v124 offset:18432
s_add_u32 s79, s41, 0x6000
v_permlane32_swap_b32 v69, v70
v_mfma_f32_16x16x32_bf16 v[224:227], v[240:243], v[232:235], v[224:227]
buffer_load_dwordx4 a[228:231], v0, s[4:7], s67 offen offset:1024
s_waitcnt lgkmcnt(4)
v_mfma_f32_16x16x32_bf16 v[228:231], v[232:235], v[232:235], v[228:231]
v_add_f32 v69, v69, v70
v_mov_b32 v70, v69
v_mfma_f32_16x16x32_bf16 v[44:47], a[16:19], v[76:79], v[44:47]
s_nop 0
v_permlane16_swap_b32 v69, v70
v_mfma_f32_16x16x32_bf16 v[48:51], a[20:23], v[76:79], v[48:51]
s_waitcnt lgkmcnt(3)
ds_read_b128 v[76:79], v125 offset:18432
v_mfma_f32_16x16x32_bf16 v[224:227], v[240:243], v[236:239], v[224:227]
buffer_load_dwordx4 a[232:235], v0, s[4:7], s67 offen offset:2048
v_mfma_f32_16x16x32_bf16 v[228:231], v[236:239], v[236:239], v[228:231]
buffer_load_dwordx4 a[236:239], v1, s[4:7], s67 offen offset:3072
v_mfma_f32_16x16x32_bf16 v[44:47], a[28:31], v[80:83], v[44:47]
v_add_f32 v69, v69, v70
v_mul_f32 v104, v36, v68
v_mfma_f32_16x16x32_bf16 v[48:51], a[32:35], v[80:83], v[48:51]
s_waitcnt lgkmcnt(3)
ds_read_b128 v[80:83], v124 offset:19456
v_mfma_f32_16x16x32_bf16 v[44:47], a[40:43], v[84:87], v[44:47]
buffer_load_dwordx4 v[128:131], v0, s[4:7], s64 offen offset:0
s_waitcnt lgkmcnt(2)
v_mfma_f32_16x16x32_bf16 v[48:51], a[44:47], v[84:87], v[48:51]
ds_read_b128 v[84:87], v125 offset:19456
v_mul_f32 v225, v228, v216
v_fmac_f32 v225, v229, v217
v_fmac_f32 v225, v230, v218
v_fmac_f32 v225, v231, v219
v_mfma_f32_16x16x32_bf16 v[44:47], a[52:55], v[72:75], v[44:47]
ds_write_b64 v222, v[224:225] offset:0
s_waitcnt lgkmcnt(3)
v_mfma_f32_16x16x32_bf16 v[48:51], a[56:59], v[72:75], v[48:51]
ds_read_b128 v[72:75], v124 offset:20480
v_mul_f32 v108, v36, v69
v_mfma_f32_16x16x32_bf16 v[44:47], a[64:67], v[76:79], v[44:47]
v_fma_f32 v108, -v104, v104, v108
v_max_f32 v108, 0, v108
v_mfma_f32_16x16x32_bf16 v[48:51], a[68:71], v[76:79], v[48:51]
ds_read_b128 v[76:79], v125 offset:20480
v_add_f32 v108, s45, v108
v_rsq_f32 v108, v108
s_waitcnt lgkmcnt(4)
v_mfma_f32_16x16x32_bf16 v[44:47], a[76:79], v[80:83], v[44:47]
buffer_load_dwordx4 v[132:135], v1, s[4:7], s64 offen offset:1024
v_mfma_f32_16x16x32_bf16 v[48:51], a[80:83], v[80:83], v[48:51]
s_waitcnt lgkmcnt(3)
ds_read_b128 v[80:83], v124 offset:21504
v_mfma_f32_16x16x32_bf16 v[44:47], a[88:91], v[84:87], v[44:47]
v_mul_f32_e64 v104, -v104, v108
v_mul_f32 v120, v104, v120
v_mfma_f32_16x16x32_bf16 v[48:51], a[92:95], v[84:87], v[48:51]
ds_read_b128 v[84:87], v125 offset:21504
s_waitcnt lgkmcnt(4)
s_barrier
v_mul_f32 v121, v104, v121
s_waitcnt lgkmcnt(3)
v_mfma_f32_16x16x32_bf16 v[44:47], a[100:103], v[72:75], v[44:47]
v_mul_f32 v122, v104, v122
v_mul_f32 v123, v104, v123
v_mfma_f32_16x16x32_bf16 v[48:51], a[104:107], v[72:75], v[48:51]
s_waitcnt lgkmcnt(2)
ds_read_b128 v[72:75], v124 offset:22528
v_mfma_f32_16x16x32_bf16 v[44:47], a[112:115], v[76:79], v[44:47]
ds_read2st64_b64 v[52:55], v223 offset0:0 offset1:1
v_fmac_f32 v120, v64, v108
v_mfma_f32_16x16x32_bf16 v[48:51], a[116:119], v[76:79], v[48:51]
ds_read_b128 v[76:79], v125 offset:22528
v_fmac_f32 v121, v65, v108
v_fmac_f32 v122, v66, v108
v_fmac_f32 v123, v67, v108
v_cvt_pk_bf16_f32 v98, v120, v121
s_waitcnt lgkmcnt(4)
v_mfma_f32_16x16x32_bf16 v[44:47], a[124:127], v[80:83], v[44:47]
buffer_load_dwordx4 v[136:139], v0, s[4:7], s64 offen offset:2048
v_mfma_f32_16x16x32_bf16 v[48:51], a[128:131], v[80:83], v[48:51]
s_waitcnt lgkmcnt(3)
ds_read_b128 v[80:83], v124 offset:23552
v_mfma_f32_16x16x32_bf16 v[44:47], a[136:139], v[84:87], v[44:47]
buffer_load_dwordx4 v[140:143], v0, s[4:7], s64 offen offset:3072
v_mfma_f32_16x16x32_bf16 v[48:51], a[140:143], v[84:87], v[48:51]
ds_read_b128 v[84:87], v125 offset:23552
v_cvt_pk_bf16_f32 v99, v122, v123
v_mul_f32 v116, v104, v116
v_mul_f32 v117, v104, v117
s_waitcnt lgkmcnt(4)
v_mfma_f32_16x16x32_bf16 v[48:51], a[152:155], v[72:75], v[48:51]
s_waitcnt lgkmcnt(3)
ds_read_b128 v[120:123], v15 offset:128
v_mfma_f32_16x16x32_bf16 v[44:47], a[148:151], v[72:75], v[44:47]
s_waitcnt lgkmcnt(3)
v_add_f32 v53, v53, v55
v_add_f32 v52, v52, v54
v_mfma_f32_16x16x32_bf16 v[48:51], a[164:167], v[76:79], v[48:51]
ds_write_b64 v16, v[98:99] offset:512
s_add_u32 s63, s41, 0x7000
v_mfma_f32_16x16x32_bf16 v[44:47], a[160:163], v[76:79], v[44:47]
buffer_load_dwordx4 v[144:147], v1, s[4:7], s62 offen offset:0
v_mul_f32 v118, v104, v118
v_mul_f32 v119, v104, v119
s_waitcnt lgkmcnt(3)
v_mfma_f32_16x16x32_bf16 v[48:51], a[176:179], v[80:83], v[48:51]
buffer_load_dwordx4 v[148:151], v0, s[4:7], s62 offen offset:1024
v_mfma_f32_16x16x32_bf16 v[44:47], a[172:175], v[80:83], v[44:47]
s_waitcnt lgkmcnt(2)
v_mul_f32 v105, s46, v104
v_fmac_f32 v116, v60, v108
v_mfma_f32_16x16x32_bf16 v[48:51], a[188:191], v[84:87], v[48:51]
v_fmac_f32 v117, v61, v108
v_fmac_f32 v118, v62, v108
v_mfma_f32_16x16x32_bf16 v[44:47], a[184:187], v[84:87], v[44:47]
buffer_load_dwordx4 v[152:155], v0, s[4:7], s62 offen offset:2048
v_fmac_f32 v119, v63, v108
v_mul_f32 v109, s46, v108
v_mul_f32 v112, v105, v112
v_mul_f32 v113, v105, v113
v_mul_f32 v114, v105, v114
v_mul_f32 v115, v105, v115
v_cvt_pk_bf16_f32 v96, v116, v117
v_cvt_pk_bf16_f32 v97, v118, v119
v_fmac_f32 v112, v56, v109
v_fmac_f32 v113, v57, v109
v_fmac_f32 v114, v58, v109
v_fmac_f32 v115, v59, v109
v_mfma_f32_16x16x16_bf16 v[60:63], v[90:91], v[88:89], v[32:35]
ds_read_b64_tr_b16 v[98:99], v17 offset:512
s_waitcnt vmcnt(14)
s_cbranch_vccnz SIG_2
buffer_store_dword v126, v2, s[4:7], s36 offen offset:256
SRET_2:
buffer_load_dwordx4 v[104:107], v0, s[4:7], s69 offen offset:2048 sc1
v_mfma_f32_16x16x16_bf16 v[56:59], v[96:97], v[88:89], 0
v_cvt_pk_bf16_f32 v94, v112, v113
v_cvt_pk_bf16_f32 v95, v114, v115
v_mul_f32 v253, s44, v253
v_mul_f32 v254, s44, v254
v_mul_f32 v255, s44, v255
ds_write_b128 v15, v[252:255] offset:512
buffer_load_dwordx4 v[108:111], v0, s[4:7], s69 offen offset:3072 sc1
s_nop 0
v_cndmask_b32_e64 v56, v60, v56, s[92:93]
v_cndmask_b32_e64 v57, v61, v57, s[94:95]
v_cndmask_b32_e64 v58, v62, v58, s[96:97]
v_cndmask_b32_e64 v59, v63, v59, s[98:99]
v_max3_f32 v112, v56, v57, v58
v_max_f32 v112, v112, v59
v_mov_b32 v113, v112
v_add_u32 v37, s66, v2
buffer_store_dword v126, v37, s[4:7], s52 offen offset:64 sc1
s_lshl_b32 s52, s25, 12
s_add_u32 s52, s52, 0xac0040
v_permlane32_swap_b32 v112, v113
v_max_f32 v112, v112, v113
v_mov_b32 v113, v112
v_lshlrev_b32 v125, 3, v0
buffer_load_dwordx4 v[156:159], v1, s[4:7], s62 offen offset:3072
v_permlane16_swap_b32 v112, v113
v_max_f32 v112, v112, v113
v_sub_f32 v56, v56, v112
v_sub_f32 v57, v57, v112
v_sub_f32 v58, v58, v112
v_sub_f32 v59, v59, v112
v_exp_f32 v56, v56
v_exp_f32 v57, v57
v_exp_f32 v58, v58
v_exp_f32 v59, v59
v_cvt_pk_bf16_f32 v114, v56, v57
buffer_load_dwordx4 v[160:163], v0, s[4:7], s68 offen offset:0
v_cvt_pk_bf16_f32 v115, v58, v59
v_mfma_f32_16x16x32_bf16 v[56:59], a[0:3], v[28:31], 0
s_add_u32 s65, s41, 0x7000
v_and_b32 v116, v26, v114
v_and_b32 v117, v27, v115
v_mfma_f32_16x16x32_bf16 v[56:59], a[48:51], v[100:103], v[56:59]
s_waitcnt lgkmcnt(0)
v_xor_b32 v118, v116, v114
v_xor_b32 v119, v117, v115
v_mfma_f32_16x16x16_bf16 v[68:71], v[24:25], v[114:115], 0
ds_read2st64_b64 v[112:115], v223 offset0:2 offset1:3
v_min_u32 v125, 1280, v125
v_mfma_f32_16x16x16_bf16 v[64:67], v[98:99], v[116:117], 0
s_lshl2_add_u32 s78, s25, s24
s_mul_i32 s67, s78, 1408
v_add_u32 v125, s67, v125
v_mfma_f32_16x16x16_bf16 v[64:67], v[92:93], v[118:119], v[64:67]
ds_read_b128 v[116:119], v15 offset:64
v_rcp_f32 v68, v68
buffer_load_dwordx4 v[164:167], v0, s[4:7], s79 offen offset:1024
s_nop 4
v_mul_f32 v64, v64, v68
v_mul_f32 v65, v65, v68
v_mul_f32 v66, v66, v68
v_mul_f32 v67, v67, v68
v_mfma_f32_16x16x32_bf16 v[68:71], a[36:39], v[28:31], 0
v_cvt_pk_bf16_f32 v60, v64, v65
v_cvt_pk_bf16_f32 v61, v66, v67
v_mfma_f32_16x16x32_bf16 v[64:67], a[24:27], v[28:31], 0
s_add_u32 s64, s31, 0xb0b000
buffer_store_dwordx2 v[60:61], v0, s[4:7], s64 offen
s_waitcnt lgkmcnt(1)
v_mfma_f32_16x16x32_bf16 v[60:63], a[12:15], v[28:31], 0
v_add_f32 v113, v113, v115
v_add_f32 v53, v53, v113
v_mfma_f32_16x16x32_bf16 v[60:63], a[60:63], v[100:103], v[60:63]
v_mov_b32 v54, v53
v_add_f32 v112, v112, v114
v_mfma_f32_16x16x32_bf16 v[64:67], a[72:75], v[100:103], v[64:67]
v_permlane32_swap_b32 v53, v54
v_mfma_f32_16x16x32_bf16 v[68:71], a[84:87], v[100:103], v[68:71]
buffer_load_dwordx4 v[168:171], v1, s[4:7], s79 offen offset:2048
v_add_f32 v53, v53, v54
v_mov_b32 v54, v53
v_add_f32 v52, v52, v112
v_mul_f32 v88, v36, v52
v_permlane16_swap_b32 v53, v54
v_add_f32 v53, v53, v54
v_mul_f32 v89, v36, v53
v_fma_f32 v89, -v88, v88, v89
v_max_f32 v89, 0, v89
v_add_f32 v89, s45, v89
v_rsq_f32 v89, v89
s_nop 0
v_mul_f32_e64 v88, -v88, v89
buffer_load_dwordx4 v[172:175], v0, s[4:7], s79 offen offset:3072
s_waitcnt lgkmcnt(0)
v_mul_f32 v120, v88, v120
v_mul_f32 v121, v88, v121
buffer_load_dword v127, v3, s[4:7], s36 offen offset:256 sc1
v_mul_f32 v122, v88, v122
v_mul_f32 v123, v88, v123
v_fmac_f32 v120, v48, v89
v_fmac_f32 v121, v49, v89
v_fmac_f32 v122, v50, v89
v_fmac_f32 v123, v51, v89
v_cvt_pk_bf16_f32 v92, v120, v121
v_cvt_pk_bf16_f32 v93, v122, v123
ds_write_b64 v16, v[92:93] offset:0
v_mul_f32 v116, v88, v116
buffer_load_dwordx4 v[176:179], v0, s[4:7], s63 offen offset:0
v_mul_f32 v117, v88, v117
v_mul_f32 v118, v88, v118
v_mul_f32 v119, v88, v119
v_fmac_f32 v116, v44, v89
v_fmac_f32 v117, v45, v89
v_fmac_f32 v118, v46, v89
v_fmac_f32 v119, v47, v89
v_cvt_pk_bf16_f32 v90, v116, v117
v_cvt_pk_bf16_f32 v91, v118, v119
v_mov_b32 v48, s50
v_mov_b32 v49, s50
v_mov_b32 v50, s50
v_mov_b32 v51, s50
v_mfma_f32_16x16x16_bf16 v[44:47], v[96:97], v[94:95], v[32:35]
buffer_load_dwordx4 v[180:183], v1, s[4:7], s65 offen offset:1024
v_mfma_f32_16x16x16_bf16 v[40:43], v[90:91], v[94:95], v[48:51]
ds_read_b64_tr_b16 v[92:93], v17 offset:0
s_nop 6
v_cndmask_b32_e64 v40, v44, v40, s[92:93]
v_cndmask_b32_e64 v41, v45, v41, s[94:95]
v_cndmask_b32_e64 v42, v46, v42, s[96:97]
v_cndmask_b32_e64 v43, v47, v43, s[98:99]
v_max3_f32 v112, v40, v41, v42
v_max_f32 v112, v112, v43
v_mov_b32 v113, v112
s_nop 1
v_permlane32_swap_b32 v112, v113
v_max_f32 v112, v112, v113
v_mov_b32 v113, v112
s_nop 1
v_permlane16_swap_b32 v112, v113
v_max_f32 v112, v112, v113
v_and_b32 v113, s49, v10
v_sub_f32 v40, v40, v112
v_sub_f32 v41, v41, v112
v_sub_f32 v42, v42, v112
v_sub_f32 v43, v43, v112
v_lshlrev_b32 v112, 16, v10
v_exp_f32 v40, v40
v_exp_f32 v41, v41
v_exp_f32 v42, v42
v_exp_f32 v43, v43
v_cvt_pk_bf16_f32 v114, v40, v41
v_cvt_pk_bf16_f32 v115, v42, v43
v_and_b32 v116, v26, v114
v_and_b32 v117, v27, v115
v_mfma_f32_16x16x16_bf16 v[52:55], v[24:25], v[114:115], 0
s_waitcnt lgkmcnt(0)
v_xor_b32 v118, v116, v114
v_lshlrev_b32 v114, 16, v11
v_mfma_f32_16x16x16_bf16 v[48:51], v[92:93], v[116:117], 0
v_xor_b32 v119, v117, v115
v_and_b32 v115, s49, v11
s_nop 0
v_mfma_f32_16x16x16_bf16 v[48:51], v[98:99], v[118:119], v[48:51]
v_rcp_f32 v52, v52
s_nop 6
v_mul_f32 v48, v48, v52
v_mul_f32 v49, v49, v52
v_mul_f32 v50, v50, v52
v_mul_f32 v51, v51, v52
v_cvt_pk_bf16_f32 v44, v48, v49
v_cvt_pk_bf16_f32 v45, v50, v51
s_add_u32 s69, s31, 0xb00000
buffer_store_dwordx2 v[44:45], v0, s[4:7], s69 offen
s_waitcnt vmcnt(12)
v_mfma_f32_16x16x32_bf16 v[56:59], a[96:99], v[104:107], v[56:59]
buffer_load_dwordx4 v[184:187], v0, s[4:7], s65 offen offset:2048
v_mfma_f32_16x16x32_bf16 v[60:63], a[108:111], v[104:107], v[60:63]
v_mfma_f32_16x16x32_bf16 v[64:67], a[120:123], v[104:107], v[64:67]
v_mfma_f32_16x16x32_bf16 v[68:71], a[132:135], v[104:107], v[68:71]
s_waitcnt vmcnt(12)
v_mfma_f32_16x16x32_bf16 v[56:59], a[144:147], v[108:111], v[56:59]
v_mfma_f32_16x16x32_bf16 v[60:63], a[156:159], v[108:111], v[60:63]
v_mfma_f32_16x16x32_bf16 v[64:67], a[168:171], v[108:111], v[64:67]
v_mfma_f32_16x16x32_bf16 v[68:71], a[180:183], v[108:111], v[68:71]
s_nop 4
ds_write_b128 v18, v[56:59] offset:0
ds_write_b128 v19, v[60:63] offset:0
ds_write_b128 v18, v[64:67] offset:128
ds_write_b128 v19, v[68:71] offset:128
s_waitcnt lgkmcnt(0)
s_barrier
ds_read_b128 v[56:59], v20 offset:0
ds_read_b128 v[60:63], v20 offset:4096
ds_read_b128 v[64:67], v20 offset:8192
ds_read_b128 v[68:71], v20 offset:12288
s_waitcnt lgkmcnt(2)
v_add_f32 v56, v56, v60
s_waitcnt vmcnt(7)
s_cbranch_vccnz SIG_3
buffer_store_dword v126, v2, s[4:7], s36 offen offset:128
SRET_3:
v_add_f32 v112, v112, v56
v_add_f32 v57, v57, v61
s_waitcnt lgkmcnt(0)
v_add_f32 v64, v64, v68
v_add_f32 v58, v58, v62
v_add_f32 v59, v59, v63
v_add_f32 v112, v112, v64
v_add_f32 v65, v65, v69
v_add_f32 v113, v113, v57
v_add_f32 v66, v66, v70
v_add_f32 v114, v114, v58
v_add_f32 v67, v67, v71
v_add_f32 v115, v115, v59
v_add_f32 v113, v113, v65
v_add_f32 v114, v114, v66
v_add_f32 v115, v115, v67
v_mul_f32 v117, v112, v112
v_add_f32 v116, v112, v113
v_add_f32 v118, v114, v115
v_fmac_f32 v117, v113, v113
v_add_f32 v116, v116, v118
v_fmac_f32 v117, v114, v114
v_fmac_f32 v117, v115, v115
v_add_f32_dpp v116, v116, v116 row_ror:8 row_mask:0xf bank_mask:0xf
v_cvt_pk_bf16_f32 v10, v112, v113
v_lshlrev_b32 v112, 16, v8
v_and_b32 v113, s49, v8
v_add_f32_dpp v116, v117, v117 row_ror:8 row_mask:0xf bank_mask:0xc
v_cvt_pk_bf16_f32 v11, v114, v115
s_add_u32 s66, s29, 0x80c000
buffer_store_dwordx2 v[10:11], v21, s[4:7], s66 offen
s_waitcnt vmcnt(6)
v_lshlrev_b32 v114, 16, v9
v_and_b32 v115, s49, v9
v_add_f32_dpp v116, v116, v116 row_half_mirror row_mask:0xf bank_mask:0xf
v_cmp_eq_u32_e64 s[58:59], v126, v127
s_nop 0
v_add_f32_dpp v116, v116, v116 quad_perm:[2,3,0,1] row_mask:0xf bank_mask:0xf
s_nop 1
v_add_f32_dpp v116, v116, v116 quad_perm:[1,0,3,2] row_mask:0xf bank_mask:0xf
s_add_u32 s62, s35, 0x520000
buffer_store_dword v116, v22, s[4:7], s62 offen offset:3072
s_waitcnt vmcnt(4)
s_cbranch_vccnz SIG_4
buffer_store_dword v126, v2, s[4:7], s36 offen offset:0
SRET_4:
s_cmp_eq_u64 s[58:59], s[56:57]
s_cbranch_scc0 CHK_7
CRET_7:
s_add_u32 s68, s72, 0xb16000
buffer_load_dwordx4 v[72:75], v0, s[4:7], s68 offen offset:0 sc1
buffer_load_dwordx4 v[76:79], v0, s[4:7], s68 offen offset:1024 sc1
buffer_load_dwordx4 v[80:83], v0, s[4:7], s68 offen offset:2048 sc1
buffer_load_dwordx4 v[84:87], v0, s[4:7], s68 offen offset:3072 sc1
buffer_load_dword v39, v3, s[4:7], s36 offen offset:128 sc1
s_waitcnt vmcnt(6)
s_cbranch_vccnz SIG_6
buffer_store_dword v126, v2, s[4:7], s36 offen offset:896
SRET_6:
s_waitcnt vmcnt(5)
v_mfma_f32_16x16x32_bf16 v[40:43], a[0:3], v[72:75], 0
s_add_u32 s78, s41, 0x7000
s_add_u32 s67, s41, 0x8000
buffer_load_dwordx4 v[188:191], v0, s[4:7], s78 offen offset:3072
v_mfma_f32_16x16x32_bf16 v[44:47], a[12:15], v[72:75], 0
s_waitcnt vmcnt(5)
buffer_load_dwordx4 v[192:195], v1, s[4:7], s67 offen offset:0
v_mfma_f32_16x16x32_bf16 v[48:51], a[24:27], v[72:75], 0
buffer_load_dwordx4 v[196:199], v0, s[4:7], s67 offen offset:1024
v_mfma_f32_16x16x32_bf16 v[52:55], a[36:39], v[72:75], 0
buffer_load_dwordx4 v[200:203], v0, s[4:7], s67 offen offset:2048
v_mfma_f32_16x16x32_bf16 v[40:43], a[48:51], v[76:79], v[40:43]
s_add_u32 s64, s41, 0x3000
buffer_load_dwordx4 a[240:243], v0, s[4:7], s64 offen offset:0
s_waitcnt vmcnt(8)
v_mfma_f32_16x16x32_bf16 v[44:47], a[60:63], v[76:79], v[44:47]
buffer_load_dwordx4 a[244:247], v0, s[4:7], s64 offen offset:1024
v_mfma_f32_16x16x32_bf16 v[48:51], a[72:75], v[76:79], v[48:51]
buffer_load_dwordx4 a[248:251], v1, s[4:7], s64 offen offset:2048
v_mfma_f32_16x16x32_bf16 v[52:55], a[84:87], v[76:79], v[52:55]
buffer_load_dwordx4 a[252:255], v0, s[4:7], s64 offen offset:3072
v_mfma_f32_16x16x32_bf16 v[40:43], a[96:99], v[80:83], v[40:43]
buffer_load_dwordx4 v[204:207], v1, s[4:7], s67 offen offset:3072
s_waitcnt vmcnt(11)
s_add_u32 s79, s41, 0x9000
v_mfma_f32_16x16x32_bf16 v[44:47], a[108:111], v[80:83], v[44:47]
buffer_load_dwordx4 v[208:211], v0, s[4:7], s79 offen offset:0
v_mfma_f32_16x16x32_bf16 v[48:51], a[120:123], v[80:83], v[48:51]
buffer_load_dwordx4 v[212:215], v0, s[4:7], s79 offen offset:1024
v_mfma_f32_16x16x32_bf16 v[52:55], a[132:135], v[80:83], v[52:55]
s_add_u32 s63, s41, 0xa000
v_mfma_f32_16x16x32_bf16 v[40:43], a[144:147], v[84:87], v[40:43]
buffer_load_dword v23, v3, s[4:7], s36 offen offset:0 sc1
v_mfma_f32_16x16x32_bf16 v[44:47], a[156:159], v[84:87], v[44:47]
v_mfma_f32_16x16x32_bf16 v[48:51], a[168:171], v[84:87], v[48:51]
v_mfma_f32_16x16x32_bf16 v[52:55], a[180:183], v[84:87], v[52:55]
s_add_u32 s69, s41, 0xb000
s_nop 2
ds_write_b128 v18, v[40:43] offset:16384
s_nop 0
ds_write_b128 v19, v[44:47] offset:16384
ds_write_b128 v18, v[48:51] offset:16512
ds_write_b128 v19, v[52:55] offset:16512
s_waitcnt vmcnt(13)
v_cmp_eq_u32_e64 s[76:77], v126, v39
buffer_load_dwordx4 v[216:219], v1, s[4:7], s79 offen offset:2048
buffer_load_dwordx4 v[220:223], v0, s[4:7], s79 offen offset:3072
s_cmp_eq_u64 s[76:77], s[56:57]
s_cbranch_scc0 CHK_9
CRET_9:
s_add_u32 s65, s72, 0xb0b000
buffer_load_dword v127, v3, s[4:7], s36 offen offset:896 sc1
s_waitcnt lgkmcnt(0)
s_barrier
buffer_load_dwordx4 v[28:31], v0, s[4:7], s65 offen offset:0 sc1
ds_read_b128 v[40:43], v20 offset:16384
ds_read_b128 v[44:47], v20 offset:20480
ds_read_b128 v[48:51], v20 offset:24576
ds_read_b128 v[52:55], v20 offset:28672
buffer_load_dwordx4 v[100:103], v0, s[4:7], s65 offen offset:1024 sc1
s_waitcnt lgkmcnt(2)
v_add_f32 v40, v40, v44
buffer_load_dwordx4 v[104:107], v0, s[4:7], s65 offen offset:2048 sc1
v_add_f32 v112, v112, v40
v_add_f32 v41, v41, v45
v_add_f32 v42, v42, v46
s_waitcnt lgkmcnt(0)
v_add_f32 v48, v48, v52
v_add_f32 v43, v43, v47
v_add_f32 v112, v112, v48
v_add_f32 v49, v49, v53
v_add_f32 v113, v113, v41
v_add_f32 v50, v50, v54
v_add_f32 v114, v114, v42
v_add_f32 v51, v51, v55
v_add_f32 v115, v115, v43
v_add_f32 v113, v113, v49
v_add_f32 v114, v114, v50
v_add_f32 v115, v115, v51
buffer_load_dwordx4 v[108:111], v0, s[4:7], s65 offen offset:3072 sc1
v_mul_f32 v117, v112, v112
v_add_f32 v116, v112, v113
v_add_f32 v118, v114, v115
v_fmac_f32 v117, v113, v113
v_add_f32 v116, v116, v118
v_fmac_f32 v117, v114, v114
v_fmac_f32 v117, v115, v115
v_add_f32_dpp v116, v116, v116 row_ror:8 row_mask:0xf bank_mask:0xf
v_cvt_pk_bf16_f32 v8, v112, v113
v_lshlrev_b32 v112, 16, v6
v_and_b32 v113, s49, v6
v_add_f32_dpp v116, v117, v117 row_ror:8 row_mask:0xf bank_mask:0xc
v_cvt_pk_bf16_f32 v9, v114, v115
s_add_u32 s66, s29, 0x808000
v_lshlrev_b32 v114, 16, v7
v_and_b32 v115, s49, v7
v_add_f32_dpp v116, v116, v116 row_half_mirror row_mask:0xf bank_mask:0xf
buffer_store_dwordx2 v[8:9], v21, s[4:7], s66 offen
s_nop 0
v_add_f32_dpp v116, v116, v116 quad_perm:[2,3,0,1] row_mask:0xf bank_mask:0xf
v_mov_b32 v52, 0x3f803f80
v_mov_b32 v53, 0x3f803f80
v_add_f32_dpp v116, v116, v116 quad_perm:[1,0,3,2] row_mask:0xf bank_mask:0xf
s_add_u32 s62, s35, 0x520000
buffer_store_dword v116, v22, s[4:7], s62 offen offset:2048
v_mov_b32 v54, 0x3f803f80
v_mov_b32 v55, 0x3f803f80
s_nop 1
v_mfma_f32_16x16x32_bf16 v[88:91], a[192:195], v[52:55], 0
buffer_load_dwordx4 v[224:227], v0, s[4:7], s63 offen offset:0
v_mfma_f32_16x16x32_bf16 v[92:95], a[196:199], v[52:55], 0
v_mfma_f32_16x16x32_bf16 v[96:99], a[200:203], v[52:55], 0
v_mfma_f32_16x16x32_bf16 v[88:91], a[204:207], v[52:55], v[88:91]
v_mfma_f32_16x16x32_bf16 v[92:95], a[208:211], v[52:55], v[92:95]
v_mfma_f32_16x16x32_bf16 v[96:99], a[212:215], v[52:55], v[96:99]
buffer_load_dwordx4 v[228:231], v1, s[4:7], s63 offen offset:1024
v_mfma_f32_16x16x32_bf16 v[88:91], a[216:219], v[52:55], v[88:91]
v_mfma_f32_16x16x32_bf16 v[92:95], a[220:223], v[52:55], v[92:95]
s_add_u32 s68, s42, 0x2000
v_mfma_f32_16x16x32_bf16 v[96:99], a[224:227], v[52:55], v[96:99]
v_mfma_f32_16x16x32_bf16 v[88:91], a[228:231], v[52:55], v[88:91]
v_mfma_f32_16x16x32_bf16 v[92:95], a[232:235], v[52:55], v[92:95]
s_waitcnt vmcnt(18)
buffer_load_dwordx4 v[232:235], v0, s[4:7], s63 offen offset:2048
v_mfma_f32_16x16x32_bf16 v[96:99], a[236:239], v[52:55], v[96:99]
s_waitcnt vmcnt(18)
v_mfma_f32_16x16x32_bf16 v[88:91], a[240:243], v[52:55], v[88:91]
v_mfma_f32_16x16x32_bf16 v[92:95], a[244:247], v[52:55], v[92:95]
v_mfma_f32_16x16x32_bf16 v[92:95], v[128:131], v[52:55], v[92:95]
v_mfma_f32_16x16x32_bf16 v[92:95], v[140:143], v[52:55], v[92:95]
buffer_load_dwordx4 v[236:239], v0, s[4:7], s63 offen offset:3072
v_mfma_f32_16x16x32_bf16 v[92:95], v[152:155], v[52:55], v[92:95]
s_waitcnt vmcnt(18)
v_mfma_f32_16x16x32_bf16 v[96:99], a[248:251], v[52:55], v[96:99]
v_mfma_f32_16x16x32_bf16 v[96:99], v[132:135], v[52:55], v[96:99]
v_mfma_f32_16x16x32_bf16 v[96:99], v[144:147], v[52:55], v[96:99]
v_mfma_f32_16x16x32_bf16 v[96:99], v[156:159], v[52:55], v[96:99]
buffer_load_dwordx4 v[240:243], v1, s[4:7], s69 offen offset:0
v_mfma_f32_16x16x32_bf16 v[92:95], v[164:167], v[52:55], v[92:95]
s_waitcnt vmcnt(18)
v_mfma_f32_16x16x32_bf16 v[88:91], a[252:255], v[52:55], v[88:91]
v_mfma_f32_16x16x32_bf16 v[88:91], v[136:139], v[52:55], v[88:91]
v_mfma_f32_16x16x32_bf16 v[88:91], v[148:151], v[52:55], v[88:91]
v_mfma_f32_16x16x32_bf16 v[88:91], v[160:163], v[52:55], v[88:91]
buffer_load_dwordx4 a[44:47], v0, s[4:7], s68 offen offset:3072
v_mfma_f32_16x16x32_bf16 v[96:99], v[168:171], v[52:55], v[96:99]
v_mfma_f32_16x16x32_bf16 v[88:91], v[172:175], v[52:55], v[88:91]
v_mfma_f32_16x16x32_bf16 v[92:95], v[176:179], v[52:55], v[92:95]
v_mfma_f32_16x16x32_bf16 v[96:99], v[180:183], v[52:55], v[96:99]
v_mfma_f32_16x16x32_bf16 v[88:91], v[184:187], v[52:55], v[88:91]
v_mfma_f32_16x16x32_bf16 v[92:95], v[188:191], v[52:55], v[92:95]
s_add_u32 s78, s42, 0x4000
buffer_load_dwordx4 a[64:67], v0, s[4:7], s78 offen offset:0
v_mfma_f32_16x16x32_bf16 v[96:99], v[192:195], v[52:55], v[96:99]
v_mfma_f32_16x16x32_bf16 v[88:91], v[196:199], v[52:55], v[88:91]
s_waitcnt vmcnt(19)
v_mfma_f32_16x16x32_bf16 v[92:95], v[200:203], v[52:55], v[92:95]
s_waitcnt vmcnt(18)
v_mfma_f32_16x16x32_bf16 v[96:99], v[204:207], v[52:55], v[96:99]
v_mfma_f32_16x16x32_bf16 v[88:91], v[208:211], v[52:55], v[88:91]
s_waitcnt vmcnt(16)
v_cmp_eq_u32_e64 s[58:59], v126, v23
v_mfma_f32_16x16x32_bf16 v[92:95], v[212:215], v[52:55], v[92:95]
s_cmp_eq_u64 s[58:59], s[56:57]
s_cbranch_scc0 CHK_13
CRET_13:
s_waitcnt vmcnt(15)
v_mfma_f32_16x16x32_bf16 v[96:99], v[216:219], v[52:55], v[96:99]
s_waitcnt vmcnt(14)
v_mfma_f32_16x16x32_bf16 v[88:91], v[220:223], v[52:55], v[88:91]
s_waitcnt vmcnt(13)
v_cmp_eq_u32_e64 s[76:77], v126, v127
s_waitcnt vmcnt(12)
v_mfma_f32_16x16x32_bf16 v[56:59], a[0:3], v[28:31], 0
s_add_u32 s64, s41, 0xb000
buffer_load_dwordx4 v[244:247], v0, s[4:7], s64 offen offset:1024
v_mfma_f32_16x16x32_bf16 v[60:63], a[12:15], v[28:31], 0
buffer_load_dwordx4 v[248:251], v0, s[4:7], s64 offen offset:2048
v_mfma_f32_16x16x32_bf16 v[64:67], a[24:27], v[28:31], 0
s_cmp_eq_u64 s[76:77], s[56:57]
s_cbranch_scc0 CHK_11
CRET_11:
v_mfma_f32_16x16x32_bf16 v[68:71], a[36:39], v[28:31], 0
s_waitcnt vmcnt(13)
s_add_u32 s67, s72, 0xb00000
buffer_load_dwordx4 v[28:31], v0, s[4:7], s67 offen offset:0 sc1
s_add_u32 s79, s30, 0x80c000
s_add_u32 m0, s38, 0x20000
v_mfma_f32_16x16x32_bf16 v[56:59], a[48:51], v[100:103], v[56:59]
buffer_load_dwordx4 v[252:255], v1, s[4:7], s64 offen offset:3072
v_mfma_f32_16x16x32_bf16 v[60:63], a[60:63], v[100:103], v[60:63]
buffer_load_dwordx4 v0, s[4:7], s79 offen offset:0 sc1 lds
v_mfma_f32_16x16x32_bf16 v[64:67], a[72:75], v[100:103], v[64:67]
buffer_load_dwordx4 v0, s[4:7], s79 offen offset:1024 sc1 lds
v_mfma_f32_16x16x32_bf16 v[68:71], a[84:87], v[100:103], v[68:71]
s_waitcnt vmcnt(16)
v_mfma_f32_16x16x32_bf16 v[56:59], a[96:99], v[104:107], v[56:59]
s_add_u32 s65, s42, 0x1000
v_mfma_f32_16x16x32_bf16 v[60:63], a[108:111], v[104:107], v[60:63]
v_mfma_f32_16x16x32_bf16 v[64:67], a[120:123], v[104:107], v[64:67]
buffer_load_dwordx4 v[100:103], v0, s[4:7], s67 offen offset:1024 sc1
v_mfma_f32_16x16x32_bf16 v[68:71], a[132:135], v[104:107], v[68:71]
s_waitcnt vmcnt(16)
s_waitcnt vmcnt(14)
s_cbranch_vccnz SIG_8
buffer_store_dword v126, v2, s[4:7], s36 offen offset:768
SRET_8:
v_mfma_f32_16x16x32_bf16 v[56:59], a[144:147], v[108:111], v[56:59]
v_mfma_f32_16x16x32_bf16 v[60:63], a[156:159], v[108:111], v[60:63]
v_mfma_f32_16x16x32_bf16 v[64:67], a[168:171], v[108:111], v[64:67]
s_add_u32 s66, s42, 0x2000
buffer_load_dwordx4 v[104:107], v0, s[4:7], s67 offen offset:2048 sc1
v_mfma_f32_16x16x32_bf16 v[68:71], a[180:183], v[108:111], v[68:71]
s_nop 2
ds_write_b128 v18, v[56:59] offset:0
ds_write_b128 v19, v[60:63] offset:0
ds_write_b128 v18, v[64:67] offset:128
s_nop 1
ds_write_b128 v19, v[68:71] offset:128
s_waitcnt vmcnt(15)
buffer_load_dwordx4 v[108:111], v0, s[4:7], s67 offen offset:3072 sc1
v_mfma_f32_16x16x32_bf16 v[92:95], v[224:227], v[52:55], v[92:95]
buffer_load_dwordx4 v0, s[4:7], s79 offen offset:2048 sc1 lds
s_waitcnt vmcnt(16)
v_mfma_f32_16x16x32_bf16 v[96:99], v[228:231], v[52:55], v[96:99]
s_waitcnt lgkmcnt(0)
s_barrier
buffer_load_dwordx4 v0, s[4:7], s79 offen offset:3072 sc1 lds
ds_read_b128 v[56:59], v20 offset:0
s_waitcnt vmcnt(16)
v_mfma_f32_16x16x32_bf16 v[88:91], v[232:235], v[52:55], v[88:91]
ds_read_b128 v[60:63], v20 offset:4096
ds_read_b128 v[64:67], v20 offset:8192
ds_read_b128 v[68:71], v20 offset:12288
buffer_load_dwordx4 a[4:7], v0, s[4:7], s42 offen offset:1024
s_waitcnt vmcnt(16)
v_mfma_f32_16x16x32_bf16 v[92:95], v[236:239], v[52:55], v[92:95]
s_waitcnt lgkmcnt(2)
v_add_f32 v56, v56, v60
buffer_load_dwordx4 a[8:11], v0, s[4:7], s42 offen offset:2048
v_add_f32 v112, v112, v56
v_add_f32 v57, v57, v61
v_add_f32 v58, v58, v62
s_waitcnt lgkmcnt(0)
v_add_f32 v64, v64, v68
v_add_f32 v59, v59, v63
v_add_f32 v112, v112, v64
v_add_f32 v65, v65, v69
v_add_f32 v113, v113, v57
v_add_f32 v66, v66, v70
v_add_f32 v114, v114, v58
v_add_f32 v67, v67, v71
v_add_f32 v115, v115, v59
v_add_f32 v113, v113, v65
v_add_f32 v114, v114, v66
v_add_f32 v115, v115, v67
v_mul_f32 v117, v112, v112
v_add_f32 v116, v112, v113
v_add_f32 v118, v114, v115
v_fmac_f32 v117, v113, v113
v_add_f32 v116, v116, v118
v_fmac_f32 v117, v114, v114
v_fmac_f32 v117, v115, v115
v_add_f32_dpp v116, v116, v116 row_ror:8 row_mask:0xf bank_mask:0xf
v_cvt_pk_bf16_f32 v6, v112, v113
v_cvt_pk_bf16_f32 v7, v114, v115
v_add_f32_dpp v116, v117, v117 row_ror:8 row_mask:0xf bank_mask:0xc
s_waitcnt vmcnt(16)
v_mfma_f32_16x16x32_bf16 v[96:99], v[240:243], v[52:55], v[96:99]
s_add_u32 s62, s29, 0x804000
buffer_store_dwordx2 v[6:7], v21, s[4:7], s62 offen
v_add_f32_dpp v116, v116, v116 row_half_mirror row_mask:0xf bank_mask:0xf
buffer_load_dword v39, v3, s[4:7], s36 offen offset:768 sc1
s_nop 0
v_add_f32_dpp v116, v116, v116 quad_perm:[2,3,0,1] row_mask:0xf bank_mask:0xf
buffer_load_dwordx4 a[16:19], v0, s[4:7], s65 offen offset:0
s_nop 0
v_add_f32_dpp v116, v116, v116 quad_perm:[1,0,3,2] row_mask:0xf bank_mask:0xf
s_add_u32 s63, s35, 0x520000
buffer_store_dword v116, v22, s[4:7], s63 offen offset:1024
v_lshlrev_b32 v112, 16, v4
buffer_load_dwordx4 a[20:23], v0, s[4:7], s65 offen offset:1024
v_and_b32 v113, s49, v4
buffer_load_dwordx4 a[28:31], v0, s[4:7], s65 offen offset:3072
s_waitcnt vmcnt(19)
v_mfma_f32_16x16x32_bf16 v[88:91], v[244:247], v[52:55], v[88:91]
v_lshlrev_b32 v114, 16, v5
v_and_b32 v115, s49, v5
buffer_load_dwordx4 a[32:35], v0, s[4:7], s66 offen offset:0
s_nop 4
ds_write_b128 v15, v[88:91] offset:192
s_waitcnt vmcnt(19)
v_mfma_f32_16x16x32_bf16 v[92:95], v[248:251], v[52:55], v[92:95]
s_waitcnt vmcnt(18)
v_mfma_f32_16x16x32_bf16 v[56:59], a[0:3], v[28:31], 0
s_add_u32 s69, s42, 0x4000
buffer_load_dwordx4 a[76:79], v0, s[4:7], s69 offen offset:3072
v_mfma_f32_16x16x32_bf16 v[60:63], a[12:15], v[28:31], 0
v_mfma_f32_16x16x32_bf16 v[64:67], a[24:27], v[28:31], 0
v_mfma_f32_16x16x32_bf16 v[68:71], a[36:39], v[28:31], 0
s_nop 0
ds_write_b128 v15, v[92:95] offset:256
s_waitcnt vmcnt(18)
v_mfma_f32_16x16x32_bf16 v[96:99], v[252:255], v[52:55], v[96:99]
s_nop 7
ds_write_b128 v15, v[96:99] offset:320
s_waitcnt vmcnt(15)
v_mfma_f32_16x16x32_bf16 v[56:59], a[48:51], v[100:103], v[56:59]
v_mfma_f32_16x16x32_bf16 v[60:63], a[60:63], v[100:103], v[60:63]
v_mfma_f32_16x16x32_bf16 v[64:67], a[72:75], v[100:103], v[64:67]
v_mfma_f32_16x16x32_bf16 v[68:71], a[84:87], v[100:103], v[68:71]
ds_read_b128 v[100:103], v15 offset:384
s_waitcnt vmcnt(13)
v_mfma_f32_16x16x32_bf16 v[56:59], a[96:99], v[104:107], v[56:59]
s_add_u32 s64, s42, 0x5000
buffer_load_dwordx4 a[80:83], v0, s[4:7], s64 offen offset:0
v_mfma_f32_16x16x32_bf16 v[60:63], a[108:111], v[104:107], v[60:63]
s_add_u32 s67, s42, 0x6000
buffer_load_dwordx4 a[108:111], v0, s[4:7], s67 offen offset:3072
v_mfma_f32_16x16x32_bf16 v[64:67], a[120:123], v[104:107], v[64:67]
s_add_u32 s79, s42, 0x7000
buffer_load_dwordx4 a[120:123], v0, s[4:7], s79 offen offset:2048
v_mfma_f32_16x16x32_bf16 v[68:71], a[132:135], v[104:107], v[68:71]
s_waitcnt vmcnt(15)
s_add_u32 s62, s42, 0x8000
buffer_load_dwordx4 a[132:135], v0, s[4:7], s62 offen offset:1024
v_mfma_f32_16x16x32_bf16 v[56:59], a[144:147], v[108:111], v[56:59]
s_add_u32 s63, s42, 0x9000
buffer_load_dwordx4 a[144:147], v0, s[4:7], s63 offen offset:0
v_mfma_f32_16x16x32_bf16 v[60:63], a[156:159], v[108:111], v[60:63]
buffer_load_dwordx4 a[156:159], v0, s[4:7], s63 offen offset:3072
v_mfma_f32_16x16x32_bf16 v[64:67], a[168:171], v[108:111], v[64:67]
s_add_u32 s65, s42, 0xa000
v_mfma_f32_16x16x32_bf16 v[68:71], a[180:183], v[108:111], v[68:71]
s_nop 0
ds_write_b128 v18, v[56:59] offset:16384
s_nop 1
ds_write_b128 v19, v[60:63] offset:16384
s_waitcnt vmcnt(16)
s_barrier
ds_write_b128 v18, v[64:67] offset:16512
s_add_u32 s66, s35, 0x520000
ds_read_b128 v[72:75], v12 offset:32768
ds_read_b128 v[76:79], v13 offset:32768
ds_read_b128 v[80:83], v12 offset:33792
ds_read_b128 v[84:87], v13 offset:33792
ds_write_b128 v19, v[68:71] offset:16512
buffer_load_dwordx4 v[52:55], v14, s[4:7], s66 offen offset:3072 sc1
buffer_load_dwordx4 a[168:171], v0, s[4:7], s65 offen offset:2048
s_waitcnt lgkmcnt(4)
v_mfma_f32_16x16x32_bf16 v[40:43], a[192:195], v[72:75], 0
buffer_load_dwordx4 a[40:43], v0, s[4:7], s68 offen offset:2048
s_waitcnt lgkmcnt(3)
s_mul_i32 s69, s26, 180224
v_mfma_f32_16x16x32_bf16 v[44:47], a[196:199], v[72:75], 0
s_add_u32 s64, s69, 0xb21000
buffer_load_dword v23, v125, s[4:7], s64 offen
v_mfma_f32_16x16x32_bf16 v[48:51], a[200:203], v[72:75], 0
ds_read_b128 v[72:75], v12 offset:34816
v_mfma_f32_16x16x32_bf16 v[40:43], a[204:207], v[76:79], v[40:43]
s_waitcnt vmcnt(16)
v_cmp_eq_u32_e64 s[58:59], v126, v39
s_waitcnt lgkmcnt(3)
v_mfma_f32_16x16x32_bf16 v[44:47], a[208:211], v[76:79], v[44:47]
s_waitcnt lgkmcnt(1)
s_barrier
v_mfma_f32_16x16x32_bf16 v[48:51], a[212:215], v[76:79], v[48:51]
ds_read_b128 v[76:79], v13 offset:34816
v_mfma_f32_16x16x32_bf16 v[40:43], a[216:219], v[80:83], v[40:43]
ds_read_b128 v[56:59], v20 offset:16384
s_cmp_eq_u64 s[58:59], s[56:57]
s_cbranch_scc0 CHK_12
CRET_12:
v_mfma_f32_16x16x32_bf16 v[44:47], a[220:223], v[80:83], v[44:47]
ds_read_b128 v[60:63], v20 offset:20480
s_add_u32 s67, s30, 0x808000
ds_read_b128 v[64:67], v20 offset:24576
s_add_u32 m0, s38, 0x18000
v_mfma_f32_16x16x32_bf16 v[48:51], a[224:227], v[80:83], v[48:51]
ds_read_b128 v[80:83], v12 offset:35840
ds_read_b128 v[68:71], v20 offset:28672
v_mfma_f32_16x16x32_bf16 v[40:43], a[228:231], v[84:87], v[40:43]
buffer_load_dwordx4 v0, s[4:7], s67 offen offset:0 sc1 lds
s_waitcnt lgkmcnt(6)
s_waitcnt vmcnt(15)
v_mfma_f32_16x16x32_bf16 v[44:47], a[232:235], v[84:87], v[44:47]
s_cbranch_vccnz SIG_10
buffer_store_dword v126, v2, s[4:7], s36 offen offset:640
SRET_10:
v_mfma_f32_16x16x32_bf16 v[48:51], a[236:239], v[84:87], v[48:51]
ds_read_b128 v[84:87], v13 offset:35840
buffer_load_dwordx4 v0, s[4:7], s67 offen offset:1024 sc1 lds
v_mfma_f32_16x16x32_bf16 v[40:43], a[240:243], v[72:75], v[40:43]
buffer_load_dwordx4 v0, s[4:7], s67 offen offset:2048 sc1 lds
s_waitcnt lgkmcnt(6)
v_mfma_f32_16x16x32_bf16 v[44:47], a[244:247], v[72:75], v[44:47]
s_waitcnt lgkmcnt(4)
v_add_f32 v56, v56, v60
v_add_f32 v112, v112, v56
v_mfma_f32_16x16x32_bf16 v[48:51], a[248:251], v[72:75], v[48:51]
ds_read_b128 v[72:75], v12 offset:36864
v_add_f32 v57, v57, v61
v_mfma_f32_16x16x32_bf16 v[40:43], a[252:255], v[76:79], v[40:43]
v_add_f32 v58, v58, v62
v_add_f32 v59, v59, v63
v_mfma_f32_16x16x32_bf16 v[44:47], v[128:131], v[76:79], v[44:47]
s_waitcnt lgkmcnt(2)
v_add_f32 v64, v64, v68
v_add_f32 v112, v112, v64
v_mfma_f32_16x16x32_bf16 v[48:51], v[132:135], v[76:79], v[48:51]
ds_read_b128 v[76:79], v13 offset:36864
s_add_u32 s79, s42, 0x3000
v_add_f32 v65, v65, v69
v_mfma_f32_16x16x32_bf16 v[40:43], v[136:139], v[80:83], v[40:43]
buffer_load_dwordx4 v0, s[4:7], s67 offen offset:3072 sc1 lds
s_waitcnt lgkmcnt(2)
v_mfma_f32_16x16x32_bf16 v[44:47], v[140:143], v[80:83], v[44:47]
v_add_f32 v113, v113, v57
v_add_f32 v66, v66, v70
v_mfma_f32_16x16x32_bf16 v[48:51], v[144:147], v[80:83], v[48:51]
ds_read_b128 v[80:83], v12 offset:37888
v_add_f32 v114, v114, v58
v_mfma_f32_16x16x32_bf16 v[40:43], v[148:151], v[84:87], v[40:43]
v_add_f32 v67, v67, v71
v_add_f32 v115, v115, v59
v_mfma_f32_16x16x32_bf16 v[44:47], v[152:155], v[84:87], v[44:47]
s_waitcnt lgkmcnt(2)
v_add_f32 v113, v113, v65
v_add_f32 v114, v114, v66
v_mfma_f32_16x16x32_bf16 v[48:51], v[156:159], v[84:87], v[48:51]
ds_read_b128 v[84:87], v13 offset:37888
v_add_f32 v115, v115, v67
v_mfma_f32_16x16x32_bf16 v[40:43], v[160:163], v[72:75], v[40:43]
buffer_load_dwordx4 a[52:55], v0, s[4:7], s79 offen offset:1024
v_mfma_f32_16x16x32_bf16 v[44:47], v[164:167], v[72:75], v[44:47]
s_waitcnt lgkmcnt(2)
v_mul_f32 v117, v112, v112
v_add_f32 v116, v112, v113
v_mfma_f32_16x16x32_bf16 v[48:51], v[168:171], v[72:75], v[48:51]
ds_read_b128 v[72:75], v12 offset:38912
v_add_f32 v118, v114, v115
v_mfma_f32_16x16x32_bf16 v[40:43], v[172:175], v[76:79], v[40:43]
v_fmac_f32 v117, v113, v113
v_add_f32 v116, v116, v118
v_mfma_f32_16x16x32_bf16 v[44:47], v[176:179], v[76:79], v[44:47]
s_waitcnt lgkmcnt(2)
v_fmac_f32 v117, v114, v114
v_fmac_f32 v117, v115, v115
v_mfma_f32_16x16x32_bf16 v[48:51], v[180:183], v[76:79], v[48:51]
ds_read_b128 v[76:79], v13 offset:38912
v_add_f32_dpp v116, v116, v116 row_ror:8 row_mask:0xf bank_mask:0xf
v_mfma_f32_16x16x32_bf16 v[40:43], v[184:187], v[80:83], v[40:43]
buffer_load_dwordx4 a[56:59], v0, s[4:7], s79 offen offset:2048
v_mfma_f32_16x16x32_bf16 v[44:47], v[188:191], v[80:83], v[44:47]
s_waitcnt lgkmcnt(2)
v_add_f32_dpp v116, v117, v117 row_ror:8 row_mask:0xf bank_mask:0xc
v_cvt_pk_bf16_f32 v4, v112, v113
v_mfma_f32_16x16x32_bf16 v[48:51], v[192:195], v[80:83], v[48:51]
ds_read_b128 v[80:83], v12 offset:39936
v_add_f32_dpp v116, v116, v116 row_half_mirror row_mask:0xf bank_mask:0xf
v_mfma_f32_16x16x32_bf16 v[40:43], v[196:199], v[84:87], v[40:43]
s_nop 0
v_add_f32_dpp v116, v116, v116 quad_perm:[2,3,0,1] row_mask:0xf bank_mask:0xf
v_cvt_pk_bf16_f32 v5, v114, v115
v_mfma_f32_16x16x32_bf16 v[44:47], v[200:203], v[84:87], v[44:47]
s_waitcnt lgkmcnt(2)
v_add_f32_dpp v116, v116, v116 quad_perm:[1,0,3,2] row_mask:0xf bank_mask:0xf
s_add_u32 s62, s29, 0x800000
v_mfma_f32_16x16x32_bf16 v[48:51], v[204:207], v[84:87], v[48:51]
ds_read_b128 v[84:87], v13 offset:39936
s_add_u32 s63, s35, 0x520000
buffer_store_dwordx2 v[4:5], v21, s[4:7], s62 offen
buffer_store_dword v116, v22, s[4:7], s63 offen offset:0
v_mfma_f32_16x16x32_bf16 v[40:43], v[208:211], v[72:75], v[40:43]
ds_read_b128 v[112:115], v15 offset:448
s_waitcnt lgkmcnt(3)
ds_read_b128 v[116:119], v15 offset:512
v_mfma_f32_16x16x32_bf16 v[44:47], v[212:215], v[72:75], v[44:47]
v_mfma_f32_16x16x32_bf16 v[48:51], v[216:219], v[72:75], v[48:51]
v_mfma_f32_16x16x32_bf16 v[40:43], v[220:223], v[76:79], v[40:43]
v_mfma_f32_16x16x32_bf16 v[44:47], v[224:227], v[76:79], v[44:47]
s_waitcnt lgkmcnt(3)
v_mfma_f32_16x16x32_bf16 v[48:51], v[228:231], v[76:79], v[48:51]
buffer_load_dwordx4 a[68:71], v0, s[4:7], s78 offen offset:1024
v_mfma_f32_16x16x32_bf16 v[40:43], v[232:235], v[80:83], v[40:43]
v_mfma_f32_16x16x32_bf16 v[44:47], v[236:239], v[80:83], v[44:47]
s_waitcnt lgkmcnt(2)
v_mfma_f32_16x16x32_bf16 v[48:51], v[240:243], v[80:83], v[48:51]
v_mfma_f32_16x16x32_bf16 v[40:43], v[244:247], v[84:87], v[40:43]
v_mfma_f32_16x16x32_bf16 v[44:47], v[248:251], v[84:87], v[44:47]
v_mfma_f32_16x16x32_bf16 v[48:51], v[252:255], v[84:87], v[48:51]
buffer_load_dword v127, v3, s[4:7], s36 offen offset:640 sc1
s_waitcnt vmcnt(14)
v_add_f32 v52, v52, v54
v_add_f32 v53, v53, v55
s_nop 0
v_mfma_f32_16x16x4_f32 v[104:107], v36, v52, 0
v_mfma_f32_16x16x4_f32 v[108:111], v36, v53, 0
s_nop 9
v_fma_f32 v108, -v104, v104, v108
v_max_f32 v108, 0, v108
v_add_f32 v108, s45, v108
v_rsq_f32 v108, v108
s_nop 0
v_mul_f32 v108, s44, v108
v_mul_f32_e64 v104, -v104, v108
v_fma_f32 v122, v104, v90, v102
v_fma_f32 v123, v104, v91, v103
v_fma_f32 v120, v104, v88, v100
v_fma_f32 v121, v104, v89, v101
s_waitcnt lgkmcnt(0)
v_fma_f32 v37, v104, v92, v112
v_fma_f32 v124, v104, v93, v113
v_fma_f32 v42, v42, v108, v122
v_fma_f32 v43, v43, v108, v123
v_fma_f32 v40, v40, v108, v120
v_fma_f32 v41, v41, v108, v121
v_fma_f32 v44, v44, v108, v37
v_fma_f32 v45, v45, v108, v124
v_fma_f32 v122, v104, v96, v116
v_fma_f32 v123, v104, v97, v117
v_fma_f32 v120, v104, v94, v114
v_fma_f32 v121, v104, v95, v115
v_fma_f32 v37, v104, v98, v118
v_fma_f32 v124, v104, v99, v119
v_fma_f32 v48, v48, v108, v122
v_fma_f32 v49, v49, v108, v123
v_fma_f32 v46, v46, v108, v120
v_fma_f32 v47, v47, v108, v121
v_fma_f32 v50, v50, v108, v37
v_fma_f32 v51, v51, v108, v124
v_fmaak_f32 v122, v42, v42, 0x409d30fc
v_fmaak_f32 v123, v43, v43, 0x409d30fc
v_fmaak_f32 v120, v40, v40, 0x409d30fc
v_fmaak_f32 v121, v41, v41, 0x409d30fc
v_fmaak_f32 v37, v44, v44, 0x409d30fc
v_fmaak_f32 v124, v45, v45, 0x409d30fc
v_mul_f32 v122, v42, v122
v_mul_f32 v123, v43, v123
v_mul_f32 v120, v40, v120
v_mul_f32 v121, v41, v121
v_mul_f32 v37, v44, v37
v_mul_f32 v124, v45, v124
v_exp_f32_e64 v122, -v122
v_exp_f32_e64 v123, -v123
v_exp_f32_e64 v120, -v120
v_exp_f32_e64 v121, -v121
v_exp_f32_e64 v37, -v37
v_exp_f32_e64 v124, -v124
v_fma_f32 v122, v122, s44, s44
v_fma_f32 v123, v123, s44, s44
v_fma_f32 v120, v120, s44, s44
v_fma_f32 v121, v121, s44, s44
v_fma_f32 v37, v37, s44, s44
v_fma_f32 v124, v124, s44, s44
v_rcp_f32 v122, v122
v_rcp_f32 v123, v123
v_rcp_f32 v120, v120
v_rcp_f32 v121, v121
v_rcp_f32 v37, v37
v_rcp_f32 v124, v124
v_mul_f32 v42, v42, v122
v_mul_f32 v43, v43, v123
v_mul_f32 v40, v40, v120
v_mul_f32 v41, v41, v121
v_mul_f32 v44, v44, v37
v_mul_f32 v45, v45, v124
v_fmaak_f32 v122, v48, v48, 0x409d30fc
v_fmaak_f32 v123, v49, v49, 0x409d30fc
v_fmaak_f32 v120, v46, v46, 0x409d30fc
v_fmaak_f32 v121, v47, v47, 0x409d30fc
v_fmaak_f32 v37, v50, v50, 0x409d30fc
v_fmaak_f32 v124, v51, v51, 0x409d30fc
v_mul_f32 v122, v48, v122
v_mul_f32 v123, v49, v123
v_mul_f32 v120, v46, v120
v_mul_f32 v121, v47, v121
v_mul_f32 v37, v50, v37
v_mul_f32 v124, v51, v124
v_exp_f32_e64 v122, -v122
v_exp_f32_e64 v123, -v123
v_exp_f32_e64 v120, -v120
v_exp_f32_e64 v121, -v121
v_exp_f32_e64 v37, -v37
v_exp_f32_e64 v124, -v124
v_fma_f32 v122, v122, s44, s44
v_fma_f32 v123, v123, s44, s44
v_fma_f32 v120, v120, s44, s44
v_fma_f32 v121, v121, s44, s44
v_fma_f32 v37, v37, s44, s44
v_fma_f32 v124, v124, s44, s44
v_rcp_f32 v122, v122
v_rcp_f32 v123, v123
v_rcp_f32 v120, v120
v_rcp_f32 v121, v121
v_rcp_f32 v37, v37
v_rcp_f32 v124, v124
v_mul_f32 v48, v48, v122
v_mul_f32 v49, v49, v123
v_mul_f32 v46, v46, v120
v_mul_f32 v47, v47, v121
v_mul_f32 v50, v50, v37
v_mul_f32 v51, v51, v124
v_cvt_pk_bf16_f32 v48, v48, v49
v_cvt_pk_bf16_f32 v52, v40, v41
v_cvt_pk_bf16_f32 v53, v42, v43
v_cvt_pk_bf16_f32 v54, v44, v45
v_cvt_pk_bf16_f32 v55, v46, v47
s_add_u32 s66, s32, 0xb21000
buffer_store_dwordx4 v[52:55], v0, s[4:7], s66 offen
v_cvt_pk_bf16_f32 v49, v50, v51
s_add_u32 s65, s33, 0xb21000
buffer_store_dwordx2 v[48:49], v1, s[4:7], s65 offen
s_waitcnt vmcnt(8)
s_barrier
s_waitcnt vmcnt(4)
s_cbranch_vccnz SIG_14
buffer_store_dword v126, v2, s[4:7], s36 offen offset:512
SRET_14:
s_waitcnt vmcnt(3)
s_add_u32 s68, s35, 0x520000
ds_read_b128 v[72:75], v12 offset:0
ds_read_b128 v[76:79], v13 offset:0
ds_read_b128 v[80:83], v12 offset:1024
ds_read_b128 v[84:87], v13 offset:1024
v_cmp_eq_u32_e64 s[76:77], v126, v127
buffer_load_dwordx4 v[68:71], v14, s[4:7], s68 offen offset:2048 sc1
s_cmp_eq_u64 s[76:77], s[56:57]
s_cbranch_scc0 CHK_16
CRET_16:
s_add_u32 s69, s30, 0x804000
s_add_u32 m0, s38, 0x1c000
s_nop 0
buffer_load_dwordx4 v0, s[4:7], s69 offen offset:0 sc1 lds
buffer_load_dwordx4 v0, s[4:7], s69 offen offset:1024 sc1 lds
s_waitcnt lgkmcnt(3)
v_mfma_f32_16x16x32_bf16 v[56:59], a[192:195], v[72:75], 0
buffer_load_dwordx4 v0, s[4:7], s69 offen offset:2048 sc1 lds
s_waitcnt lgkmcnt(2)
s_add_u32 s64, s42, 0x5000
v_mfma_f32_16x16x32_bf16 v[60:63], a[196:199], v[72:75], 0
buffer_load_dwordx4 v0, s[4:7], s69 offen offset:3072 sc1 lds
s_mul_i32 s67, s26, 180224
s_add_u32 s79, s67, 0xb16000
v_mfma_f32_16x16x32_bf16 v[64:67], a[200:203], v[72:75], 0
ds_read_b128 v[72:75], v12 offset:2048
buffer_load_dwordx4 a[88:91], v0, s[4:7], s64 offen offset:2048
v_mfma_f32_16x16x32_bf16 v[56:59], a[204:207], v[76:79], v[56:59]
buffer_load_dword v23, v125, s[4:7], s79 offen
s_waitcnt lgkmcnt(2)
v_mfma_f32_16x16x32_bf16 v[60:63], a[208:211], v[76:79], v[60:63]
s_waitcnt vmcnt(8)
s_cbranch_vccnz SIG_15
buffer_store_dword v126, v2, s[4:7], s36 offen offset:1408
SRET_15:
v_mfma_f32_16x16x32_bf16 v[64:67], a[212:215], v[76:79], v[64:67]
ds_read_b128 v[76:79], v13 offset:2048
v_mfma_f32_16x16x32_bf16 v[56:59], a[216:219], v[80:83], v[56:59]
buffer_load_dwordx4 a[92:95], v0, s[4:7], s64 offen offset:3072
s_waitcnt lgkmcnt(2)
v_mfma_f32_16x16x32_bf16 v[60:63], a[220:223], v[80:83], v[60:63]
v_mfma_f32_16x16x32_bf16 v[64:67], a[224:227], v[80:83], v[64:67]
ds_read_b128 v[80:83], v12 offset:3072
v_mfma_f32_16x16x32_bf16 v[56:59], a[228:231], v[84:87], v[56:59]
v_mfma_f32_16x16x32_bf16 v[60:63], a[232:235], v[84:87], v[60:63]
s_waitcnt lgkmcnt(2)
v_mfma_f32_16x16x32_bf16 v[64:67], a[236:239], v[84:87], v[64:67]
ds_read_b128 v[84:87], v13 offset:3072
v_mfma_f32_16x16x32_bf16 v[56:59], a[240:243], v[72:75], v[56:59]
s_add_u32 s62, s42, 0x6000
buffer_load_dwordx4 a[100:103], v0, s[4:7], s62 offen offset:1024
s_waitcnt lgkmcnt(2)
v_mfma_f32_16x16x32_bf16 v[60:63], a[244:247], v[72:75], v[60:63]
v_mfma_f32_16x16x32_bf16 v[64:67], a[248:251], v[72:75], v[64:67]
ds_read_b128 v[72:75], v12 offset:4096
v_mfma_f32_16x16x32_bf16 v[56:59], a[252:255], v[76:79], v[56:59]
v_mfma_f32_16x16x32_bf16 v[60:63], v[128:131], v[76:79], v[60:63]
s_waitcnt lgkmcnt(2)
v_mfma_f32_16x16x32_bf16 v[64:67], v[132:135], v[76:79], v[64:67]
ds_read_b128 v[76:79], v13 offset:4096
v_mfma_f32_16x16x32_bf16 v[56:59], v[136:139], v[80:83], v[56:59]
buffer_load_dwordx4 a[104:107], v0, s[4:7], s62 offen offset:2048
s_waitcnt lgkmcnt(2)
v_mfma_f32_16x16x32_bf16 v[60:63], v[140:143], v[80:83], v[60:63]
v_mfma_f32_16x16x32_bf16 v[64:67], v[144:147], v[80:83], v[64:67]
ds_read_b128 v[80:83], v12 offset:5120
v_mfma_f32_16x16x32_bf16 v[56:59], v[148:151], v[84:87], v[56:59]
v_mfma_f32_16x16x32_bf16 v[60:63], v[152:155], v[84:87], v[60:63]
s_waitcnt lgkmcnt(2)
v_mfma_f32_16x16x32_bf16 v[64:67], v[156:159], v[84:87], v[64:67]
ds_read_b128 v[84:87], v13 offset:5120
v_mfma_f32_16x16x32_bf16 v[56:59], v[160:163], v[72:75], v[56:59]
s_add_u32 s63, s42, 0x7000
buffer_load_dwordx4 a[112:115], v0, s[4:7], s63 offen offset:0
s_waitcnt lgkmcnt(2)
v_mfma_f32_16x16x32_bf16 v[60:63], v[164:167], v[72:75], v[60:63]
v_mfma_f32_16x16x32_bf16 v[64:67], v[168:171], v[72:75], v[64:67]
ds_read_b128 v[72:75], v12 offset:6144
v_mfma_f32_16x16x32_bf16 v[56:59], v[172:175], v[76:79], v[56:59]
buffer_load_dword v39, v3, s[4:7], s36 offen offset:512 sc1
s_waitcnt lgkmcnt(2)
v_mfma_f32_16x16x32_bf16 v[60:63], v[176:179], v[76:79], v[60:63]
v_mfma_f32_16x16x32_bf16 v[64:67], v[180:183], v[76:79], v[64:67]
ds_read_b128 v[76:79], v13 offset:6144
v_mfma_f32_16x16x32_bf16 v[56:59], v[184:187], v[80:83], v[56:59]
buffer_load_dwordx4 a[116:119], v0, s[4:7], s63 offen offset:1024
s_waitcnt lgkmcnt(2)
v_mfma_f32_16x16x32_bf16 v[60:63], v[188:191], v[80:83], v[60:63]
v_mfma_f32_16x16x32_bf16 v[64:67], v[192:195], v[80:83], v[64:67]
ds_read_b128 v[80:83], v12 offset:7168
v_mfma_f32_16x16x32_bf16 v[56:59], v[196:199], v[84:87], v[56:59]
s_waitcnt vmcnt(13)
v_add_f32 v68, v68, v70
v_add_f32 v69, v69, v71
v_mfma_f32_16x16x32_bf16 v[60:63], v[200:203], v[84:87], v[60:63]
s_waitcnt lgkmcnt(2)
v_mfma_f32_16x16x32_bf16 v[64:67], v[204:207], v[84:87], v[64:67]
ds_read_b128 v[84:87], v13 offset:7168
v_mfma_f32_16x16x32_bf16 v[56:59], v[208:211], v[72:75], v[56:59]
buffer_load_dwordx4 a[124:127], v0, s[4:7], s63 offen offset:3072
v_mfma_f32_16x16x32_bf16 v[60:63], v[212:215], v[72:75], v[60:63]
s_waitcnt lgkmcnt(2)
v_mfma_f32_16x16x32_bf16 v[64:67], v[216:219], v[72:75], v[64:67]
v_mfma_f32_16x16x32_bf16 v[56:59], v[220:223], v[76:79], v[56:59]
v_mfma_f32_16x16x32_bf16 v[60:63], v[224:227], v[76:79], v[60:63]
s_waitcnt lgkmcnt(1)
v_mfma_f32_16x16x32_bf16 v[64:67], v[228:231], v[76:79], v[64:67]
buffer_load_dword v127, v3, s[4:7], s36 offen offset:1408 sc1
v_mfma_f32_16x16x32_bf16 v[56:59], v[232:235], v[80:83], v[56:59]
s_add_u32 s78, s42, 0x8000
buffer_load_dwordx4 a[128:131], v0, s[4:7], s78 offen offset:0
s_waitcnt lgkmcnt(0)
v_mfma_f32_16x16x32_bf16 v[60:63], v[236:239], v[80:83], v[60:63]
v_mfma_f32_16x16x32_bf16 v[64:67], v[240:243], v[80:83], v[64:67]
v_mfma_f32_16x16x32_bf16 v[56:59], v[244:247], v[84:87], v[56:59]
v_mfma_f32_16x16x32_bf16 v[60:63], v[248:251], v[84:87], v[60:63]
v_mfma_f32_16x16x32_bf16 v[64:67], v[252:255], v[84:87], v[64:67]
s_waitcnt vmcnt(12)
s_barrier
v_mfma_f32_16x16x4_f32 v[104:107], v36, v68, 0
s_add_u32 s66, s35, 0x520000
ds_read_b128 v[72:75], v12 offset:16384
ds_read_b128 v[76:79], v13 offset:16384
ds_read_b128 v[80:83], v12 offset:17408
ds_read_b128 v[84:87], v13 offset:17408
v_mfma_f32_16x16x4_f32 v[108:111], v36, v69, 0
buffer_load_dwordx4 v[52:55], v14, s[4:7], s66 offen offset:1024 sc1
s_nop 8
v_fma_f32 v108, -v104, v104, v108
v_max_f32 v108, 0, v108
v_add_f32 v108, s45, v108
v_rsq_f32 v108, v108
s_waitcnt lgkmcnt(3)
v_mfma_f32_16x16x32_bf16 v[40:43], a[192:195], v[72:75], 0
s_add_u32 s65, s42, 0x8000
v_mul_f32 v108, s44, v108
v_mul_f32_e64 v104, -v104, v108
v_mfma_f32_16x16x32_bf16 v[44:47], a[196:199], v[72:75], 0
s_waitcnt lgkmcnt(2)
v_fma_f32 v122, v104, v90, v102
v_fma_f32 v123, v104, v91, v103
v_mfma_f32_16x16x32_bf16 v[48:51], a[200:203], v[72:75], 0
ds_read_b128 v[72:75], v12 offset:18432
s_mul_i32 s68, s26, 180224
v_fma_f32 v120, v104, v88, v100
v_mfma_f32_16x16x32_bf16 v[40:43], a[204:207], v[76:79], v[40:43]
buffer_load_dwordx4 a[136:139], v0, s[4:7], s65 offen offset:2048
s_waitcnt lgkmcnt(2)
s_add_u32 s69, s68, 0xb0b000
v_mfma_f32_16x16x32_bf16 v[44:47], a[208:211], v[76:79], v[44:47]
buffer_load_dwordx4 a[140:143], v0, s[4:7], s65 offen offset:3072
v_mfma_f32_16x16x32_bf16 v[48:51], a[212:215], v[76:79], v[48:51]
ds_read_b128 v[76:79], v13 offset:18432
v_fma_f32 v121, v104, v89, v101
v_mfma_f32_16x16x32_bf16 v[40:43], a[216:219], v[80:83], v[40:43]
buffer_load_dword v23, v125, s[4:7], s69 offen
s_waitcnt lgkmcnt(2)
v_fma_f32 v37, v104, v92, v112
v_mfma_f32_16x16x32_bf16 v[44:47], a[220:223], v[80:83], v[44:47]
v_fma_f32 v124, v104, v93, v113
v_fma_f32 v58, v58, v108, v122
v_mfma_f32_16x16x32_bf16 v[48:51], a[224:227], v[80:83], v[48:51]
ds_read_b128 v[80:83], v12 offset:19456
s_add_u32 s67, s42, 0x9000
v_fma_f32 v59, v59, v108, v123
v_mfma_f32_16x16x32_bf16 v[40:43], a[228:231], v[84:87], v[40:43]
buffer_load_dwordx4 a[148:151], v0, s[4:7], s67 offen offset:1024
v_mfma_f32_16x16x32_bf16 v[44:47], a[232:235], v[84:87], v[44:47]
s_waitcnt lgkmcnt(2)
v_fma_f32 v56, v56, v108, v120
v_fma_f32 v57, v57, v108, v121
v_mfma_f32_16x16x32_bf16 v[48:51], a[236:239], v[84:87], v[48:51]
ds_read_b128 v[84:87], v13 offset:19456
v_fma_f32 v60, v60, v108, v37
v_fma_f32 v61, v61, v108, v124
v_fma_f32 v122, v104, v96, v116
v_fma_f32 v123, v104, v97, v117
v_fma_f32 v120, v104, v94, v114
v_fma_f32 v121, v104, v95, v115
v_fma_f32 v37, v104, v98, v118
v_fma_f32 v124, v104, v99, v119
v_fma_f32 v64, v64, v108, v122
v_fma_f32 v65, v65, v108, v123
v_mfma_f32_16x16x32_bf16 v[40:43], a[240:243], v[72:75], v[40:43]
v_fma_f32 v62, v62, v108, v120
v_fma_f32 v63, v63, v108, v121
v_mfma_f32_16x16x32_bf16 v[44:47], a[244:247], v[72:75], v[44:47]
s_waitcnt lgkmcnt(2)
v_fma_f32 v66, v66, v108, v37
v_fma_f32 v67, v67, v108, v124
v_mfma_f32_16x16x32_bf16 v[48:51], a[248:251], v[72:75], v[48:51]
ds_read_b128 v[72:75], v12 offset:20480
v_fmaak_f32 v122, v58, v58, 0x409d30fc
v_fmaak_f32 v123, v59, v59, 0x409d30fc
v_fmaak_f32 v120, v56, v56, 0x409d30fc
v_fmaak_f32 v121, v57, v57, 0x409d30fc
v_fmaak_f32 v37, v60, v60, 0x409d30fc
v_fmaak_f32 v124, v61, v61, 0x409d30fc
v_mul_f32 v122, v58, v122
v_mul_f32 v123, v59, v123
v_mul_f32 v120, v56, v120
v_mul_f32 v121, v57, v121
v_mul_f32 v37, v60, v37
v_mul_f32 v124, v61, v124
v_exp_f32_e64 v122, -v122
v_exp_f32_e64 v123, -v123
v_exp_f32_e64 v120, -v120
v_exp_f32_e64 v121, -v121
v_exp_f32_e64 v37, -v37
v_exp_f32_e64 v124, -v124
v_mfma_f32_16x16x32_bf16 v[40:43], a[252:255], v[76:79], v[40:43]
v_fma_f32 v122, v122, s44, s44
v_fma_f32 v123, v123, s44, s44
v_mfma_f32_16x16x32_bf16 v[44:47], v[128:131], v[76:79], v[44:47]
s_waitcnt lgkmcnt(1)
v_fma_f32 v120, v120, s44, s44
v_fma_f32 v121, v121, s44, s44
v_mfma_f32_16x16x32_bf16 v[48:51], v[132:135], v[76:79], v[48:51]
ds_read_b128 v[76:79], v13 offset:20480
s_add_u32 s79, s42, 0xa000
v_fma_f32 v37, v37, s44, s44
v_fma_f32 v124, v124, s44, s44
v_rcp_f32 v122, v122
v_rcp_f32 v123, v123
v_rcp_f32 v120, v120
v_rcp_f32 v121, v121
v_rcp_f32 v37, v37
v_rcp_f32 v124, v124
v_mfma_f32_16x16x32_bf16 v[40:43], v[136:139], v[80:83], v[40:43]
buffer_load_dwordx4 a[152:155], v0, s[4:7], s67 offen offset:2048
v_mfma_f32_16x16x32_bf16 v[44:47], v[140:143], v[80:83], v[44:47]
buffer_load_dwordx4 a[160:163], v0, s[4:7], s79 offen offset:0
v_mfma_f32_16x16x32_bf16 v[48:51], v[144:147], v[80:83], v[48:51]
ds_read_b128 v[80:83], v12 offset:21504
v_mul_f32 v58, v58, v122
v_mul_f32 v59, v59, v123
v_mul_f32 v56, v56, v120
v_mul_f32 v57, v57, v121
v_mul_f32 v60, v60, v37
v_mul_f32 v61, v61, v124
v_fmaak_f32 v122, v64, v64, 0x409d30fc
v_fmaak_f32 v123, v65, v65, 0x409d30fc
v_fmaak_f32 v120, v62, v62, 0x409d30fc
v_fmaak_f32 v121, v63, v63, 0x409d30fc
v_fmaak_f32 v37, v66, v66, 0x409d30fc
v_fmaak_f32 v124, v67, v67, 0x409d30fc
v_mul_f32 v122, v64, v122
v_mul_f32 v123, v65, v123
v_mfma_f32_16x16x32_bf16 v[40:43], v[148:151], v[84:87], v[40:43]
buffer_load_dwordx4 a[164:167], v0, s[4:7], s79 offen offset:1024
s_waitcnt lgkmcnt(1)
v_mfma_f32_16x16x32_bf16 v[44:47], v[152:155], v[84:87], v[44:47]
v_mul_f32 v120, v62, v120
v_mul_f32 v121, v63, v121
v_mfma_f32_16x16x32_bf16 v[48:51], v[156:159], v[84:87], v[48:51]
ds_read_b128 v[84:87], v13 offset:21504
v_mul_f32 v37, v66, v37
v_mul_f32 v124, v67, v124
v_exp_f32_e64 v122, -v122
v_exp_f32_e64 v123, -v123
v_exp_f32_e64 v120, -v120
v_exp_f32_e64 v121, -v121
v_exp_f32_e64 v37, -v37
v_exp_f32_e64 v124, -v124
v_fma_f32 v122, v122, s44, s44
v_fma_f32 v123, v123, s44, s44
v_fma_f32 v120, v120, s44, s44
v_fma_f32 v121, v121, s44, s44
v_fma_f32 v37, v37, s44, s44
v_fma_f32 v124, v124, s44, s44
v_rcp_f32 v122, v122
v_rcp_f32 v123, v123
v_rcp_f32 v120, v120
v_rcp_f32 v121, v121
v_rcp_f32 v37, v37
v_rcp_f32 v124, v124
v_mul_f32 v64, v64, v122
v_mul_f32 v65, v65, v123
v_mul_f32 v62, v62, v120
v_mul_f32 v63, v63, v121
v_mul_f32 v66, v66, v37
v_mul_f32 v67, v67, v124
v_cvt_pk_bf16_f32 v64, v64, v65
v_cvt_pk_bf16_f32 v68, v56, v57
s_waitcnt vmcnt(12)
v_cmp_eq_u32_e64 s[58:59], v126, v39
v_cvt_pk_bf16_f32 v69, v58, v59
v_cvt_pk_bf16_f32 v70, v60, v61
v_cvt_pk_bf16_f32 v71, v62, v63
v_cvt_pk_bf16_f32 v65, v66, v67
v_mfma_f32_16x16x32_bf16 v[40:43], v[160:163], v[72:75], v[40:43]
s_waitcnt vmcnt(9)
s_add_u32 s64, s32, 0xb16000
s_add_u32 s62, s33, 0xb16000
v_mfma_f32_16x16x32_bf16 v[44:47], v[164:167], v[72:75], v[44:47]
s_waitcnt vmcnt(7)
buffer_store_dwordx4 v[68:71], v0, s[4:7], s64 offen
s_cmp_eq_u64 s[58:59], s[56:57]
s_cbranch_scc0 CHK_18
CRET_18:
s_add_u32 s63, s30, 0x800000
s_add_u32 m0, s38, 0x20000
s_nop 0
buffer_load_dwordx4 v0, s[4:7], s63 offen offset:0 sc1 lds
buffer_load_dwordx4 v0, s[4:7], s63 offen offset:1024 sc1 lds
buffer_load_dwordx4 v0, s[4:7], s63 offen offset:2048 sc1 lds
buffer_load_dwordx4 v0, s[4:7], s63 offen offset:3072 sc1 lds
buffer_store_dwordx2 v[64:65], v1, s[4:7], s62 offen
v_mfma_f32_16x16x32_bf16 v[48:51], v[168:171], v[72:75], v[48:51]
ds_read_b128 v[72:75], v12 offset:22528
v_cmp_eq_u32_e64 s[76:77], v126, v127
v_mfma_f32_16x16x32_bf16 v[40:43], v[172:175], v[76:79], v[40:43]
buffer_load_dwordx4 a[172:175], v0, s[4:7], s79 offen offset:3072
s_waitcnt lgkmcnt(1)
v_mfma_f32_16x16x32_bf16 v[44:47], v[176:179], v[76:79], v[44:47]
v_add_f32 v52, v52, v54
v_add_f32 v53, v53, v55
v_mfma_f32_16x16x32_bf16 v[48:51], v[180:183], v[76:79], v[48:51]
ds_read_b128 v[76:79], v13 offset:22528
s_cmp_eq_u64 s[76:77], s[56:57]
s_cbranch_scc0 CHK_22
CRET_22:
v_mfma_f32_16x16x32_bf16 v[40:43], v[184:187], v[80:83], v[40:43]
v_mfma_f32_16x16x32_bf16 v[44:47], v[188:191], v[80:83], v[44:47]
v_mfma_f32_16x16x32_bf16 v[48:51], v[192:195], v[80:83], v[48:51]
ds_read_b128 v[80:83], v12 offset:23552
v_mfma_f32_16x16x32_bf16 v[40:43], v[196:199], v[84:87], v[40:43]
v_mfma_f32_16x16x32_bf16 v[44:47], v[200:203], v[84:87], v[44:47]
s_waitcnt lgkmcnt(2)
v_mfma_f32_16x16x32_bf16 v[48:51], v[204:207], v[84:87], v[48:51]
ds_read_b128 v[84:87], v13 offset:23552
v_mfma_f32_16x16x32_bf16 v[40:43], v[208:211], v[72:75], v[40:43]
s_add_u32 s78, s42, 0x1000
v_mfma_f32_16x16x32_bf16 v[44:47], v[212:215], v[72:75], v[44:47]
s_waitcnt lgkmcnt(2)
v_mfma_f32_16x16x32_bf16 v[48:51], v[216:219], v[72:75], v[48:51]
v_mfma_f32_16x16x32_bf16 v[40:43], v[220:223], v[76:79], v[40:43]
v_mfma_f32_16x16x32_bf16 v[44:47], v[224:227], v[76:79], v[44:47]
s_waitcnt lgkmcnt(1)
s_add_u32 s66, s42, 0x2000
v_mfma_f32_16x16x32_bf16 v[48:51], v[228:231], v[76:79], v[48:51]
v_mfma_f32_16x16x32_bf16 v[40:43], v[232:235], v[80:83], v[40:43]
v_mfma_f32_16x16x32_bf16 v[44:47], v[236:239], v[80:83], v[44:47]
s_waitcnt lgkmcnt(0)
v_mfma_f32_16x16x32_bf16 v[48:51], v[240:243], v[80:83], v[48:51]
s_add_u32 s68, s42, 0x3000
v_mfma_f32_16x16x32_bf16 v[40:43], v[244:247], v[84:87], v[40:43]
v_mfma_f32_16x16x32_bf16 v[44:47], v[248:251], v[84:87], v[44:47]
buffer_load_dwordx4 a[0:3], v0, s[4:7], s42 offen offset:0
v_mfma_f32_16x16x32_bf16 v[48:51], v[252:255], v[84:87], v[48:51]
buffer_load_dwordx4 a[12:15], v0, s[4:7], s42 offen offset:3072
v_mfma_f32_16x16x4_f32 v[104:107], v36, v52, 0
buffer_load_dwordx4 a[24:27], v0, s[4:7], s78 offen offset:2048
buffer_load_dwordx4 a[36:39], v0, s[4:7], s66 offen offset:1024
buffer_load_dwordx4 a[48:51], v0, s[4:7], s68 offen offset:0
v_mfma_f32_16x16x4_f32 v[108:111], v36, v53, 0
s_nop 9
v_fma_f32 v108, -v104, v104, v108
v_max_f32 v108, 0, v108
v_add_f32 v108, s45, v108
v_rsq_f32 v108, v108
s_nop 0
v_mul_f32 v108, s44, v108
v_mul_f32_e64 v104, -v104, v108
v_fma_f32 v120, v104, v88, v100
v_fma_f32 v121, v104, v89, v101
v_fma_f32 v122, v104, v90, v102
v_fma_f32 v123, v104, v91, v103
v_fma_f32 v37, v104, v92, v112
v_fma_f32 v124, v104, v93, v113
v_fma_f32 v40, v40, v108, v120
v_fma_f32 v41, v41, v108, v121
v_fma_f32 v42, v42, v108, v122
v_fma_f32 v43, v43, v108, v123
v_fma_f32 v44, v44, v108, v37
v_fma_f32 v45, v45, v108, v124
v_fma_f32 v120, v104, v94, v114
v_fma_f32 v121, v104, v95, v115
v_fma_f32 v122, v104, v96, v116
v_fma_f32 v123, v104, v97, v117
v_fma_f32 v37, v104, v98, v118
v_fma_f32 v124, v104, v99, v119
v_fma_f32 v46, v46, v108, v120
v_fma_f32 v47, v47, v108, v121
v_fma_f32 v48, v48, v108, v122
v_fma_f32 v49, v49, v108, v123
v_fma_f32 v50, v50, v108, v37
v_fma_f32 v51, v51, v108, v124
v_fmaak_f32 v120, v40, v40, 0x409d30fc
v_fmaak_f32 v121, v41, v41, 0x409d30fc
v_fmaak_f32 v122, v42, v42, 0x409d30fc
v_fmaak_f32 v123, v43, v43, 0x409d30fc
v_mul_f32 v120, v40, v120
v_mul_f32 v121, v41, v121
v_mul_f32 v122, v42, v122
v_mul_f32 v123, v43, v123
v_exp_f32_e64 v120, -v120
v_exp_f32_e64 v121, -v121
v_exp_f32_e64 v122, -v122
v_exp_f32_e64 v123, -v123
v_fmaak_f32 v37, v44, v44, 0x409d30fc
v_fmaak_f32 v124, v45, v45, 0x409d30fc
v_fma_f32 v120, v120, s44, s44
v_fma_f32 v121, v121, s44, s44
v_fma_f32 v122, v122, s44, s44
v_fma_f32 v123, v123, s44, s44
v_mul_f32 v37, v44, v37
v_mul_f32 v124, v45, v124
v_rcp_f32 v120, v120
v_rcp_f32 v121, v121
v_rcp_f32 v122, v122
v_rcp_f32 v123, v123
v_exp_f32_e64 v37, -v37
v_exp_f32_e64 v124, -v124
s_waitcnt vmcnt(7)
s_barrier
s_waitcnt vmcnt(6)
s_cbranch_vccnz SIG_17
buffer_store_dword v126, v2, s[4:7], s36 offen offset:1280
SRET_17:
s_add_u32 s65, s35, 0x520000
ds_read_b128 v[72:75], v12 offset:32768
ds_read_b128 v[76:79], v13 offset:32768
ds_read_b128 v[80:83], v12 offset:33792
ds_read_b128 v[84:87], v13 offset:33792
buffer_load_dwordx4 v[68:71], v14, s[4:7], s65 offen offset:0 sc1
v_mul_f32 v40, v40, v120
v_mul_f32 v41, v41, v121
v_mul_f32 v42, v42, v122
v_mul_f32 v43, v43, v123
v_fma_f32 v37, v37, s44, s44
v_fma_f32 v124, v124, s44, s44
v_fmaak_f32 v120, v46, v46, 0x409d30fc
v_fmaak_f32 v121, v47, v47, 0x409d30fc
v_fmaak_f32 v122, v48, v48, 0x409d30fc
v_fmaak_f32 v123, v49, v49, 0x409d30fc
v_rcp_f32 v37, v37
v_rcp_f32 v124, v124
v_mul_f32 v120, v46, v120
v_mul_f32 v121, v47, v121
v_mul_f32 v122, v48, v122
v_mul_f32 v123, v49, v123
v_exp_f32_e64 v120, -v120
v_exp_f32_e64 v121, -v121
s_waitcnt lgkmcnt(3)
v_mfma_f32_16x16x32_bf16 v[56:59], a[192:195], v[72:75], 0
s_add_u32 s69, s42, 0x3000
v_exp_f32_e64 v122, -v122
v_mfma_f32_16x16x32_bf16 v[60:63], a[196:199], v[72:75], 0
s_waitcnt lgkmcnt(2)
v_exp_f32_e64 v123, -v123
v_mfma_f32_16x16x32_bf16 v[64:67], a[200:203], v[72:75], 0
ds_read_b128 v[72:75], v12 offset:34816
s_mul_i32 s67, s26, 180224
v_mul_f32 v44, v44, v37
v_mfma_f32_16x16x32_bf16 v[56:59], a[204:207], v[76:79], v[56:59]
buffer_load_dwordx4 a[60:63], v0, s[4:7], s69 offen offset:3072
s_waitcnt lgkmcnt(2)
s_add_u32 s64, s67, 0xb00000
v_mfma_f32_16x16x32_bf16 v[60:63], a[208:211], v[76:79], v[60:63]
buffer_load_dword v23, v125, s[4:7], s64 offen
v_mul_f32 v45, v45, v124
v_mfma_f32_16x16x32_bf16 v[64:67], a[212:215], v[76:79], v[64:67]
ds_read_b128 v[76:79], v13 offset:34816
v_fmaak_f32 v37, v50, v50, 0x409d30fc
v_mfma_f32_16x16x32_bf16 v[56:59], a[216:219], v[80:83], v[56:59]
v_fmaak_f32 v124, v51, v51, 0x409d30fc
v_fma_f32 v120, v120, s44, s44
v_mfma_f32_16x16x32_bf16 v[60:63], a[220:223], v[80:83], v[60:63]
s_waitcnt lgkmcnt(2)
v_fma_f32 v121, v121, s44, s44
v_fma_f32 v122, v122, s44, s44
v_mfma_f32_16x16x32_bf16 v[64:67], a[224:227], v[80:83], v[64:67]
ds_read_b128 v[80:83], v12 offset:35840
v_fma_f32 v123, v123, s44, s44
v_mfma_f32_16x16x32_bf16 v[56:59], a[228:231], v[84:87], v[56:59]
v_mul_f32 v37, v50, v37
v_mul_f32 v124, v51, v124
v_mfma_f32_16x16x32_bf16 v[60:63], a[232:235], v[84:87], v[60:63]
s_waitcnt lgkmcnt(2)
v_rcp_f32 v120, v120
v_mfma_f32_16x16x32_bf16 v[64:67], a[236:239], v[84:87], v[64:67]
ds_read_b128 v[84:87], v13 offset:35840
v_rcp_f32 v121, v121
v_mfma_f32_16x16x32_bf16 v[56:59], a[240:243], v[72:75], v[56:59]
s_add_u32 s63, s42, 0x4000
v_rcp_f32 v122, v122
v_mfma_f32_16x16x32_bf16 v[60:63], a[244:247], v[72:75], v[60:63]
s_waitcnt lgkmcnt(2)
v_rcp_f32 v123, v123
v_mfma_f32_16x16x32_bf16 v[64:67], a[248:251], v[72:75], v[64:67]
ds_read_b128 v[72:75], v12 offset:36864
v_exp_f32_e64 v37, -v37
v_mfma_f32_16x16x32_bf16 v[56:59], a[252:255], v[76:79], v[56:59]
buffer_load_dwordx4 a[72:75], v0, s[4:7], s63 offen offset:2048
s_waitcnt lgkmcnt(2)
v_mfma_f32_16x16x32_bf16 v[60:63], v[128:131], v[76:79], v[60:63]
v_exp_f32_e64 v124, -v124
v_mfma_f32_16x16x32_bf16 v[64:67], v[132:135], v[76:79], v[64:67]
ds_read_b128 v[76:79], v13 offset:36864
v_mul_f32 v46, v46, v120
v_mfma_f32_16x16x32_bf16 v[56:59], v[136:139], v[80:83], v[56:59]
v_mul_f32 v47, v47, v121
v_mul_f32 v48, v48, v122
v_mfma_f32_16x16x32_bf16 v[60:63], v[140:143], v[80:83], v[60:63]
s_waitcnt lgkmcnt(2)
v_mul_f32 v49, v49, v123
v_fma_f32 v37, v37, s44, s44
v_mfma_f32_16x16x32_bf16 v[64:67], v[144:147], v[80:83], v[64:67]
ds_read_b128 v[80:83], v12 offset:37888
v_fma_f32 v124, v124, s44, s44
v_mfma_f32_16x16x32_bf16 v[56:59], v[148:151], v[84:87], v[56:59]
v_rcp_f32 v37, v37
v_mfma_f32_16x16x32_bf16 v[60:63], v[152:155], v[84:87], v[60:63]
s_waitcnt lgkmcnt(2)
v_rcp_f32 v124, v124
v_mfma_f32_16x16x32_bf16 v[64:67], v[156:159], v[84:87], v[64:67]
ds_read_b128 v[84:87], v13 offset:37888
v_mul_f32 v50, v50, v37
v_mfma_f32_16x16x32_bf16 v[56:59], v[160:163], v[72:75], v[56:59]
s_add_u32 s62, s42, 0x5000
v_mul_f32 v51, v51, v124
v_cvt_pk_bf16_f32 v48, v48, v49
v_mfma_f32_16x16x32_bf16 v[60:63], v[164:167], v[72:75], v[60:63]
s_waitcnt lgkmcnt(2)
v_cvt_pk_bf16_f32 v52, v40, v41
v_cvt_pk_bf16_f32 v53, v42, v43
v_mfma_f32_16x16x32_bf16 v[64:67], v[168:171], v[72:75], v[64:67]
ds_read_b128 v[72:75], v12 offset:38912
v_cvt_pk_bf16_f32 v54, v44, v45
v_mfma_f32_16x16x32_bf16 v[56:59], v[172:175], v[76:79], v[56:59]
buffer_load_dwordx4 a[84:87], v0, s[4:7], s62 offen offset:1024
v_mfma_f32_16x16x32_bf16 v[60:63], v[176:179], v[76:79], v[60:63]
s_waitcnt lgkmcnt(2)
buffer_load_dword v39, v3, s[4:7], s36 offen offset:1280 sc1
v_mfma_f32_16x16x32_bf16 v[64:67], v[180:183], v[76:79], v[64:67]
ds_read_b128 v[76:79], v13 offset:38912
v_cvt_pk_bf16_f32 v55, v46, v47
v_mfma_f32_16x16x32_bf16 v[56:59], v[184:187], v[80:83], v[56:59]
s_add_u32 s79, s32, 0xb0b000
v_cvt_pk_bf16_f32 v49, v50, v51
s_add_u32 s78, s33, 0xb0b000
v_mfma_f32_16x16x32_bf16 v[60:63], v[188:191], v[80:83], v[60:63]
s_waitcnt lgkmcnt(2)
buffer_store_dwordx4 v[52:55], v0, s[4:7], s79 offen
v_mfma_f32_16x16x32_bf16 v[64:67], v[192:195], v[80:83], v[64:67]
s_waitcnt vmcnt(6)
ds_read_b128 v[80:83], v12 offset:39936
v_mfma_f32_16x16x32_bf16 v[56:59], v[196:199], v[84:87], v[56:59]
buffer_store_dwordx2 v[48:49], v1, s[4:7], s78 offen
s_waitcnt lgkmcnt(2)
v_mfma_f32_16x16x32_bf16 v[60:63], v[200:203], v[84:87], v[60:63]
v_add_f32 v68, v68, v70
v_add_f32 v69, v69, v71
v_mfma_f32_16x16x32_bf16 v[64:67], v[204:207], v[84:87], v[64:67]
ds_read_b128 v[84:87], v13 offset:39936
v_or_b32 v125, 0x2000, v13
v_mfma_f32_16x16x32_bf16 v[56:59], v[208:211], v[72:75], v[56:59]
s_add_u32 s66, s42, 0x6000
buffer_load_dwordx4 a[96:99], v0, s[4:7], s66 offen offset:0
s_waitcnt lgkmcnt(2)
v_mfma_f32_16x16x32_bf16 v[60:63], v[212:215], v[72:75], v[60:63]
v_mfma_f32_16x16x32_bf16 v[64:67], v[216:219], v[72:75], v[64:67]
s_add_u32 s68, s34, 0xb21000
buffer_load_dwordx4 v[72:75], v0, s[4:7], s68 offen offset:0 sc1
v_mfma_f32_16x16x32_bf16 v[56:59], v[220:223], v[76:79], v[56:59]
v_mfma_f32_16x16x32_bf16 v[60:63], v[224:227], v[76:79], v[60:63]
s_waitcnt lgkmcnt(1)
v_mfma_f32_16x16x32_bf16 v[64:67], v[228:231], v[76:79], v[64:67]
buffer_load_dwordx4 v[76:79], v0, s[4:7], s68 offen offset:1024 sc1
v_mfma_f32_16x16x32_bf16 v[56:59], v[232:235], v[80:83], v[56:59]
v_mfma_f32_16x16x32_bf16 v[60:63], v[236:239], v[80:83], v[60:63]
s_waitcnt lgkmcnt(0)
v_mfma_f32_16x16x32_bf16 v[64:67], v[240:243], v[80:83], v[64:67]
buffer_load_dwordx4 v[80:83], v0, s[4:7], s68 offen offset:2048 sc1
v_mfma_f32_16x16x32_bf16 v[56:59], v[244:247], v[84:87], v[56:59]
v_mfma_f32_16x16x32_bf16 v[60:63], v[248:251], v[84:87], v[60:63]
v_mfma_f32_16x16x32_bf16 v[64:67], v[252:255], v[84:87], v[64:67]
buffer_load_dwordx4 v[84:87], v0, s[4:7], s68 offen offset:3072 sc1
v_mfma_f32_16x16x4_f32 v[104:107], v36, v68, 0
v_mfma_f32_16x16x4_f32 v[108:111], v36, v69, 0
s_nop 8
v_and_b32 v105, s49, v10
v_lshlrev_b32 v106, 16, v11
v_and_b32 v107, s49, v11
v_fma_f32 v108, -v104, v104, v108
v_max_f32 v108, 0, v108
v_add_f32 v108, s45, v108
v_rsq_f32 v108, v108
s_nop 0
v_mul_f32 v108, s44, v108
v_mul_f32_e64 v104, -v104, v108
v_fma_f32 v120, v104, v88, v100
v_fma_f32 v121, v104, v89, v101
v_fma_f32 v122, v104, v90, v102
v_fma_f32 v123, v104, v91, v103
s_add_u32 s65, s34, 0xb22000
buffer_load_dwordx4 v[88:91], v0, s[4:7], s65 offen offset:0 sc1
buffer_load_dwordx4 v[100:103], v0, s[4:7], s65 offen offset:3072 sc1
v_fma_f32 v56, v56, v108, v120
v_fma_f32 v57, v57, v108, v121
v_fma_f32 v58, v58, v108, v122
v_fma_f32 v59, v59, v108, v123
v_fma_f32 v120, v104, v94, v114
v_fma_f32 v121, v104, v95, v115
v_fma_f32 v122, v104, v96, v116
v_fma_f32 v123, v104, v97, v117
v_fma_f32 v37, v104, v92, v112
v_fma_f32 v124, v104, v93, v113
s_add_u32 s69, s34, 0xb23000
v_fma_f32 v62, v62, v108, v120
v_fma_f32 v63, v63, v108, v121
v_fma_f32 v64, v64, v108, v122
v_fma_f32 v65, v65, v108, v123
v_fmaak_f32 v120, v56, v56, 0x409d30fc
v_fmaak_f32 v121, v57, v57, 0x409d30fc
v_fmaak_f32 v122, v58, v58, 0x409d30fc
v_fmaak_f32 v123, v59, v59, 0x409d30fc
v_mul_f32 v120, v56, v120
v_mul_f32 v121, v57, v121
v_mul_f32 v122, v58, v122
v_mul_f32 v123, v59, v123
v_fma_f32 v60, v60, v108, v37
v_fma_f32 v61, v61, v108, v124
v_exp_f32_e64 v120, -v120
v_exp_f32_e64 v121, -v121
v_exp_f32_e64 v122, -v122
v_exp_f32_e64 v123, -v123
v_fma_f32 v37, v104, v98, v118
v_fma_f32 v124, v104, v99, v119
v_fma_f32 v120, v120, s44, s44
v_fma_f32 v121, v121, s44, s44
v_fma_f32 v122, v122, s44, s44
v_fma_f32 v123, v123, s44, s44
v_rcp_f32 v120, v120
v_rcp_f32 v121, v121
v_rcp_f32 v122, v122
v_rcp_f32 v123, v123
v_mul_f32 v56, v56, v120
buffer_load_dwordx4 v[92:95], v0, s[4:7], s65 offen offset:1024 sc1
buffer_load_dwordx4 v[96:99], v0, s[4:7], s65 offen offset:2048 sc1
buffer_load_dwordx4 v[112:115], v0, s[4:7], s69 offen offset:0 sc1
buffer_load_dwordx4 v[116:119], v0, s[4:7], s69 offen offset:1024 sc1
v_mul_f32 v57, v57, v121
v_mul_f32 v58, v58, v122
v_mul_f32 v59, v59, v123
v_fmaak_f32 v120, v62, v62, 0x409d30fc
v_fmaak_f32 v121, v63, v63, 0x409d30fc
v_fmaak_f32 v122, v64, v64, 0x409d30fc
v_fmaak_f32 v123, v65, v65, 0x409d30fc
v_mul_f32 v120, v62, v120
v_mul_f32 v121, v63, v121
v_mul_f32 v122, v64, v122
v_mul_f32 v123, v65, v123
v_exp_f32_e64 v120, -v120
v_exp_f32_e64 v121, -v121
v_exp_f32_e64 v122, -v122
v_exp_f32_e64 v123, -v123
v_fma_f32 v120, v120, s44, s44
v_fma_f32 v121, v121, s44, s44
v_fma_f32 v122, v122, s44, s44
v_fma_f32 v123, v123, s44, s44
v_rcp_f32 v120, v120
v_rcp_f32 v121, v121
v_rcp_f32 v122, v122
v_rcp_f32 v123, v123
v_mul_f32 v62, v62, v120
v_mul_f32 v63, v63, v121
v_mul_f32 v64, v64, v122
v_mul_f32 v65, v65, v123
buffer_load_dwordx4 v[120:123], v0, s[4:7], s69 offen offset:2048 sc1
v_lshlrev_b32 v104, 16, v10
v_fma_f32 v66, v66, v108, v37
v_fma_f32 v67, v67, v108, v124
v_fmaak_f32 v37, v60, v60, 0x409d30fc
v_fmaak_f32 v124, v61, v61, 0x409d30fc
v_mul_f32 v37, v60, v37
v_mul_f32 v124, v61, v124
v_exp_f32_e64 v37, -v37
v_exp_f32_e64 v124, -v124
v_fma_f32 v37, v37, s44, s44
v_fma_f32 v124, v124, s44, s44
v_rcp_f32 v37, v37
v_rcp_f32 v124, v124
v_mul_f32 v60, v60, v37
v_mul_f32 v61, v61, v124
v_fmaak_f32 v37, v66, v66, 0x409d30fc
v_fmaak_f32 v124, v67, v67, 0x409d30fc
v_mul_f32 v37, v66, v37
v_mul_f32 v124, v67, v124
v_exp_f32_e64 v37, -v37
v_exp_f32_e64 v124, -v124
v_fma_f32 v37, v37, s44, s44
v_fma_f32 v124, v124, s44, s44
v_rcp_f32 v37, v37
v_rcp_f32 v124, v124
v_mul_f32 v66, v66, v37
v_mul_f32 v67, v67, v124
v_cvt_pk_bf16_f32 v64, v64, v65
s_waitcnt vmcnt(10)
v_mfma_f32_16x16x32_bf16 v[40:43], a[0:3], v[72:75], 0
s_cbranch_vccnz SIG_19
buffer_store_dword v126, v2, s[4:7], s36 offen offset:1152
SRET_19:
s_waitcnt vmcnt(10)
v_mfma_f32_16x16x32_bf16 v[44:47], a[4:7], v[72:75], 0
v_cmp_eq_u32_e64 s[58:59], v126, v39
v_cvt_pk_bf16_f32 v68, v56, v57
v_mfma_f32_16x16x32_bf16 v[48:51], a[8:11], v[72:75], 0
v_cvt_pk_bf16_f32 v69, v58, v59
v_cvt_pk_bf16_f32 v70, v60, v61
v_mfma_f32_16x16x32_bf16 v[52:55], a[12:15], v[72:75], 0
v_cvt_pk_bf16_f32 v71, v62, v63
v_cvt_pk_bf16_f32 v65, v66, v67
v_mfma_f32_16x16x32_bf16 v[40:43], a[16:19], v[76:79], v[40:43]
s_add_u32 s67, s32, 0xb00000
s_cmp_eq_u64 s[58:59], s[56:57]
s_cbranch_scc0 CHK_24
CRET_24:
v_mfma_f32_16x16x32_bf16 v[44:47], a[20:23], v[76:79], v[44:47]
s_waitcnt vmcnt(9)
s_add_u32 s64, s34, 0xb16000
buffer_load_dwordx4 v[72:75], v0, s[4:7], s64 offen offset:0 sc1
s_add_u32 s63, s33, 0xb00000
v_mfma_f32_16x16x32_bf16 v[48:51], a[24:27], v[76:79], v[48:51]
buffer_store_dwordx4 v[68:71], v0, s[4:7], s67 offen
v_mfma_f32_16x16x32_bf16 v[52:55], a[28:31], v[76:79], v[52:55]
buffer_load_dwordx4 v[76:79], v0, s[4:7], s64 offen offset:1024 sc1
v_mfma_f32_16x16x32_bf16 v[40:43], a[32:35], v[80:83], v[40:43]
buffer_store_dwordx2 v[64:65], v1, s[4:7], s63 offen
s_waitcnt vmcnt(12)
v_mfma_f32_16x16x32_bf16 v[44:47], a[36:39], v[80:83], v[44:47]
v_lshlrev_b32 v37, 5, v3
v_mfma_f32_16x16x32_bf16 v[48:51], a[40:43], v[80:83], v[48:51]
buffer_load_dword v127, v37, s[4:7], s52 offen sc1
v_mfma_f32_16x16x32_bf16 v[52:55], a[44:47], v[80:83], v[52:55]
buffer_load_dwordx4 v[80:83], v0, s[4:7], s64 offen offset:2048 sc1
v_mfma_f32_16x16x32_bf16 v[40:43], a[48:51], v[84:87], v[40:43]
v_mfma_f32_16x16x32_bf16 v[44:47], a[52:55], v[84:87], v[44:47]
s_waitcnt vmcnt(13)
v_mfma_f32_16x16x32_bf16 v[48:51], a[56:59], v[84:87], v[48:51]
v_mfma_f32_16x16x32_bf16 v[52:55], a[60:63], v[84:87], v[52:55]
buffer_load_dwordx4 v[84:87], v0, s[4:7], s64 offen offset:3072 sc1
v_mfma_f32_16x16x32_bf16 v[40:43], a[64:67], v[88:91], v[40:43]
v_mfma_f32_16x16x32_bf16 v[44:47], a[68:71], v[88:91], v[44:47]
s_waitcnt vmcnt(12)
v_mfma_f32_16x16x32_bf16 v[48:51], a[72:75], v[88:91], v[48:51]
v_mfma_f32_16x16x32_bf16 v[52:55], a[76:79], v[88:91], v[52:55]
s_add_u32 s62, s34, 0xb17000
buffer_load_dwordx4 v[88:91], v0, s[4:7], s62 offen offset:0 sc1
v_mfma_f32_16x16x32_bf16 v[40:43], a[80:83], v[92:95], v[40:43]
v_mfma_f32_16x16x32_bf16 v[44:47], a[84:87], v[92:95], v[44:47]
s_waitcnt vmcnt(12)
v_mfma_f32_16x16x32_bf16 v[48:51], a[88:91], v[92:95], v[48:51]
v_mfma_f32_16x16x32_bf16 v[52:55], a[92:95], v[92:95], v[52:55]
buffer_load_dwordx4 v[92:95], v0, s[4:7], s62 offen offset:1024 sc1
v_mfma_f32_16x16x32_bf16 v[40:43], a[96:99], v[96:99], v[40:43]
v_mfma_f32_16x16x32_bf16 v[44:47], a[100:103], v[96:99], v[44:47]
v_mfma_f32_16x16x32_bf16 v[48:51], a[104:107], v[96:99], v[48:51]
v_mfma_f32_16x16x32_bf16 v[52:55], a[108:111], v[96:99], v[52:55]
buffer_load_dwordx4 v[96:99], v0, s[4:7], s62 offen offset:2048 sc1
v_mfma_f32_16x16x32_bf16 v[40:43], a[112:115], v[100:103], v[40:43]
v_mfma_f32_16x16x32_bf16 v[44:47], a[116:119], v[100:103], v[44:47]
s_waitcnt vmcnt(13)
v_mfma_f32_16x16x32_bf16 v[48:51], a[120:123], v[100:103], v[48:51]
v_mfma_f32_16x16x32_bf16 v[52:55], a[124:127], v[100:103], v[52:55]
buffer_load_dwordx4 v[100:103], v0, s[4:7], s62 offen offset:3072 sc1
v_mfma_f32_16x16x32_bf16 v[40:43], a[128:131], v[112:115], v[40:43]
v_mfma_f32_16x16x32_bf16 v[44:47], a[132:135], v[112:115], v[44:47]
s_waitcnt vmcnt(13)
buffer_load_dword v23, v3, s[4:7], s36 offen offset:1152 sc1
v_mfma_f32_16x16x32_bf16 v[48:51], a[136:139], v[112:115], v[48:51]
v_mfma_f32_16x16x32_bf16 v[52:55], a[140:143], v[112:115], v[52:55]
s_add_u32 s79, s34, 0xb18000
buffer_load_dwordx4 v[112:115], v0, s[4:7], s79 offen offset:0 sc1
v_mfma_f32_16x16x32_bf16 v[40:43], a[144:147], v[116:119], v[40:43]
v_mfma_f32_16x16x32_bf16 v[44:47], a[148:151], v[116:119], v[44:47]
s_waitcnt vmcnt(14)
v_mfma_f32_16x16x32_bf16 v[48:51], a[152:155], v[116:119], v[48:51]
v_mfma_f32_16x16x32_bf16 v[52:55], a[156:159], v[116:119], v[52:55]
buffer_load_dwordx4 v[116:119], v0, s[4:7], s79 offen offset:1024 sc1
v_mfma_f32_16x16x32_bf16 v[40:43], a[160:163], v[120:123], v[40:43]
v_mfma_f32_16x16x32_bf16 v[44:47], a[164:167], v[120:123], v[44:47]
v_mfma_f32_16x16x32_bf16 v[48:51], a[168:171], v[120:123], v[48:51]
s_waitcnt vmcnt(13)
v_mfma_f32_16x16x32_bf16 v[52:55], a[172:175], v[120:123], v[52:55]
buffer_load_dwordx4 v[120:123], v0, s[4:7], s79 offen offset:2048 sc1
v_mfma_f32_16x16x32_bf16 v[56:59], a[0:3], v[72:75], 0
s_nop 1
ds_write_b128 v18, v[40:43] offset:0
ds_write_b128 v19, v[44:47] offset:0
ds_write_b128 v18, v[48:51] offset:128
s_waitcnt vmcnt(12)
s_waitcnt vmcnt(11)
ds_write_b128 v19, v[52:55] offset:128
v_mfma_f32_16x16x32_bf16 v[60:63], a[4:7], v[72:75], 0
s_waitcnt vmcnt(10)
s_cbranch_vccnz SIG_20
buffer_store_dword v126, v2, s[4:7], s36 offen offset:1024
SRET_20:
v_mfma_f32_16x16x32_bf16 v[64:67], a[8:11], v[72:75], 0
v_cmp_eq_u32_e64 s[76:77], v126, v127
v_mfma_f32_16x16x32_bf16 v[68:71], a[12:15], v[72:75], 0
v_mfma_f32_16x16x32_bf16 v[56:59], a[16:19], v[76:79], v[56:59]
v_mfma_f32_16x16x32_bf16 v[60:63], a[20:23], v[76:79], v[60:63]
s_waitcnt vmcnt(10)
s_cmp_eq_u64 s[76:77], -1
s_cbranch_scc0 CHK_21
CRET_21:
v_add_u32 v37, s53, v21
v_mfma_f32_16x16x32_bf16 v[64:67], a[24:27], v[76:79], v[64:67]
s_waitcnt lgkmcnt(0)
s_barrier
v_mfma_f32_16x16x32_bf16 v[68:71], a[28:31], v[76:79], v[68:71]
v_mfma_f32_16x16x32_bf16 v[56:59], a[32:35], v[80:83], v[56:59]
ds_read_b128 v[40:43], v20 offset:0
s_waitcnt vmcnt(9)
ds_read_b128 v[44:47], v20 offset:4096
ds_read_b128 v[48:51], v20 offset:8192
ds_read_b128 v[52:55], v20 offset:12288
v_mfma_f32_16x16x32_bf16 v[60:63], a[36:39], v[80:83], v[60:63]
v_mfma_f32_16x16x32_bf16 v[64:67], a[40:43], v[80:83], v[64:67]
v_mfma_f32_16x16x32_bf16 v[68:71], a[44:47], v[80:83], v[68:71]
v_mfma_f32_16x16x32_bf16 v[56:59], a[48:51], v[84:87], v[56:59]
v_mfma_f32_16x16x32_bf16 v[60:63], a[52:55], v[84:87], v[60:63]
s_waitcnt vmcnt(8)
v_mfma_f32_16x16x32_bf16 v[64:67], a[56:59], v[84:87], v[64:67]
v_mfma_f32_16x16x32_bf16 v[68:71], a[60:63], v[84:87], v[68:71]
s_waitcnt lgkmcnt(2)
v_add_f32 v40, v40, v44
v_add_f32 v104, v104, v40
v_add_f32 v41, v41, v45
v_add_f32 v42, v42, v46
v_add_f32 v43, v43, v47
v_add_f32 v105, v105, v41
v_add_f32 v106, v106, v42
v_add_f32 v107, v107, v43
s_waitcnt lgkmcnt(0)
v_add_f32 v48, v48, v52
v_add_f32 v104, v104, v48
v_add_f32 v49, v49, v53
v_add_f32 v50, v50, v54
v_add_f32 v51, v51, v55
v_add_f32 v105, v105, v49
v_add_f32 v106, v106, v50
v_add_f32 v107, v107, v51
v_mul_f32 v109, v104, v104
v_add_f32 v108, v104, v105
v_add_f32 v110, v106, v107
v_fmac_f32 v109, v105, v105
v_add_f32 v108, v108, v110
v_fmac_f32 v109, v106, v106
v_fmac_f32 v109, v107, v107
v_add_f32_dpp v108, v108, v108 row_ror:8 row_mask:0xf bank_mask:0xf
v_cvt_pk_bf16_f32 v10, v104, v105
v_lshlrev_b32 v104, 16, v8
v_and_b32 v105, s49, v8
v_add_f32_dpp v108, v109, v109 row_ror:8 row_mask:0xf bank_mask:0xc
v_cvt_pk_bf16_f32 v11, v106, v107
v_lshlrev_b32 v106, 16, v9
v_and_b32 v107, s49, v9
v_add_f32_dpp v108, v108, v108 row_half_mirror row_mask:0xf bank_mask:0xf
v_mfma_f32_16x16x32_bf16 v[56:59], a[64:67], v[88:91], v[56:59]
s_waitcnt vmcnt(4)
v_add_f32_dpp v108, v108, v108 quad_perm:[2,3,0,1] row_mask:0xf bank_mask:0xf
s_add_u32 s78, s27, 0x80c000
v_mfma_f32_16x16x32_bf16 v[60:63], a[68:71], v[88:91], v[60:63]
buffer_store_dwordx2 v[10:11], v21, s[4:7], s78 offen
v_add_f32_dpp v108, v108, v108 quad_perm:[1,0,3,2] row_mask:0xf bank_mask:0xf
v_mov_b32 v124, v108
v_mfma_f32_16x16x32_bf16 v[64:67], a[72:75], v[88:91], v[64:67]
s_add_u32 s66, s35, 0x520000
buffer_store_dword v108, v22, s[4:7], s66 offen offset:3072
v_mfma_f32_16x16x32_bf16 v[68:71], a[76:79], v[88:91], v[68:71]
v_cmp_eq_u32_e64 s[58:59], v126, v23
v_mfma_f32_16x16x32_bf16 v[56:59], a[80:83], v[92:95], v[56:59]
buffer_load_dword v39, v3, s[4:7], s36 offen offset:1024 sc1
v_mfma_f32_16x16x32_bf16 v[60:63], a[84:87], v[92:95], v[60:63]
v_mfma_f32_16x16x32_bf16 v[64:67], a[88:91], v[92:95], v[64:67]
s_cmp_eq_u64 s[58:59], s[56:57]
s_cbranch_scc0 CHK_26
CRET_26:
v_mfma_f32_16x16x32_bf16 v[68:71], a[92:95], v[92:95], v[68:71]
s_add_u32 s68, s34, 0xb0b000
buffer_load_dwordx4 v[72:75], v0, s[4:7], s68 offen offset:0 sc1
s_add_u32 s65, s34, 0xb0c000
v_mfma_f32_16x16x32_bf16 v[56:59], a[96:99], v[96:99], v[56:59]
buffer_load_dwordx4 v[76:79], v0, s[4:7], s68 offen offset:1024 sc1
v_mfma_f32_16x16x32_bf16 v[60:63], a[100:103], v[96:99], v[60:63]
buffer_load_dwordx4 v[80:83], v0, s[4:7], s68 offen offset:2048 sc1
v_mfma_f32_16x16x32_bf16 v[64:67], a[104:107], v[96:99], v[64:67]
buffer_load_dwordx4 v[84:87], v0, s[4:7], s68 offen offset:3072 sc1
v_mfma_f32_16x16x32_bf16 v[68:71], a[108:111], v[96:99], v[68:71]
buffer_load_dwordx4 v[88:91], v0, s[4:7], s65 offen offset:0 sc1
v_mfma_f32_16x16x32_bf16 v[56:59], a[112:115], v[100:103], v[56:59]
buffer_load_dwordx4 v[92:95], v0, s[4:7], s65 offen offset:1024 sc1
s_waitcnt vmcnt(12)
v_mfma_f32_16x16x32_bf16 v[60:63], a[116:119], v[100:103], v[60:63]
buffer_load_dwordx4 v[96:99], v0, s[4:7], s65 offen offset:2048 sc1
v_mfma_f32_16x16x32_bf16 v[64:67], a[120:123], v[100:103], v[64:67]
v_mfma_f32_16x16x32_bf16 v[68:71], a[124:127], v[100:103], v[68:71]
buffer_load_dwordx4 v[100:103], v0, s[4:7], s65 offen offset:3072 sc1
v_mfma_f32_16x16x32_bf16 v[56:59], a[128:131], v[112:115], v[56:59]
v_mfma_f32_16x16x32_bf16 v[60:63], a[132:135], v[112:115], v[60:63]
s_waitcnt vmcnt(13)
v_mfma_f32_16x16x32_bf16 v[64:67], a[136:139], v[112:115], v[64:67]
v_mfma_f32_16x16x32_bf16 v[68:71], a[140:143], v[112:115], v[68:71]
s_add_u32 s69, s34, 0xb0d000
buffer_load_dwordx4 v[112:115], v0, s[4:7], s69 offen offset:0 sc1
v_mfma_f32_16x16x32_bf16 v[56:59], a[144:147], v[116:119], v[56:59]
v_mfma_f32_16x16x32_bf16 v[60:63], a[148:151], v[116:119], v[60:63]
s_waitcnt vmcnt(13)
v_mfma_f32_16x16x32_bf16 v[64:67], a[152:155], v[116:119], v[64:67]
v_mfma_f32_16x16x32_bf16 v[68:71], a[156:159], v[116:119], v[68:71]
buffer_load_dwordx4 v[116:119], v0, s[4:7], s69 offen offset:1024 sc1
v_mfma_f32_16x16x32_bf16 v[56:59], a[160:163], v[120:123], v[56:59]
v_mfma_f32_16x16x32_bf16 v[60:63], a[164:167], v[120:123], v[60:63]
v_mfma_f32_16x16x32_bf16 v[64:67], a[168:171], v[120:123], v[64:67]
v_mfma_f32_16x16x32_bf16 v[68:71], a[172:175], v[120:123], v[68:71]
buffer_load_dwordx4 v[120:123], v0, s[4:7], s69 offen offset:2048 sc1
s_nop 3
ds_write_b128 v18, v[56:59] offset:16384
ds_write_b128 v19, v[60:63] offset:16384
ds_write_b128 v18, v[64:67] offset:16512
ds_write_b128 v19, v[68:71] offset:16512
s_waitcnt vmcnt(12)
s_cbranch_vccnz SIG_23
buffer_store_dword v126, v2, s[4:7], s36 offen offset:1920
SRET_23:
s_waitcnt lgkmcnt(0)
s_barrier
ds_read_b128 v[56:59], v20 offset:16384
ds_read_b128 v[60:63], v20 offset:20480
s_waitcnt vmcnt(12)
ds_read_b128 v[64:67], v20 offset:24576
ds_read_b128 v[68:71], v20 offset:28672
v_cmp_eq_u32_e64 s[76:77], v126, v39
s_waitcnt vmcnt(11)
v_mfma_f32_16x16x32_bf16 v[40:43], a[0:3], v[72:75], 0
s_cmp_eq_u64 s[76:77], s[56:57]
s_cbranch_scc0 CHK_28
CRET_28:
v_mfma_f32_16x16x32_bf16 v[44:47], a[4:7], v[72:75], 0
s_waitcnt vmcnt(10)
v_mfma_f32_16x16x32_bf16 v[48:51], a[8:11], v[72:75], 0
v_mfma_f32_16x16x32_bf16 v[52:55], a[12:15], v[72:75], 0
s_add_u32 s67, s34, 0xb00000
buffer_load_dwordx4 v[72:75], v0, s[4:7], s67 offen offset:0 sc1
s_waitcnt lgkmcnt(2)
v_add_f32 v56, v56, v60
v_add_f32 v104, v104, v56
v_add_f32 v57, v57, v61
v_add_f32 v58, v58, v62
v_add_f32 v59, v59, v63
v_add_f32 v105, v105, v57
v_add_f32 v106, v106, v58
v_add_f32 v107, v107, v59
s_waitcnt lgkmcnt(0)
v_add_f32 v64, v64, v68
v_add_f32 v104, v104, v64
v_add_f32 v65, v65, v69
v_add_f32 v66, v66, v70
v_add_f32 v67, v67, v71
v_add_f32 v105, v105, v65
v_add_f32 v106, v106, v66
v_add_f32 v107, v107, v67
v_mul_f32 v109, v104, v104
v_add_f32 v108, v104, v105
v_add_f32 v110, v106, v107
v_fmac_f32 v109, v105, v105
v_add_f32 v108, v108, v110
v_fmac_f32 v109, v106, v106
v_fmac_f32 v109, v107, v107
v_add_f32_dpp v108, v108, v108 row_ror:8 row_mask:0xf bank_mask:0xf
v_cvt_pk_bf16_f32 v8, v104, v105
v_cvt_pk_bf16_f32 v9, v106, v107
v_add_f32_dpp v108, v109, v109 row_ror:8 row_mask:0xf bank_mask:0xc
v_mfma_f32_16x16x32_bf16 v[40:43], a[16:19], v[76:79], v[40:43]
s_add_u32 s63, s27, 0x808000
v_add_f32_dpp v108, v108, v108 row_half_mirror row_mask:0xf bank_mask:0xf
v_lshlrev_b32 v104, 16, v6
v_mfma_f32_16x16x32_bf16 v[44:47], a[20:23], v[76:79], v[44:47]
s_waitcnt vmcnt(10)
v_add_f32_dpp v108, v108, v108 quad_perm:[2,3,0,1] row_mask:0xf bank_mask:0xf
v_and_b32 v105, s49, v6
v_mfma_f32_16x16x32_bf16 v[48:51], a[24:27], v[76:79], v[48:51]
buffer_store_dwordx2 v[8:9], v21, s[4:7], s63 offen
v_add_f32_dpp v108, v108, v108 quad_perm:[1,0,3,2] row_mask:0xf bank_mask:0xf
v_mfma_f32_16x16x32_bf16 v[52:55], a[28:31], v[76:79], v[52:55]
s_add_u32 s64, s35, 0x520000
buffer_store_dword v108, v22, s[4:7], s64 offen offset:2048
buffer_load_dwordx4 v[76:79], v0, s[4:7], s67 offen offset:1024 sc1
v_mfma_f32_16x16x32_bf16 v[40:43], a[32:35], v[80:83], v[40:43]
v_lshlrev_b32 v106, 16, v7
v_and_b32 v107, s49, v7
v_mfma_f32_16x16x32_bf16 v[44:47], a[36:39], v[80:83], v[44:47]
s_waitcnt vmcnt(12)
v_mfma_f32_16x16x32_bf16 v[48:51], a[40:43], v[80:83], v[48:51]
v_mfma_f32_16x16x32_bf16 v[52:55], a[44:47], v[80:83], v[52:55]
buffer_load_dwordx4 v[80:83], v0, s[4:7], s67 offen offset:2048 sc1
v_mfma_f32_16x16x32_bf16 v[40:43], a[48:51], v[84:87], v[40:43]
v_mfma_f32_16x16x32_bf16 v[44:47], a[52:55], v[84:87], v[44:47]
s_waitcnt vmcnt(12)
v_mfma_f32_16x16x32_bf16 v[48:51], a[56:59], v[84:87], v[48:51]
buffer_load_dword v127, v3, s[4:7], s36 offen offset:1920 sc1
v_mfma_f32_16x16x32_bf16 v[52:55], a[60:63], v[84:87], v[52:55]
buffer_load_dwordx4 v[84:87], v0, s[4:7], s67 offen offset:3072 sc1
v_mfma_f32_16x16x32_bf16 v[40:43], a[64:67], v[88:91], v[40:43]
v_mfma_f32_16x16x32_bf16 v[44:47], a[68:71], v[88:91], v[44:47]
s_waitcnt vmcnt(13)
v_mfma_f32_16x16x32_bf16 v[48:51], a[72:75], v[88:91], v[48:51]
v_mfma_f32_16x16x32_bf16 v[52:55], a[76:79], v[88:91], v[52:55]
s_add_u32 s62, s34, 0xb01000
buffer_load_dwordx4 v[88:91], v0, s[4:7], s62 offen offset:0 sc1
v_mfma_f32_16x16x32_bf16 v[40:43], a[80:83], v[92:95], v[40:43]
v_mfma_f32_16x16x32_bf16 v[44:47], a[84:87], v[92:95], v[44:47]
s_waitcnt vmcnt(13)
v_mfma_f32_16x16x32_bf16 v[48:51], a[88:91], v[92:95], v[48:51]
v_mfma_f32_16x16x32_bf16 v[52:55], a[92:95], v[92:95], v[52:55]
buffer_load_dwordx4 v[92:95], v0, s[4:7], s62 offen offset:1024 sc1
v_mfma_f32_16x16x32_bf16 v[40:43], a[96:99], v[96:99], v[40:43]
v_mfma_f32_16x16x32_bf16 v[44:47], a[100:103], v[96:99], v[44:47]
s_waitcnt vmcnt(13)
v_mfma_f32_16x16x32_bf16 v[48:51], a[104:107], v[96:99], v[48:51]
v_mfma_f32_16x16x32_bf16 v[52:55], a[108:111], v[96:99], v[52:55]
buffer_load_dwordx4 v[96:99], v0, s[4:7], s62 offen offset:2048 sc1
v_mfma_f32_16x16x32_bf16 v[40:43], a[112:115], v[100:103], v[40:43]
v_mfma_f32_16x16x32_bf16 v[44:47], a[116:119], v[100:103], v[44:47]
s_waitcnt vmcnt(13)
v_mfma_f32_16x16x32_bf16 v[48:51], a[120:123], v[100:103], v[48:51]
v_mfma_f32_16x16x32_bf16 v[52:55], a[124:127], v[100:103], v[52:55]
buffer_load_dwordx4 v[100:103], v0, s[4:7], s62 offen offset:3072 sc1
v_mfma_f32_16x16x32_bf16 v[40:43], a[128:131], v[112:115], v[40:43]
v_mfma_f32_16x16x32_bf16 v[44:47], a[132:135], v[112:115], v[44:47]
s_waitcnt vmcnt(13)
v_mfma_f32_16x16x32_bf16 v[48:51], a[136:139], v[112:115], v[48:51]
s_waitcnt vmcnt(10)
v_mfma_f32_16x16x32_bf16 v[52:55], a[140:143], v[112:115], v[52:55]
s_add_u32 s79, s34, 0xb02000
buffer_load_dwordx4 v[112:115], v0, s[4:7], s79 offen offset:0 sc1
v_mfma_f32_16x16x32_bf16 v[40:43], a[144:147], v[116:119], v[40:43]
v_mfma_f32_16x16x32_bf16 v[44:47], a[148:151], v[116:119], v[44:47]
v_mfma_f32_16x16x32_bf16 v[48:51], a[152:155], v[116:119], v[48:51]
s_waitcnt vmcnt(9)
s_cbranch_vccnz SIG_25
buffer_store_dword v126, v2, s[4:7], s36 offen offset:1792
SRET_25:
v_mfma_f32_16x16x32_bf16 v[52:55], a[156:159], v[116:119], v[52:55]
buffer_load_dwordx4 v[116:119], v0, s[4:7], s79 offen offset:1024 sc1
v_mfma_f32_16x16x32_bf16 v[40:43], a[160:163], v[120:123], v[40:43]
v_mfma_f32_16x16x32_bf16 v[44:47], a[164:167], v[120:123], v[44:47]
v_mfma_f32_16x16x32_bf16 v[48:51], a[168:171], v[120:123], v[48:51]
v_mfma_f32_16x16x32_bf16 v[52:55], a[172:175], v[120:123], v[52:55]
buffer_load_dwordx4 v[120:123], v0, s[4:7], s79 offen offset:2048 sc1
s_add_u32 s78, s73, 0xa00000
buffer_store_dwordx2 v[10:11], v37, s[4:7], s78 offen sc1
v_add_u32 v37, s53, v22
v_mfma_f32_16x16x32_bf16 v[56:59], a[0:3], v[72:75], 0
s_add_u32 s66, s74, 0x540000
buffer_store_dword v124, v37, s[4:7], s66 offen sc1
s_waitcnt vmcnt(13)
s_add_u32 s68, s3, 0
v_lshlrev_b32 v37, 5, v2
v_or_b32 v37, v37, v2
v_or_b32 v37, s53, v37
v_mfma_f32_16x16x32_bf16 v[60:63], a[4:7], v[72:75], 0
ds_write_b128 v18, v[40:43] offset:0
s_and_b32 s65, s68, 15
s_mul_i32 s69, s65, 3072
s_add_u32 s63, s69, s39
ds_write_b128 v19, v[44:47] offset:0
ds_write_b128 v18, v[48:51] offset:128
ds_write_b128 v19, v[52:55] offset:128
s_waitcnt vmcnt(11)
v_cmp_eq_u32_e64 s[58:59], v126, v127
v_mfma_f32_16x16x32_bf16 v[64:67], a[8:11], v[72:75], 0
buffer_load_dwordx4 a[0:3], v0, s[4:7], s63 offen offset:0
v_mfma_f32_16x16x32_bf16 v[68:71], a[12:15], v[72:75], 0
s_add_u32 s64, s3, 1
buffer_load_dwordx4 a[4:7], v0, s[4:7], s63 offen offset:1024
s_and_b32 s67, s64, 15
s_mul_i32 s62, s67, 3072
v_mfma_f32_16x16x32_bf16 v[56:59], a[16:19], v[76:79], v[56:59]
buffer_load_dwordx4 a[8:11], v0, s[4:7], s63 offen offset:2048
s_cmp_eq_u64 s[58:59], s[56:57]
s_cbranch_scc0 CHK_31
CRET_31:
v_mfma_f32_16x16x32_bf16 v[60:63], a[20:23], v[76:79], v[60:63]
s_add_u32 s79, s30, 0x80c000
s_add_u32 m0, s38, 0x18000
s_add_u32 s78, s62, s39
v_mfma_f32_16x16x32_bf16 v[64:67], a[24:27], v[76:79], v[64:67]
buffer_load_dwordx4 v0, s[4:7], s79 offen offset:0 sc1 lds
s_add_u32 s66, s3, 2
s_and_b32 s68, s66, 15
v_mfma_f32_16x16x32_bf16 v[68:71], a[28:31], v[76:79], v[68:71]
buffer_load_dwordx4 v0, s[4:7], s79 offen offset:1024 sc1 lds
s_mul_i32 s65, s68, 3072
s_waitcnt lgkmcnt(0)
s_barrier
v_mfma_f32_16x16x32_bf16 v[56:59], a[32:35], v[80:83], v[56:59]
buffer_load_dwordx4 v0, s[4:7], s79 offen offset:2048 sc1 lds
s_waitcnt vmcnt(16)
s_add_u32 s69, s65, s39
v_mfma_f32_16x16x32_bf16 v[60:63], a[36:39], v[80:83], v[60:63]
buffer_load_dwordx4 v0, s[4:7], s79 offen offset:3072 sc1 lds
s_add_u32 s64, s3, 3
s_and_b32 s67, s64, 15
v_mfma_f32_16x16x32_bf16 v[64:67], a[40:43], v[80:83], v[64:67]
ds_read_b128 v[40:43], v20 offset:0
s_mul_i32 s63, s67, 3072
ds_read_b128 v[44:47], v20 offset:4096
s_add_u32 s62, s63, s39
v_mfma_f32_16x16x32_bf16 v[68:71], a[44:47], v[80:83], v[68:71]
ds_read_b128 v[48:51], v20 offset:8192
ds_read_b128 v[52:55], v20 offset:12288
v_mfma_f32_16x16x32_bf16 v[56:59], a[48:51], v[84:87], v[56:59]
buffer_load_dwordx4 a[12:15], v0, s[4:7], s78 offen offset:0
s_waitcnt vmcnt(17)
s_add_u32 s66, s3, 4
v_mfma_f32_16x16x32_bf16 v[60:63], a[52:55], v[84:87], v[60:63]
buffer_load_dwordx4 a[16:19], v0, s[4:7], s78 offen offset:1024
s_and_b32 s68, s66, 15
s_mul_i32 s65, s68, 3072
v_mfma_f32_16x16x32_bf16 v[64:67], a[56:59], v[84:87], v[64:67]
buffer_load_dwordx4 a[20:23], v0, s[4:7], s78 offen offset:2048
s_add_u32 s79, s65, s39
v_mfma_f32_16x16x32_bf16 v[68:71], a[60:63], v[84:87], v[68:71]
s_add_u32 s64, s3, 5
v_bfe_u32 v124, v0, 4, 1
s_and_b32 s67, s64, 15
v_mfma_f32_16x16x32_bf16 v[56:59], a[64:67], v[88:91], v[56:59]
s_mul_i32 s63, s67, 3072
s_add_u32 s66, s63, s39
s_waitcnt vmcnt(18)
v_mfma_f32_16x16x32_bf16 v[60:63], a[68:71], v[88:91], v[60:63]
v_mfma_f32_16x16x32_bf16 v[64:67], a[72:75], v[88:91], v[64:67]
s_waitcnt lgkmcnt(2)
s_add_u32 s68, s3, 6
v_add_f32 v40, v40, v44
v_add_f32 v104, v104, v40
v_add_f32 v41, v41, v45
v_add_f32 v42, v42, v46
v_add_f32 v43, v43, v47
v_add_f32 v105, v105, v41
v_add_f32 v106, v106, v42
v_add_f32 v107, v107, v43
s_waitcnt lgkmcnt(0)
v_add_f32 v48, v48, v52
v_add_f32 v104, v104, v48
v_add_f32 v49, v49, v53
v_add_f32 v50, v50, v54
v_add_f32 v51, v51, v55
v_add_f32 v105, v105, v49
v_add_f32 v106, v106, v50
v_add_f32 v107, v107, v51
v_mul_f32 v109, v104, v104
v_add_f32 v108, v104, v105
v_add_f32 v110, v106, v107
v_fmac_f32 v109, v105, v105
v_mfma_f32_16x16x32_bf16 v[68:71], a[76:79], v[88:91], v[68:71]
s_and_b32 s78, s68, 15
v_add_f32 v108, v108, v110
v_fmac_f32 v109, v106, v106
v_fmac_f32 v109, v107, v107
v_add_f32_dpp v108, v108, v108 row_ror:8 row_mask:0xf bank_mask:0xf
v_mfma_f32_16x16x32_bf16 v[56:59], a[80:83], v[92:95], v[56:59]
s_mul_i32 s65, s78, 3072
v_add_f32_dpp v108, v109, v109 row_ror:8 row_mask:0xf bank_mask:0xc
v_cvt_pk_bf16_f32 v6, v104, v105
v_mfma_f32_16x16x32_bf16 v[60:63], a[84:87], v[92:95], v[60:63]
s_waitcnt vmcnt(17)
v_add_f32_dpp v108, v108, v108 row_half_mirror row_mask:0xf bank_mask:0xf
v_cvt_pk_bf16_f32 v7, v106, v107
v_mfma_f32_16x16x32_bf16 v[64:67], a[88:91], v[92:95], v[64:67]
s_add_u32 s64, s27, 0x804000
v_add_f32_dpp v108, v108, v108 quad_perm:[2,3,0,1] row_mask:0xf bank_mask:0xf
v_lshlrev_b32 v104, 16, v4
v_mfma_f32_16x16x32_bf16 v[68:71], a[92:95], v[92:95], v[68:71]
s_add_u32 s67, s65, s39
v_add_f32_dpp v108, v108, v108 quad_perm:[1,0,3,2] row_mask:0xf bank_mask:0xf
s_add_u32 s63, s35, 0x520000
v_mfma_f32_16x16x32_bf16 v[56:59], a[96:99], v[96:99], v[56:59]
buffer_store_dword v108, v22, s[4:7], s63 offen offset:1024
s_waitcnt vmcnt(17)
s_add_u32 s68, s3, 7
v_mfma_f32_16x16x32_bf16 v[60:63], a[100:103], v[96:99], v[60:63]
buffer_store_dwordx2 v[6:7], v21, s[4:7], s64 offen
s_and_b32 s78, s68, 15
s_mul_i32 s65, s78, 3072
s_add_u32 s63, s65, s39
s_add_u32 s64, s3, 8
s_and_b32 s68, s64, 15
s_mul_i32 s78, s68, 3072
s_add_u32 s65, s78, s39
v_mfma_f32_16x16x32_bf16 v[64:67], a[104:107], v[96:99], v[64:67]
v_and_b32 v105, s49, v4
v_lshlrev_b32 v106, 16, v5
v_mfma_f32_16x16x32_bf16 v[68:71], a[108:111], v[96:99], v[68:71]
buffer_load_dwordx4 a[24:27], v0, s[4:7], s69 offen offset:0
s_add_u32 s64, s3, 9
v_mfma_f32_16x16x32_bf16 v[56:59], a[112:115], v[100:103], v[56:59]
buffer_load_dwordx4 a[28:31], v0, s[4:7], s69 offen offset:1024
s_waitcnt vmcnt(19)
v_mfma_f32_16x16x32_bf16 v[60:63], a[116:119], v[100:103], v[60:63]
buffer_load_dwordx4 a[32:35], v0, s[4:7], s69 offen offset:2048
s_and_b32 s68, s64, 15
s_mul_i32 s78, s68, 3072
v_mfma_f32_16x16x32_bf16 v[64:67], a[120:123], v[100:103], v[64:67]
buffer_load_dwordx4 a[36:39], v0, s[4:7], s62 offen offset:0
s_add_u32 s69, s78, s39
s_add_u32 s64, s3, 10
v_mfma_f32_16x16x32_bf16 v[68:71], a[124:127], v[100:103], v[68:71]
buffer_load_dwordx4 a[40:43], v0, s[4:7], s62 offen offset:1024
v_mfma_f32_16x16x32_bf16 v[56:59], a[128:131], v[112:115], v[56:59]
v_and_b32 v107, s49, v5
s_waitcnt vmcnt(20)
v_mfma_f32_16x16x32_bf16 v[60:63], a[132:135], v[112:115], v[60:63]
buffer_load_dwordx4 a[44:47], v0, s[4:7], s62 offen offset:2048
s_and_b32 s68, s64, 15
s_mul_i32 s78, s68, 3072
v_mfma_f32_16x16x32_bf16 v[64:67], a[136:139], v[112:115], v[64:67]
s_add_u32 s62, s78, s39
v_mfma_f32_16x16x32_bf16 v[68:71], a[140:143], v[112:115], v[68:71]
ds_read_b128 v[112:115], v15 offset:0
v_mfma_f32_16x16x32_bf16 v[56:59], a[144:147], v[116:119], v[56:59]
v_mfma_f32_16x16x32_bf16 v[60:63], a[148:151], v[116:119], v[60:63]
s_waitcnt vmcnt(20)
buffer_load_dwordx4 a[48:51], v0, s[4:7], s79 offen offset:0
v_mfma_f32_16x16x32_bf16 v[64:67], a[152:155], v[116:119], v[64:67]
v_mfma_f32_16x16x32_bf16 v[68:71], a[156:159], v[116:119], v[68:71]
ds_read_b128 v[116:119], v15 offset:64
v_mfma_f32_16x16x32_bf16 v[56:59], a[160:163], v[120:123], v[56:59]
v_mfma_f32_16x16x32_bf16 v[60:63], a[164:167], v[120:123], v[60:63]
v_mfma_f32_16x16x32_bf16 v[64:67], a[168:171], v[120:123], v[64:67]
v_mfma_f32_16x16x32_bf16 v[68:71], a[172:175], v[120:123], v[68:71]
ds_read_b128 v[120:123], v15 offset:128
s_nop 3
ds_write_b128 v18, v[56:59] offset:16384
s_add_u32 s64, s35, 0xa80000
ds_write_b128 v19, v[60:63] offset:16384
s_waitcnt vmcnt(19)
buffer_store_dword v126, v37, s[4:7], s64 offen sc1
s_lshl_b32 s68, s24, 14
ds_write_b128 v18, v[64:67] offset:16512
ds_write_b128 v19, v[68:71] offset:16512
buffer_load_dwordx4 a[52:55], v0, s[4:7], s79 offen offset:1024
buffer_load_dwordx4 a[56:59], v0, s[4:7], s79 offen offset:2048
v_add_u32 v37, s68, v0
ds_read_b128 a[132:135], v37 offset:1024
ds_read_b128 a[136:139], v37 offset:2048
ds_read_b128 a[140:143], v37 offset:3072
ds_read_b128 a[144:147], v37 offset:4096
buffer_load_dwordx4 a[60:63], v0, s[4:7], s66 offen offset:0
buffer_load_dwordx4 a[64:67], v0, s[4:7], s66 offen offset:1024
ds_read_b128 a[148:151], v37 offset:5120
ds_read_b128 a[152:155], v37 offset:6144
s_waitcnt lgkmcnt(6)
s_barrier
ds_read_b128 a[156:159], v37 offset:7168
s_waitcnt vmcnt(17)
s_barrier
s_add_u32 s78, s35, 0x520000
ds_read_b128 a[160:163], v37 offset:8192
ds_read_b128 v[56:59], v20 offset:16384
ds_read_b128 v[72:75], v12 offset:0
ds_read_b128 v[80:83], v13 offset:0
ds_read_b128 v[60:63], v20 offset:20480
ds_read_b128 v[64:67], v20 offset:24576
buffer_load_dwordx4 v[52:55], v14, s[4:7], s78 offen offset:3072 sc1
ds_read_b128 v[68:71], v20 offset:28672
s_waitcnt lgkmcnt(10)
ds_read_b128 a[164:167], v37 offset:9216
ds_read_b128 a[168:171], v37 offset:10240
ds_read_b128 a[172:175], v37 offset:11264
ds_read_b128 a[176:179], v37 offset:12288
s_waitcnt lgkmcnt(10)
ds_read_b128 a[180:183], v37 offset:13312
ds_read_b128 a[184:187], v37 offset:14336
ds_read_b128 a[188:191], v37 offset:15360
ds_read_b128 a[128:131], v37 offset:0
v_lshrrev_b32 v37, 4, v0
buffer_load_dwordx4 a[68:71], v0, s[4:7], s66 offen offset:2048
v_and_b32 v37, 14, v37
v_lshlrev_b32 v37, 1, v37
v_add3_u32 v37, v37, v124, 2
v_mul_u32_u24 v37, 0x84, v37
v_or_b32 v124, 0x2000, v12
s_waitcnt lgkmcnt(12)
v_mfma_f32_16x16x32_bf16 v[40:43], a[0:3], v[72:75], 0
v_mfma_f32_16x16x32_bf16 v[44:47], a[4:7], v[72:75], 0
s_waitcnt lgkmcnt(10)
s_waitcnt vmcnt(18)
v_add_f32 v56, v56, v60
v_mfma_f32_16x16x32_bf16 v[48:51], a[8:11], v[72:75], 0
s_waitcnt vmcnt(17)
ds_read_b128 v[72:75], v13 offset:5120
v_mfma_f32_16x16x32_bf16 v[40:43], a[12:15], v[80:83], v[40:43]
s_waitcnt lgkmcnt(9)
v_add_f32 v104, v104, v56
v_add_f32 v64, v64, v68
v_mfma_f32_16x16x32_bf16 v[44:47], a[16:19], v[80:83], v[44:47]
buffer_load_dwordx4 a[72:75], v0, s[4:7], s67 offen offset:0
v_add_f32 v57, v57, v61
v_add_f32 v58, v58, v62
v_add_f32 v59, v59, v63
v_add_f32 v104, v104, v64
v_add_f32 v65, v65, v69
v_add_f32 v105, v105, v57
s_waitcnt vmcnt(17)
v_mfma_f32_16x16x32_bf16 v[48:51], a[20:23], v[80:83], v[48:51]
ds_read_b128 v[80:83], v12 offset:6144
s_waitcnt vmcnt(15)
s_cbranch_vccnz SIG_27
buffer_store_dword v126, v2, s[4:7], s36 offen offset:1664
SRET_27:
v_add_f32 v66, v66, v70
buffer_load_dwordx4 a[76:79], v0, s[4:7], s67 offen offset:1024
v_add_f32 v106, v106, v58
v_add_f32 v67, v67, v71
v_add_f32 v107, v107, v59
v_add_f32 v105, v105, v65
v_add_f32 v106, v106, v66
v_add_f32 v107, v107, v67
v_mul_f32 v109, v104, v104
v_add_f32 v108, v104, v105
v_add_f32 v110, v106, v107
v_fmac_f32 v109, v105, v105
v_add_f32 v108, v108, v110
v_fmac_f32 v109, v106, v106
s_waitcnt lgkmcnt(1)
v_mfma_f32_16x16x32_bf16 v[40:43], a[132:135], v[72:75], v[40:43]
buffer_load_dwordx4 a[80:83], v0, s[4:7], s67 offen offset:2048
v_mfma_f32_16x16x32_bf16 v[44:47], a[136:139], v[72:75], v[44:47]
v_fmac_f32 v109, v107, v107
v_add_f32_dpp v108, v108, v108 row_ror:8 row_mask:0xf bank_mask:0xf
v_mfma_f32_16x16x32_bf16 v[48:51], a[140:143], v[72:75], v[48:51]
s_waitcnt lgkmcnt(0)
ds_read_b128 v[72:75], v13 offset:6144
v_mfma_f32_16x16x32_bf16 v[40:43], a[144:147], v[80:83], v[40:43]
v_add_f32_dpp v108, v109, v109 row_ror:8 row_mask:0xf bank_mask:0xc
v_cvt_pk_bf16_f32 v4, v104, v105
v_mfma_f32_16x16x32_bf16 v[44:47], a[148:151], v[80:83], v[44:47]
v_add_f32_dpp v108, v108, v108 row_half_mirror row_mask:0xf bank_mask:0xf
v_cvt_pk_bf16_f32 v5, v106, v107
v_mfma_f32_16x16x32_bf16 v[48:51], a[152:155], v[80:83], v[48:51]
ds_read_b128 v[80:83], v12 offset:7168
s_add_u32 s64, s27, 0x800000
buffer_store_dwordx2 v[4:5], v21, s[4:7], s64 offen
v_add_f32_dpp v108, v108, v108 quad_perm:[2,3,0,1] row_mask:0xf bank_mask:0xf
s_nop 1
v_add_f32_dpp v108, v108, v108 quad_perm:[1,0,3,2] row_mask:0xf bank_mask:0xf
s_add_u32 s79, s35, 0x520000
buffer_store_dword v108, v22, s[4:7], s79 offen offset:0
buffer_load_dwordx4 a[84:87], v0, s[4:7], s63 offen offset:0
s_waitcnt lgkmcnt(1)
v_mfma_f32_16x16x32_bf16 v[40:43], a[156:159], v[72:75], v[40:43]
v_mfma_f32_16x16x32_bf16 v[44:47], a[160:163], v[72:75], v[44:47]
v_mfma_f32_16x16x32_bf16 v[48:51], a[164:167], v[72:75], v[48:51]
s_waitcnt lgkmcnt(0)
ds_read_b128 v[72:75], v13 offset:7168
v_mfma_f32_16x16x32_bf16 v[40:43], a[168:171], v[80:83], v[40:43]
v_mfma_f32_16x16x32_bf16 v[44:47], a[172:175], v[80:83], v[44:47]
v_mfma_f32_16x16x32_bf16 v[48:51], a[176:179], v[80:83], v[48:51]
ds_read_b128 v[80:83], v12 offset:1024
s_waitcnt lgkmcnt(1)
v_mfma_f32_16x16x32_bf16 v[40:43], a[180:183], v[72:75], v[40:43]
v_mfma_f32_16x16x32_bf16 v[44:47], a[184:187], v[72:75], v[44:47]
v_mfma_f32_16x16x32_bf16 v[48:51], a[188:191], v[72:75], v[48:51]
s_waitcnt vmcnt(20) lgkmcnt(0)
ds_read_b128 v[72:75], v13 offset:1024
s_waitcnt vmcnt(19)
v_mfma_f32_16x16x32_bf16 v[40:43], a[24:27], v[80:83], v[40:43]
s_waitcnt vmcnt(18)
v_mfma_f32_16x16x32_bf16 v[44:47], a[28:31], v[80:83], v[44:47]
v_mfma_f32_16x16x32_bf16 v[48:51], a[32:35], v[80:83], v[48:51]
ds_read_b128 v[80:83], v12 offset:2048
buffer_load_dword v23, v3, s[4:7], s36 offen offset:1792 sc1
s_waitcnt vmcnt(18) lgkmcnt(1)
v_mfma_f32_16x16x32_bf16 v[40:43], a[36:39], v[72:75], v[40:43]
s_waitcnt vmcnt(17)
buffer_load_dword v39, v3, s[4:7], s36 offen offset:1664 sc1
s_waitcnt vmcnt(17)
v_mfma_f32_16x16x32_bf16 v[44:47], a[40:43], v[72:75], v[44:47]
v_mfma_f32_16x16x32_bf16 v[48:51], a[44:47], v[72:75], v[48:51]
s_waitcnt vmcnt(16) lgkmcnt(0)
ds_read_b128 v[72:75], v13 offset:2048
v_mfma_f32_16x16x32_bf16 v[40:43], a[48:51], v[80:83], v[40:43]
buffer_load_dwordx4 a[88:91], v0, s[4:7], s63 offen offset:1024
buffer_load_dwordx4 a[92:95], v0, s[4:7], s63 offen offset:2048
buffer_load_dwordx4 a[96:99], v0, s[4:7], s65 offen offset:0
buffer_load_dwordx4 a[100:103], v0, s[4:7], s65 offen offset:1024
buffer_load_dwordx4 a[104:107], v0, s[4:7], s65 offen offset:2048
buffer_load_dwordx4 a[116:119], v0, s[4:7], s69 offen offset:2048
buffer_load_dwordx4 a[112:115], v0, s[4:7], s69 offen offset:1024
buffer_load_dwordx4 a[124:127], v0, s[4:7], s62 offen offset:1024
buffer_load_dwordx4 a[108:111], v0, s[4:7], s69 offen offset:0
buffer_load_dwordx4 a[120:123], v0, s[4:7], s62 offen offset:0
s_waitcnt vmcnt(24)
v_mfma_f32_16x16x32_bf16 v[44:47], a[52:55], v[80:83], v[44:47]
s_waitcnt vmcnt(20)
v_add_f32 v52, v52, v54
v_add_f32 v53, v53, v55
v_mfma_f32_16x16x32_bf16 v[48:51], a[56:59], v[80:83], v[48:51]
s_waitcnt lgkmcnt(0)
ds_read_b128 v[80:83], v12 offset:3072
s_waitcnt vmcnt(19)
v_mfma_f32_16x16x32_bf16 v[40:43], a[60:63], v[72:75], v[40:43]
buffer_load_dword v127, v37, s[4:7], s37 offen sc1
v_permlane32_swap_b32 v52, v53
v_mfma_f32_16x16x32_bf16 v[44:47], a[64:67], v[72:75], v[44:47]
v_add_f32 v54, v52, v53
v_mov_b32 v55, v54
v_mfma_f32_16x16x32_bf16 v[48:51], a[68:71], v[72:75], v[48:51]
ds_read_b128 v[72:75], v13 offset:3072
v_permlane16_swap_b32 v54, v55
v_add_f32 v52, v54, v55
v_mul_f32 v104, v36, v52
v_mul_f32 v108, v36, v52
s_nop 1
v_permlane32_swap_b32 v104, v108
v_fma_f32 v108, -v104, v104, v108
v_max_f32 v108, 0, v108
v_add_f32 v108, s45, v108
v_rsq_f32 v108, v108
s_nop 0
v_mul_f32_e64 v104, -v104, v108
v_mul_f32 v120, v104, v120
v_mul_f32 v121, v104, v121
s_waitcnt vmcnt(19) lgkmcnt(1)
v_mfma_f32_16x16x32_bf16 v[40:43], a[72:75], v[80:83], v[40:43]
s_waitcnt vmcnt(17)
v_mul_f32 v122, v104, v122
v_mul_f32 v123, v104, v123
v_mfma_f32_16x16x32_bf16 v[44:47], a[76:79], v[80:83], v[44:47]
v_mul_f32 v116, v104, v116
v_mul_f32 v117, v104, v117
v_mul_f32 v118, v104, v118
v_mul_f32 v119, v104, v119
v_mul_f32 v109, s46, v108
v_mul_f32 v105, s46, v104
v_mul_f32 v112, v105, v112
v_mul_f32 v113, v105, v113
v_mul_f32 v114, v105, v114
v_mul_f32 v115, v105, v115
s_waitcnt vmcnt(16)
v_mfma_f32_16x16x32_bf16 v[48:51], a[80:83], v[80:83], v[48:51]
ds_read_b128 v[80:83], v12 offset:4096
s_waitcnt vmcnt(14)
s_cbranch_vccnz SIG_30
buffer_store_dword v126, v2, s[4:7], s36 offen offset:1536
SRET_30:
s_waitcnt vmcnt(13)
v_cmp_eq_u32_e64 s[76:77], v126, v23
s_waitcnt lgkmcnt(1)
v_mfma_f32_16x16x32_bf16 v[40:43], a[84:87], v[72:75], v[40:43]
s_waitcnt vmcnt(12)
v_cmp_eq_u32_e64 s[58:59], v126, v39
s_cmp_eq_u64 s[76:77], s[56:57]
s_cbranch_scc0 CHK_32
CRET_32:
s_add_u32 s68, s30, 0x808000
s_add_u32 m0, s38, 0x1c000
s_cmp_eq_u64 s[58:59], s[56:57]
s_cbranch_scc0 CHK_33
CRET_33:
buffer_load_dwordx4 v0, s[4:7], s68 offen offset:0 sc1 lds
s_waitcnt vmcnt(12)
buffer_load_dwordx4 v0, s[4:7], s68 offen offset:1024 sc1 lds
buffer_load_dwordx4 v0, s[4:7], s68 offen offset:2048 sc1 lds
buffer_load_dwordx4 v0, s[4:7], s68 offen offset:3072 sc1 lds
s_add_u32 s78, s30, 0x804000
s_add_u32 m0, s38, 0x20000
v_mfma_f32_16x16x32_bf16 v[44:47], a[88:91], v[72:75], v[44:47]
buffer_load_dwordx4 v0, s[4:7], s78 offen offset:0 sc1 lds
buffer_load_dwordx4 v0, s[4:7], s78 offen offset:1024 sc1 lds
buffer_load_dwordx4 v0, s[4:7], s78 offen offset:2048 sc1 lds
s_waitcnt vmcnt(17)
v_mfma_f32_16x16x32_bf16 v[48:51], a[92:95], v[72:75], v[48:51]
ds_read_b128 v[72:75], v13 offset:4096
buffer_load_dwordx4 v0, s[4:7], s78 offen offset:3072 sc1 lds
s_waitcnt vmcnt(17) lgkmcnt(1)
v_mfma_f32_16x16x32_bf16 v[40:43], a[96:99], v[80:83], v[40:43]
s_waitcnt vmcnt(16)
v_mfma_f32_16x16x32_bf16 v[44:47], a[100:103], v[80:83], v[44:47]
buffer_load_dword v23, v3, s[4:7], s36 offen offset:1536 sc1
s_waitcnt vmcnt(16)
v_mfma_f32_16x16x32_bf16 v[48:51], a[104:107], v[80:83], v[48:51]
ds_read_b128 v[80:83], v12 offset:5120
s_waitcnt vmcnt(15) lgkmcnt(1)
v_mfma_f32_16x16x32_bf16 v[48:51], a[116:119], v[72:75], v[48:51]
s_waitcnt lgkmcnt(0)
v_mfma_f32_16x16x32_bf16 v[48:51], a[128:131], v[80:83], v[48:51]
s_waitcnt vmcnt(14)
v_mfma_f32_16x16x32_bf16 v[44:47], a[112:115], v[72:75], v[44:47]
s_nop 5
v_fmac_f32 v120, v48, v108
v_fmac_f32 v121, v49, v108
v_fmac_f32 v122, v50, v108
v_fmac_f32 v123, v51, v108
v_cvt_pk_bf16_f32 v92, v120, v121
v_cvt_pk_bf16_f32 v93, v122, v123
ds_read_b128 v[120:123], v15 offset:128
ds_write_b64 v16, v[92:93] offset:512
s_waitcnt vmcnt(13)
v_mfma_f32_16x16x32_bf16 v[44:47], a[124:127], v[80:83], v[44:47]
s_nop 7
v_fmac_f32 v116, v44, v108
v_fmac_f32 v117, v45, v108
v_fmac_f32 v118, v46, v108
v_fmac_f32 v119, v47, v108
v_cvt_pk_bf16_f32 v90, v116, v117
v_cvt_pk_bf16_f32 v91, v118, v119
s_waitcnt vmcnt(12)
v_mfma_f32_16x16x32_bf16 v[40:43], a[108:111], v[72:75], v[40:43]
ds_read_b128 v[116:119], v15 offset:64
ds_read_b64_tr_b16 v[92:93], v17 offset:512
s_waitcnt vmcnt(11)
v_mfma_f32_16x16x32_bf16 v[40:43], a[120:123], v[80:83], v[40:43]
s_waitcnt vmcnt(10)
v_cmp_eq_u32_e64 s[76:77], v126, v127
s_nop 5
v_fmac_f32 v112, v40, v109
s_cmp_eq_u64 s[76:77], -1
s_cbranch_scc0 CHK_36
CRET_36:
v_fmac_f32 v113, v41, v109
v_fmac_f32 v114, v42, v109
v_fmac_f32 v115, v43, v109
v_cvt_pk_bf16_f32 v88, v112, v113
v_cvt_pk_bf16_f32 v89, v114, v115
v_or_b32 v37, 0x200, v14
ds_read_b128 v[112:115], v15 offset:0
s_waitcnt vmcnt(5)
s_barrier
s_add_u32 s66, s35, 0x520000
ds_read_b128 v[76:79], v12 offset:16384
ds_read_b128 v[84:87], v13 offset:16384
buffer_load_dwordx4 v[68:71], v14, s[4:7], s66 offen offset:2048 sc1
s_waitcnt lgkmcnt(1)
v_mfma_f32_16x16x32_bf16 v[56:59], a[0:3], v[76:79], 0
v_mfma_f32_16x16x32_bf16 v[60:63], a[4:7], v[76:79], 0
s_waitcnt lgkmcnt(0)
v_mfma_f32_16x16x32_bf16 v[64:67], a[8:11], v[76:79], 0
ds_read_b128 v[76:79], v13 offset:21504
v_mfma_f32_16x16x32_bf16 v[56:59], a[12:15], v[84:87], v[56:59]
v_mfma_f32_16x16x32_bf16 v[60:63], a[16:19], v[84:87], v[60:63]
v_mfma_f32_16x16x32_bf16 v[64:67], a[20:23], v[84:87], v[64:67]
ds_read_b128 v[84:87], v12 offset:22528
s_waitcnt vmcnt(1)
v_cmp_eq_u32_e64 s[58:59], v126, v23
s_nop 0
s_cmp_eq_u64 s[58:59], s[56:57]
s_cbranch_scc0 CHK_35
CRET_35:
s_waitcnt lgkmcnt(1)
v_mfma_f32_16x16x32_bf16 v[56:59], a[132:135], v[76:79], v[56:59]
v_mfma_f32_16x16x32_bf16 v[60:63], a[136:139], v[76:79], v[60:63]
v_mfma_f32_16x16x32_bf16 v[64:67], a[140:143], v[76:79], v[64:67]
ds_read_b128 v[76:79], v13 offset:22528
s_waitcnt lgkmcnt(1)
v_mfma_f32_16x16x32_bf16 v[56:59], a[144:147], v[84:87], v[56:59]
v_mfma_f32_16x16x32_bf16 v[60:63], a[148:151], v[84:87], v[60:63]
v_mfma_f32_16x16x32_bf16 v[64:67], a[152:155], v[84:87], v[64:67]
ds_read_b128 v[84:87], v12 offset:23552
s_waitcnt lgkmcnt(1)
v_mfma_f32_16x16x32_bf16 v[56:59], a[156:159], v[76:79], v[56:59]
v_mfma_f32_16x16x32_bf16 v[60:63], a[160:163], v[76:79], v[60:63]
v_mfma_f32_16x16x32_bf16 v[64:67], a[164:167], v[76:79], v[64:67]
ds_read_b128 v[76:79], v13 offset:23552
s_waitcnt lgkmcnt(1)
v_mfma_f32_16x16x32_bf16 v[56:59], a[168:171], v[84:87], v[56:59]
v_mfma_f32_16x16x32_bf16 v[60:63], a[172:175], v[84:87], v[60:63]
v_mfma_f32_16x16x32_bf16 v[64:67], a[176:179], v[84:87], v[64:67]
ds_read_b128 v[84:87], v12 offset:17408
s_waitcnt lgkmcnt(1)
v_mfma_f32_16x16x32_bf16 v[56:59], a[180:183], v[76:79], v[56:59]
v_mfma_f32_16x16x32_bf16 v[60:63], a[184:187], v[76:79], v[60:63]
v_mfma_f32_16x16x32_bf16 v[64:67], a[188:191], v[76:79], v[64:67]
s_waitcnt vmcnt(0)
ds_read_b128 v[76:79], v13 offset:17408
s_waitcnt lgkmcnt(1)
v_mfma_f32_16x16x32_bf16 v[56:59], a[24:27], v[84:87], v[56:59]
v_add_f32 v68, v68, v70
v_add_f32 v69, v69, v71
v_mfma_f32_16x16x32_bf16 v[60:63], a[28:31], v[84:87], v[60:63]
s_nop 0
v_permlane32_swap_b32 v68, v69
v_mfma_f32_16x16x32_bf16 v[64:67], a[32:35], v[84:87], v[64:67]
ds_read_b128 v[84:87], v12 offset:18432
v_add_f32 v70, v68, v69
v_mov_b32 v71, v70
s_nop 1
v_permlane16_swap_b32 v70, v71
v_add_f32 v68, v70, v71
v_mul_f32 v104, v36, v68
v_mul_f32 v108, v36, v68
s_nop 1
v_permlane32_swap_b32 v104, v108
v_fma_f32 v108, -v104, v104, v108
v_max_f32 v108, 0, v108
v_add_f32 v108, s45, v108
v_rsq_f32 v108, v108
s_waitcnt lgkmcnt(1)
v_mfma_f32_16x16x32_bf16 v[56:59], a[36:39], v[76:79], v[56:59]
v_mul_f32_e64 v104, -v104, v108
v_mul_f32 v120, v104, v120
v_mfma_f32_16x16x32_bf16 v[60:63], a[40:43], v[76:79], v[60:63]
v_mul_f32 v121, v104, v121
v_mul_f32 v122, v104, v122
v_mfma_f32_16x16x32_bf16 v[64:67], a[44:47], v[76:79], v[64:67]
s_waitcnt lgkmcnt(0)
ds_read_b128 v[76:79], v13 offset:18432
v_mfma_f32_16x16x32_bf16 v[56:59], a[48:51], v[84:87], v[56:59]
v_mul_f32 v123, v104, v123
v_mul_f32 v116, v104, v116
v_mfma_f32_16x16x32_bf16 v[60:63], a[52:55], v[84:87], v[60:63]
v_mul_f32 v117, v104, v117
v_mul_f32 v118, v104, v118
v_mfma_f32_16x16x32_bf16 v[64:67], a[56:59], v[84:87], v[64:67]
ds_read_b128 v[84:87], v12 offset:19456
v_mul_f32 v119, v104, v119
v_mul_f32 v105, s46, v104
v_mul_f32 v109, s46, v108
v_mul_f32 v112, v105, v112
v_mul_f32 v113, v105, v113
v_mul_f32 v114, v105, v114
v_mul_f32 v115, v105, v115
s_waitcnt lgkmcnt(1)
v_mfma_f32_16x16x32_bf16 v[56:59], a[60:63], v[76:79], v[56:59]
v_mfma_f32_16x16x32_bf16 v[60:63], a[64:67], v[76:79], v[60:63]
v_mfma_f32_16x16x32_bf16 v[64:67], a[68:71], v[76:79], v[64:67]
s_waitcnt lgkmcnt(0)
ds_read_b128 v[76:79], v13 offset:19456
v_mfma_f32_16x16x32_bf16 v[56:59], a[72:75], v[84:87], v[56:59]
v_mfma_f32_16x16x32_bf16 v[60:63], a[76:79], v[84:87], v[60:63]
v_mfma_f32_16x16x32_bf16 v[64:67], a[80:83], v[84:87], v[64:67]
ds_read_b128 v[84:87], v12 offset:20480
s_waitcnt lgkmcnt(1)
v_mfma_f32_16x16x32_bf16 v[56:59], a[84:87], v[76:79], v[56:59]
v_mfma_f32_16x16x32_bf16 v[60:63], a[88:91], v[76:79], v[60:63]
v_mfma_f32_16x16x32_bf16 v[64:67], a[92:95], v[76:79], v[64:67]
s_waitcnt lgkmcnt(0)
ds_read_b128 v[76:79], v13 offset:20480
v_mfma_f32_16x16x32_bf16 v[56:59], a[96:99], v[84:87], v[56:59]
v_mfma_f32_16x16x32_bf16 v[60:63], a[100:103], v[84:87], v[60:63]
v_mfma_f32_16x16x32_bf16 v[64:67], a[104:107], v[84:87], v[64:67]
ds_read_b128 v[84:87], v12 offset:21504
s_waitcnt lgkmcnt(1)
v_mfma_f32_16x16x32_bf16 v[64:67], a[116:119], v[76:79], v[64:67]
v_mfma_f32_16x16x32_bf16 v[60:63], a[112:115], v[76:79], v[60:63]
v_mfma_f32_16x16x32_bf16 v[56:59], a[108:111], v[76:79], v[56:59]
s_waitcnt lgkmcnt(0)
s_barrier
v_mfma_f32_16x16x32_bf16 v[64:67], a[128:131], v[84:87], v[64:67]
s_add_u32 s67, s30, 0x800000
s_add_u32 m0, s38, 0x18000
s_add_u32 s64, s35, 0x520000
v_mfma_f32_16x16x32_bf16 v[60:63], a[124:127], v[84:87], v[60:63]
buffer_load_dwordx4 v0, s[4:7], s67 offen offset:0 sc1 lds
v_mfma_f32_16x16x32_bf16 v[56:59], a[120:123], v[84:87], v[56:59]
buffer_load_dwordx4 v0, s[4:7], s67 offen offset:1024 sc1 lds
s_nop 0
v_fmac_f32 v120, v64, v108
buffer_load_dwordx4 v0, s[4:7], s67 offen offset:2048 sc1 lds
v_fmac_f32 v121, v65, v108
buffer_load_dwordx4 v0, s[4:7], s67 offen offset:3072 sc1 lds
s_lshl2_add_u32 s79, s24, s3
s_lshl2_add_u32 s63, s24, s3
ds_read_b128 v[72:75], v12 offset:32768
s_add_u32 s65, s79, 0
ds_read_b128 v[76:79], v13 offset:32768
s_add_u32 s69, s63, 2
ds_read_b128 v[80:83], v12 offset:33792
s_and_b32 s62, s65, 14
ds_read_b128 v[84:87], v13 offset:33792
s_and_b32 s68, s69, 14
s_lshl_b32 s78, s62, 9
s_lshl_b32 s66, s68, 9
s_add_u32 s67, s78, s54
s_add_u32 m0, s71, 0x1e000
s_nop 0
buffer_load_dwordx4 v0, s[4:7], s67 offen sc1 lds
s_add_u32 s79, s66, s54
s_add_u32 m0, s71, 0x1e400
s_nop 0
buffer_load_dwordx4 v0, s[4:7], s79 offen sc1 lds
v_fmac_f32 v122, v66, v108
v_fmac_f32 v123, v67, v108
v_cvt_pk_bf16_f32 v98, v120, v121
v_cvt_pk_bf16_f32 v99, v122, v123
ds_write_b64 v16, v[98:99] offset:0
v_fmac_f32 v116, v60, v108
v_fmac_f32 v117, v61, v108
v_fmac_f32 v118, v62, v108
v_fmac_f32 v119, v63, v108
v_cvt_pk_bf16_f32 v96, v116, v117
v_cvt_pk_bf16_f32 v97, v118, v119
v_fmac_f32 v112, v56, v109
v_fmac_f32 v113, v57, v109
v_fmac_f32 v114, v58, v109
v_fmac_f32 v115, v59, v109
v_mfma_f32_16x16x16_bf16 v[60:63], v[90:91], v[88:89], v[32:35]
s_waitcnt lgkmcnt(4)
v_cvt_pk_bf16_f32 v94, v112, v113
v_cvt_pk_bf16_f32 v95, v114, v115
v_mfma_f32_16x16x16_bf16 v[56:59], v[96:97], v[88:89], 0
buffer_load_dwordx4 v[52:55], v14, s[4:7], s64 offen offset:1024 sc1
v_mfma_f32_16x16x32_bf16 v[40:43], a[0:3], v[72:75], 0
ds_read_b128 v[120:123], v15 offset:128
s_waitcnt lgkmcnt(3)
v_mfma_f32_16x16x32_bf16 v[44:47], a[4:7], v[72:75], 0
s_nop 2
v_cndmask_b32_e64 v56, v60, v56, s[92:93]
v_cndmask_b32_e64 v57, v61, v57, s[94:95]
v_cndmask_b32_e64 v58, v62, v58, s[96:97]
v_cndmask_b32_e64 v59, v63, v59, s[98:99]
v_max3_f32 v112, v56, v57, v58
v_max_f32 v112, v112, v59
v_mov_b32 v113, v112
v_mfma_f32_16x16x32_bf16 v[48:51], a[8:11], v[72:75], 0
ds_read_b64_tr_b16 v[98:99], v17 offset:0
v_permlane32_swap_b32 v112, v113
v_max_f32 v112, v112, v113
v_mov_b32 v113, v112
v_mfma_f32_16x16x32_bf16 v[40:43], a[12:15], v[76:79], v[40:43]
ds_read_b128 v[72:75], v12 offset:34816
v_permlane16_swap_b32 v112, v113
v_max_f32 v112, v112, v113
v_sub_f32 v56, v56, v112
v_sub_f32 v57, v57, v112
v_sub_f32 v58, v58, v112
v_sub_f32 v59, v59, v112
v_exp_f32 v56, v56
v_exp_f32 v57, v57
v_exp_f32 v58, v58
v_exp_f32 v59, v59
v_cvt_pk_bf16_f32 v114, v56, v57
v_cvt_pk_bf16_f32 v115, v58, v59
v_and_b32 v116, v26, v114
v_and_b32 v117, v27, v115
v_mfma_f32_16x16x16_bf16 v[68:71], v[24:25], v[114:115], 0
v_xor_b32 v118, v116, v114
v_xor_b32 v119, v117, v115
s_waitcnt lgkmcnt(1)
v_mfma_f32_16x16x16_bf16 v[64:67], v[98:99], v[116:117], 0
ds_read_b128 v[112:115], v15 offset:0
v_mfma_f32_16x16x16_bf16 v[64:67], v[92:93], v[118:119], v[64:67]
ds_read_b128 v[116:119], v15 offset:64
s_nop 0
v_rcp_f32 v68, v68
v_mfma_f32_16x16x32_bf16 v[44:47], a[16:19], v[76:79], v[44:47]
v_mfma_f32_16x16x32_bf16 v[48:51], a[20:23], v[76:79], v[48:51]
ds_read_b128 v[76:79], v13 offset:34816
s_nop 1
v_mul_f32 v64, v64, v68
v_mul_f32 v65, v65, v68
v_mul_f32 v66, v66, v68
v_mul_f32 v67, v67, v68
v_cvt_pk_bf16_f32 v60, v64, v65
v_cvt_pk_bf16_f32 v61, v66, v67
v_mfma_f32_16x16x32_bf16 v[40:43], a[24:27], v[80:83], v[40:43]
s_add_u32 s63, s31, 0xb21000
buffer_store_dwordx2 v[60:61], v0, s[4:7], s63 offen
v_mfma_f32_16x16x32_bf16 v[44:47], a[28:31], v[80:83], v[44:47]
v_mfma_f32_16x16x32_bf16 v[48:51], a[32:35], v[80:83], v[48:51]
ds_read_b128 v[80:83], v12 offset:35840
v_mfma_f32_16x16x32_bf16 v[40:43], a[36:39], v[84:87], v[40:43]
v_mfma_f32_16x16x32_bf16 v[44:47], a[40:43], v[84:87], v[44:47]
s_waitcnt lgkmcnt(2)
v_mfma_f32_16x16x32_bf16 v[48:51], a[44:47], v[84:87], v[48:51]
ds_read_b128 v[84:87], v13 offset:35840
v_mfma_f32_16x16x32_bf16 v[40:43], a[48:51], v[72:75], v[40:43]
v_mfma_f32_16x16x32_bf16 v[44:47], a[52:55], v[72:75], v[44:47]
s_waitcnt lgkmcnt(2)
v_mfma_f32_16x16x32_bf16 v[48:51], a[56:59], v[72:75], v[48:51]
ds_read_b128 v[72:75], v12 offset:36864
v_mfma_f32_16x16x32_bf16 v[40:43], a[60:63], v[76:79], v[40:43]
v_mfma_f32_16x16x32_bf16 v[44:47], a[64:67], v[76:79], v[44:47]
s_waitcnt lgkmcnt(2)
v_mfma_f32_16x16x32_bf16 v[48:51], a[68:71], v[76:79], v[48:51]
ds_read_b128 v[76:79], v13 offset:36864
v_mfma_f32_16x16x32_bf16 v[40:43], a[72:75], v[80:83], v[40:43]
v_mfma_f32_16x16x32_bf16 v[44:47], a[76:79], v[80:83], v[44:47]
s_waitcnt lgkmcnt(2)
v_mfma_f32_16x16x32_bf16 v[48:51], a[80:83], v[80:83], v[48:51]
ds_read_b128 v[80:83], v12 offset:37888
v_mfma_f32_16x16x32_bf16 v[40:43], a[84:87], v[84:87], v[40:43]
v_mfma_f32_16x16x32_bf16 v[44:47], a[88:91], v[84:87], v[44:47]
s_waitcnt lgkmcnt(2)
v_mfma_f32_16x16x32_bf16 v[48:51], a[92:95], v[84:87], v[48:51]
ds_read_b128 v[84:87], v13 offset:37888
v_mfma_f32_16x16x32_bf16 v[40:43], a[96:99], v[72:75], v[40:43]
v_mfma_f32_16x16x32_bf16 v[44:47], a[100:103], v[72:75], v[44:47]
s_waitcnt lgkmcnt(2)
v_mfma_f32_16x16x32_bf16 v[48:51], a[104:107], v[72:75], v[48:51]
ds_read_b128 v[72:75], v12 offset:38912
v_mfma_f32_16x16x32_bf16 v[40:43], a[108:111], v[76:79], v[40:43]
v_mfma_f32_16x16x32_bf16 v[44:47], a[112:115], v[76:79], v[44:47]
s_waitcnt lgkmcnt(2)
v_mfma_f32_16x16x32_bf16 v[48:51], a[116:119], v[76:79], v[48:51]
ds_read_b128 v[76:79], v13 offset:38912
v_mfma_f32_16x16x32_bf16 v[40:43], a[120:123], v[80:83], v[40:43]
v_mfma_f32_16x16x32_bf16 v[44:47], a[124:127], v[80:83], v[44:47]
s_waitcnt lgkmcnt(2)
v_mfma_f32_16x16x32_bf16 v[48:51], a[128:131], v[80:83], v[48:51]
ds_read_b128 v[80:83], v12 offset:39936
s_waitcnt vmcnt(1)
v_mfma_f32_16x16x32_bf16 v[40:43], a[132:135], v[84:87], v[40:43]
v_add_f32 v52, v52, v54
v_add_f32 v53, v53, v55
v_mfma_f32_16x16x32_bf16 v[44:47], a[136:139], v[84:87], v[44:47]
s_waitcnt lgkmcnt(2)
v_permlane32_swap_b32 v52, v53
v_mfma_f32_16x16x32_bf16 v[48:51], a[140:143], v[84:87], v[48:51]
ds_read_b128 v[84:87], v13 offset:39936
v_add_f32 v54, v52, v53
v_mfma_f32_16x16x32_bf16 v[48:51], a[152:155], v[72:75], v[48:51]
v_mov_b32 v55, v54
v_mfma_f32_16x16x32_bf16 v[40:43], a[144:147], v[72:75], v[40:43]
s_waitcnt lgkmcnt(2)
s_waitcnt vmcnt(0)
s_cbranch_vccnz SIG_34
buffer_store_dword v126, v2, s[4:7], s36 offen offset:2432
SRET_34:
v_mfma_f32_16x16x32_bf16 v[44:47], a[148:151], v[72:75], v[44:47]
v_permlane16_swap_b32 v54, v55
v_mfma_f32_16x16x32_bf16 v[48:51], a[164:167], v[76:79], v[48:51]
v_add_f32 v52, v54, v55
v_mul_f32 v104, v36, v52
v_mfma_f32_16x16x32_bf16 v[40:43], a[156:159], v[76:79], v[40:43]
s_waitcnt lgkmcnt(1)
v_mul_f32 v108, v36, v52
v_mfma_f32_16x16x32_bf16 v[44:47], a[160:163], v[76:79], v[44:47]
s_nop 0
v_permlane32_swap_b32 v104, v108
v_mfma_f32_16x16x32_bf16 v[48:51], a[176:179], v[80:83], v[48:51]
s_waitcnt lgkmcnt(0)
s_barrier
v_mfma_f32_16x16x32_bf16 v[40:43], a[168:171], v[80:83], v[40:43]
s_add_u32 s65, s35, 0x520000
v_fma_f32 v108, -v104, v104, v108
v_max_f32 v108, 0, v108
v_mfma_f32_16x16x32_bf16 v[44:47], a[172:175], v[80:83], v[44:47]
ds_read_b128 v[72:75], v12 offset:0
ds_read_b128 v[76:79], v13 offset:0
ds_read_b128 v[80:83], v12 offset:1024
v_mfma_f32_16x16x32_bf16 v[48:51], a[188:191], v[84:87], v[48:51]
buffer_load_dwordx4 v[68:71], v14, s[4:7], s65 offen offset:0 sc1
v_mfma_f32_16x16x32_bf16 v[40:43], a[180:183], v[84:87], v[40:43]
v_add_f32 v108, s45, v108
v_rsq_f32 v108, v108
v_mfma_f32_16x16x32_bf16 v[44:47], a[184:187], v[84:87], v[44:47]
ds_read_b128 v[84:87], v13 offset:1024
v_mul_f32_e64 v104, -v104, v108
v_mul_f32 v120, v104, v120
v_mul_f32 v121, v104, v121
v_mul_f32 v122, v104, v122
v_mul_f32 v123, v104, v123
v_fmac_f32 v120, v48, v108
v_fmac_f32 v121, v49, v108
v_fmac_f32 v122, v50, v108
v_fmac_f32 v123, v51, v108
v_cvt_pk_bf16_f32 v92, v120, v121
v_cvt_pk_bf16_f32 v93, v122, v123
v_mul_f32 v116, v104, v116
v_mul_f32 v117, v104, v117
v_mul_f32 v118, v104, v118
s_waitcnt lgkmcnt(3)
v_mfma_f32_16x16x32_bf16 v[56:59], a[0:3], v[72:75], 0
ds_write_b64 v16, v[92:93] offset:512
s_waitcnt lgkmcnt(3)
v_mfma_f32_16x16x32_bf16 v[60:63], a[4:7], v[72:75], 0
ds_read_b128 v[120:123], v15 offset:128
v_mul_f32 v119, v104, v119
v_mfma_f32_16x16x32_bf16 v[64:67], a[8:11], v[72:75], 0
ds_read_b128 v[72:75], v12 offset:2048
v_mul_f32 v105, s46, v104
v_mfma_f32_16x16x32_bf16 v[56:59], a[12:15], v[76:79], v[56:59]
buffer_load_dwordx4 a[0:3], v0, s[4:7], s40 offen offset:0
s_waitcnt lgkmcnt(4)
v_mfma_f32_16x16x32_bf16 v[60:63], a[16:19], v[76:79], v[60:63]
buffer_load_dwordx4 a[12:15], v0, s[4:7], s40 offen offset:1024
v_mfma_f32_16x16x32_bf16 v[64:67], a[20:23], v[76:79], v[64:67]
ds_read_b128 v[76:79], v13 offset:2048
v_fmac_f32 v116, v44, v108
v_mfma_f32_16x16x32_bf16 v[56:59], a[24:27], v[80:83], v[56:59]
buffer_load_dwordx4 a[24:27], v0, s[4:7], s40 offen offset:2048
s_waitcnt lgkmcnt(4)
v_mfma_f32_16x16x32_bf16 v[60:63], a[28:31], v[80:83], v[60:63]
v_fmac_f32 v117, v45, v108
v_fmac_f32 v118, v46, v108
v_mfma_f32_16x16x32_bf16 v[64:67], a[32:35], v[80:83], v[64:67]
ds_read_b128 v[80:83], v12 offset:3072
v_fmac_f32 v119, v47, v108
v_mfma_f32_16x16x32_bf16 v[56:59], a[36:39], v[84:87], v[56:59]
ds_read_b64_tr_b16 v[92:93], v17 offset:512
v_mul_f32 v109, s46, v108
v_mfma_f32_16x16x32_bf16 v[60:63], a[40:43], v[84:87], v[60:63]
s_waitcnt lgkmcnt(3)
v_mul_f32 v112, v105, v112
v_mul_f32 v113, v105, v113
v_mfma_f32_16x16x32_bf16 v[64:67], a[44:47], v[84:87], v[64:67]
ds_read_b128 v[84:87], v13 offset:3072
v_mul_f32 v114, v105, v114
v_mul_f32 v115, v105, v115
v_cvt_pk_bf16_f32 v90, v116, v117
v_cvt_pk_bf16_f32 v91, v118, v119
v_fmac_f32 v112, v40, v109
v_fmac_f32 v113, v41, v109
v_fmac_f32 v114, v42, v109
v_fmac_f32 v115, v43, v109
v_mfma_f32_16x16x16_bf16 v[44:47], v[96:97], v[94:95], v[32:35]
buffer_load_dwordx4 a[36:39], v0, s[4:7], s40 offen offset:3072
v_mfma_f32_16x16x16_bf16 v[40:43], v[90:91], v[94:95], 0
v_cvt_pk_bf16_f32 v88, v112, v113
v_cvt_pk_bf16_f32 v89, v114, v115
v_mfma_f32_16x16x32_bf16 v[56:59], a[48:51], v[72:75], v[56:59]
s_add_u32 s69, s40, 0x1000
buffer_load_dwordx4 a[48:51], v0, s[4:7], s69 offen offset:0
s_waitcnt lgkmcnt(3)
v_mfma_f32_16x16x32_bf16 v[60:63], a[52:55], v[72:75], v[60:63]
s_nop 0
v_cndmask_b32_e64 v40, v44, v40, s[92:93]
v_cndmask_b32_e64 v41, v45, v41, s[94:95]
v_mfma_f32_16x16x32_bf16 v[64:67], a[56:59], v[72:75], v[64:67]
ds_read_b128 v[72:75], v12 offset:4096
v_cndmask_b32_e64 v42, v46, v42, s[96:97]
v_cndmask_b32_e64 v43, v47, v43, s[98:99]
v_max3_f32 v112, v40, v41, v42
v_max_f32 v112, v112, v43
v_mfma_f32_16x16x32_bf16 v[56:59], a[60:63], v[76:79], v[56:59]
buffer_load_dwordx4 a[60:63], v0, s[4:7], s69 offen offset:1024
s_waitcnt lgkmcnt(2)
v_mfma_f32_16x16x32_bf16 v[60:63], a[64:67], v[76:79], v[60:63]
v_mov_b32 v113, v112
buffer_load_dword v39, v3, s[4:7], s36 offen offset:2432 sc1
v_mfma_f32_16x16x32_bf16 v[64:67], a[68:71], v[76:79], v[64:67]
ds_read_b128 v[76:79], v13 offset:4096
v_permlane32_swap_b32 v112, v113
v_max_f32 v112, v112, v113
v_mfma_f32_16x16x32_bf16 v[56:59], a[72:75], v[80:83], v[56:59]
buffer_load_dwordx4 a[72:75], v0, s[4:7], s69 offen offset:2048
s_waitcnt lgkmcnt(2)
v_mfma_f32_16x16x32_bf16 v[60:63], a[76:79], v[80:83], v[60:63]
v_mov_b32 v113, v112
v_mfma_f32_16x16x32_bf16 v[64:67], a[80:83], v[80:83], v[64:67]
ds_read_b128 v[80:83], v12 offset:5120
v_permlane16_swap_b32 v112, v113
v_max_f32 v112, v112, v113
v_mfma_f32_16x16x32_bf16 v[56:59], a[84:87], v[84:87], v[56:59]
buffer_load_dwordx4 a[84:87], v0, s[4:7], s69 offen offset:3072
s_waitcnt lgkmcnt(2)
v_mfma_f32_16x16x32_bf16 v[60:63], a[88:91], v[84:87], v[60:63]
v_sub_f32 v40, v40, v112
v_sub_f32 v41, v41, v112
v_mfma_f32_16x16x32_bf16 v[64:67], a[92:95], v[84:87], v[64:67]
ds_read_b128 v[84:87], v13 offset:5120
v_sub_f32 v42, v42, v112
v_sub_f32 v43, v43, v112
v_exp_f32 v40, v40
v_exp_f32 v41, v41
v_exp_f32 v42, v42
v_exp_f32 v43, v43
v_cvt_pk_bf16_f32 v114, v40, v41
v_cvt_pk_bf16_f32 v115, v42, v43
v_and_b32 v116, v26, v114
v_and_b32 v117, v27, v115
v_mfma_f32_16x16x16_bf16 v[52:55], v[24:25], v[114:115], 0
s_waitcnt vmcnt(9)
v_xor_b32 v118, v116, v114
v_xor_b32 v119, v117, v115
v_mfma_f32_16x16x16_bf16 v[48:51], v[92:93], v[116:117], 0
ds_read_b128 v[112:115], v15 offset:0
v_add_f32 v68, v68, v70
v_mfma_f32_16x16x32_bf16 v[56:59], a[96:99], v[72:75], v[56:59]
s_add_u32 s62, s40, 0x2000
v_rcp_f32 v52, v52
v_mfma_f32_16x16x32_bf16 v[60:63], a[100:103], v[72:75], v[60:63]
s_waitcnt lgkmcnt(2)
v_add_f32 v69, v69, v71
v_mfma_f32_16x16x32_bf16 v[64:67], a[104:107], v[72:75], v[64:67]
ds_read_b128 v[72:75], v12 offset:6144
v_permlane32_swap_b32 v68, v69
v_mfma_f32_16x16x16_bf16 v[48:51], v[98:99], v[118:119], v[48:51]
ds_read_b128 v[116:119], v15 offset:64
v_add_f32 v70, v68, v69
v_mfma_f32_16x16x32_bf16 v[56:59], a[108:111], v[76:79], v[56:59]
buffer_load_dwordx4 a[96:99], v0, s[4:7], s62 offen offset:0
v_mfma_f32_16x16x32_bf16 v[60:63], a[112:115], v[76:79], v[60:63]
buffer_load_dwordx4 a[108:111], v0, s[4:7], s62 offen offset:1024
v_mfma_f32_16x16x32_bf16 v[64:67], a[116:119], v[76:79], v[64:67]
ds_read_b128 v[76:79], v13 offset:6144
v_mul_f32 v48, v48, v52
v_mfma_f32_16x16x32_bf16 v[56:59], a[120:123], v[80:83], v[56:59]
buffer_load_dwordx4 a[120:123], v0, s[4:7], s62 offen offset:2048
s_waitcnt lgkmcnt(4)
v_mfma_f32_16x16x32_bf16 v[60:63], a[124:127], v[80:83], v[60:63]
v_mul_f32 v49, v49, v52
v_mul_f32 v50, v50, v52
v_mfma_f32_16x16x32_bf16 v[64:67], a[128:131], v[80:83], v[64:67]
ds_read_b128 v[80:83], v12 offset:7168
v_mul_f32 v51, v51, v52
v_cvt_pk_bf16_f32 v44, v48, v49
v_cvt_pk_bf16_f32 v45, v50, v51
v_mfma_f32_16x16x32_bf16 v[56:59], a[132:135], v[84:87], v[56:59]
s_add_u32 s68, s31, 0xb16000
buffer_store_dwordx2 v[44:45], v0, s[4:7], s68 offen
s_waitcnt lgkmcnt(3)
v_mfma_f32_16x16x32_bf16 v[60:63], a[136:139], v[84:87], v[60:63]
buffer_load_dwordx4 a[132:135], v0, s[4:7], s62 offen offset:3072
v_mfma_f32_16x16x32_bf16 v[64:67], a[140:143], v[84:87], v[64:67]
ds_read_b128 v[84:87], v13 offset:7168
v_mov_b32 v71, v70
v_mfma_f32_16x16x32_bf16 v[64:67], a[152:155], v[72:75], v[64:67]
s_nop 0
v_permlane16_swap_b32 v70, v71
s_waitcnt lgkmcnt(2)
v_mfma_f32_16x16x32_bf16 v[64:67], a[164:167], v[76:79], v[64:67]
v_add_f32 v68, v70, v71
v_mul_f32 v104, v36, v68
s_waitcnt lgkmcnt(1)
v_mfma_f32_16x16x32_bf16 v[64:67], a[176:179], v[80:83], v[64:67]
v_mul_f32 v108, v36, v68
v_mfma_f32_16x16x32_bf16 v[60:63], a[148:151], v[72:75], v[60:63]
s_nop 0
v_permlane32_swap_b32 v104, v108
v_mfma_f32_16x16x32_bf16 v[56:59], a[144:147], v[72:75], v[56:59]
s_add_u32 s78, s40, 0x3000
v_fma_f32 v108, -v104, v104, v108
v_max_f32 v108, 0, v108
v_mfma_f32_16x16x32_bf16 v[60:63], a[160:163], v[76:79], v[60:63]
buffer_load_dwordx4 a[144:147], v0, s[4:7], s78 offen offset:0
v_mfma_f32_16x16x32_bf16 v[56:59], a[156:159], v[76:79], v[56:59]
s_waitcnt lgkmcnt(0)
v_add_f32 v108, s45, v108
s_barrier
v_mfma_f32_16x16x32_bf16 v[64:67], a[188:191], v[84:87], v[64:67]
buffer_load_dwordx4 a[156:159], v0, s[4:7], s78 offen offset:1024
v_mfma_f32_16x16x32_bf16 v[60:63], a[172:175], v[80:83], v[60:63]
ds_read_b128 v[72:75], v124 offset:16384
v_mfma_f32_16x16x32_bf16 v[56:59], a[168:171], v[80:83], v[56:59]
ds_read_b128 v[76:79], v125 offset:16384
ds_read_b128 v[80:83], v124 offset:17408
v_mfma_f32_16x16x32_bf16 v[60:63], a[184:187], v[84:87], v[60:63]
buffer_load_dwordx4 v[52:55], v37, s[4:7], s55 offen offset:0 sc1
v_mfma_f32_16x16x32_bf16 v[56:59], a[180:183], v[84:87], v[56:59]
ds_read_b128 v[84:87], v125 offset:17408
v_rsq_f32 v108, v108
s_nop 0
v_mul_f32_e64 v104, -v104, v108
buffer_load_dwordx4 a[168:171], v0, s[4:7], s78 offen offset:2048
v_mul_f32 v120, v104, v120
buffer_load_dwordx4 a[180:183], v0, s[4:7], s78 offen offset:3072
v_mul_f32 v121, v104, v121
v_mul_f32 v122, v104, v122
v_mul_f32 v123, v104, v123
v_fmac_f32 v120, v64, v108
v_fmac_f32 v121, v65, v108
s_waitcnt lgkmcnt(3)
v_mfma_f32_16x16x32_bf16 v[44:47], a[4:7], v[72:75], 0
v_fmac_f32 v122, v66, v108
v_fmac_f32 v123, v67, v108
v_mfma_f32_16x16x32_bf16 v[48:51], a[8:11], v[72:75], 0
s_waitcnt lgkmcnt(2)
ds_read_b128 v[72:75], v124 offset:18432
v_mfma_f32_16x16x32_bf16 v[44:47], a[16:19], v[76:79], v[44:47]
v_cvt_pk_bf16_f32 v98, v120, v121
v_cvt_pk_bf16_f32 v99, v122, v123
s_waitcnt vmcnt(12)
v_cmp_eq_u32_e64 s[76:77], v126, v39
v_mfma_f32_16x16x32_bf16 v[48:51], a[20:23], v[76:79], v[48:51]
s_waitcnt lgkmcnt(2)
ds_read_b128 v[76:79], v125 offset:18432
v_mfma_f32_16x16x32_bf16 v[44:47], a[28:31], v[80:83], v[44:47]
ds_read_b128 v[120:123], v15 offset:128
s_waitcnt lgkmcnt(3)
ds_write_b64 v16, v[98:99] offset:0
s_cmp_eq_u64 s[76:77], s[56:57]
s_cbranch_scc0 CHK_40
CRET_40:
v_mfma_f32_16x16x32_bf16 v[48:51], a[32:35], v[80:83], v[48:51]
s_add_u32 s67, s72, 0xb21000
buffer_load_dwordx4 v[28:31], v0, s[4:7], s67 offen offset:0 sc1
buffer_load_dwordx4 v[100:103], v0, s[4:7], s67 offen offset:1024 sc1
ds_read_b128 v[80:83], v124 offset:19456
v_mfma_f32_16x16x32_bf16 v[44:47], a[40:43], v[84:87], v[44:47]
v_mul_f32 v116, v104, v116
v_mul_f32 v117, v104, v117
v_mfma_f32_16x16x32_bf16 v[48:51], a[44:47], v[84:87], v[48:51]
s_waitcnt lgkmcnt(4)
ds_read_b128 v[84:87], v125 offset:19456
v_mfma_f32_16x16x32_bf16 v[44:47], a[52:55], v[72:75], v[44:47]
v_mul_f32 v118, v104, v118
v_mul_f32 v119, v104, v119
v_mfma_f32_16x16x32_bf16 v[48:51], a[56:59], v[72:75], v[48:51]
s_waitcnt lgkmcnt(4)
ds_read_b128 v[72:75], v124 offset:20480
v_mfma_f32_16x16x32_bf16 v[44:47], a[64:67], v[76:79], v[44:47]
ds_read_b64_tr_b16 v[98:99], v17 offset:0
v_mul_f32 v105, s46, v104
v_mfma_f32_16x16x32_bf16 v[48:51], a[68:71], v[76:79], v[48:51]
ds_read_b128 v[76:79], v125 offset:20480
v_fmac_f32 v116, v60, v108
v_fmac_f32 v117, v61, v108
v_fmac_f32 v118, v62, v108
v_fmac_f32 v119, v63, v108
v_mul_f32 v109, s46, v108
v_mul_f32 v112, v105, v112
v_mul_f32 v113, v105, v113
s_waitcnt lgkmcnt(4)
v_mfma_f32_16x16x32_bf16 v[44:47], a[76:79], v[80:83], v[44:47]
v_mul_f32 v114, v105, v114
v_mul_f32 v115, v105, v115
v_mfma_f32_16x16x32_bf16 v[48:51], a[80:83], v[80:83], v[48:51]
s_waitcnt lgkmcnt(3)
buffer_load_dwordx4 v[104:107], v0, s[4:7], s67 offen offset:2048 sc1
ds_read_b128 v[80:83], v124 offset:21504
v_mfma_f32_16x16x32_bf16 v[44:47], a[88:91], v[84:87], v[44:47]
v_cvt_pk_bf16_f32 v96, v116, v117
v_cvt_pk_bf16_f32 v97, v118, v119
v_mfma_f32_16x16x32_bf16 v[48:51], a[92:95], v[84:87], v[48:51]
s_waitcnt lgkmcnt(3)
ds_read_b128 v[84:87], v125 offset:21504
v_mfma_f32_16x16x32_bf16 v[44:47], a[100:103], v[72:75], v[44:47]
v_fmac_f32 v112, v56, v109
v_fmac_f32 v113, v57, v109
v_mfma_f32_16x16x32_bf16 v[48:51], a[104:107], v[72:75], v[48:51]
s_waitcnt lgkmcnt(2)
ds_read_b128 v[72:75], v124 offset:22528
v_mfma_f32_16x16x32_bf16 v[44:47], a[112:115], v[76:79], v[44:47]
v_fmac_f32 v114, v58, v109
v_fmac_f32 v115, v59, v109
v_mfma_f32_16x16x32_bf16 v[48:51], a[116:119], v[76:79], v[48:51]
buffer_load_dwordx4 v[108:111], v0, s[4:7], s67 offen offset:3072 sc1
ds_read_b128 v[76:79], v125 offset:22528
v_mfma_f32_16x16x16_bf16 v[60:63], v[90:91], v[88:89], v[32:35]
v_cvt_pk_bf16_f32 v94, v112, v113
v_cvt_pk_bf16_f32 v95, v114, v115
s_waitcnt lgkmcnt(3)
v_mfma_f32_16x16x32_bf16 v[44:47], a[124:127], v[80:83], v[44:47]
s_waitcnt vmcnt(10)
s_cbranch_vccnz SIG_37
buffer_store_dword v126, v2, s[4:7], s36 offen offset:2304
SRET_37:
s_waitcnt lgkmcnt(2)
v_mfma_f32_16x16x32_bf16 v[48:51], a[128:131], v[80:83], v[48:51]
ds_read_b128 v[80:83], v124 offset:23552
v_mfma_f32_16x16x32_bf16 v[44:47], a[136:139], v[84:87], v[44:47]
v_mfma_f32_16x16x32_bf16 v[48:51], a[140:143], v[84:87], v[48:51]
s_waitcnt lgkmcnt(2)
ds_read_b128 v[84:87], v125 offset:23552
v_mfma_f32_16x16x32_bf16 v[48:51], a[152:155], v[72:75], v[48:51]
v_mfma_f32_16x16x32_bf16 v[44:47], a[148:151], v[72:75], v[44:47]
s_waitcnt lgkmcnt(2)
v_mfma_f32_16x16x32_bf16 v[48:51], a[164:167], v[76:79], v[48:51]
v_mfma_f32_16x16x32_bf16 v[44:47], a[160:163], v[76:79], v[44:47]
v_mfma_f32_16x16x16_bf16 v[56:59], v[96:97], v[88:89], 0
s_waitcnt lgkmcnt(1)
v_mfma_f32_16x16x32_bf16 v[48:51], a[176:179], v[80:83], v[48:51]
v_mfma_f32_16x16x32_bf16 v[44:47], a[172:175], v[80:83], v[44:47]
s_waitcnt lgkmcnt(0)
v_mfma_f32_16x16x32_bf16 v[48:51], a[188:191], v[84:87], v[48:51]
v_mfma_f32_16x16x32_bf16 v[44:47], a[184:187], v[84:87], v[44:47]
s_nop 1
v_cndmask_b32_e64 v56, v60, v56, s[92:93]
v_cndmask_b32_e64 v57, v61, v57, s[94:95]
v_cndmask_b32_e64 v58, v62, v58, s[96:97]
v_cndmask_b32_e64 v59, v63, v59, s[98:99]
v_max3_f32 v112, v56, v57, v58
v_max_f32 v112, v112, v59
v_mov_b32 v113, v112
s_nop 1
v_permlane32_swap_b32 v112, v113
v_max_f32 v112, v112, v113
v_mov_b32 v113, v112
s_nop 1
v_permlane16_swap_b32 v112, v113
v_max_f32 v112, v112, v113
v_sub_f32 v56, v56, v112
v_sub_f32 v57, v57, v112
s_waitcnt vmcnt(7)
v_add_f32 v52, v52, v54
v_add_f32 v53, v53, v55
v_sub_f32 v58, v58, v112
v_sub_f32 v59, v59, v112
v_permlane32_swap_b32 v52, v53
v_add_f32 v54, v52, v53
v_mov_b32 v55, v54
v_exp_f32 v56, v56
v_exp_f32 v57, v57
v_permlane16_swap_b32 v54, v55
v_add_f32 v52, v54, v55
v_mul_f32 v88, v36, v52
v_mul_f32 v89, v36, v52
v_exp_f32 v58, v58
v_exp_f32 v59, v59
v_permlane32_swap_b32 v88, v89
v_fma_f32 v89, -v88, v88, v89
v_max_f32 v89, 0, v89
v_add_f32 v89, s45, v89
v_rsq_f32 v89, v89
v_cvt_pk_bf16_f32 v114, v56, v57
v_mul_f32_e64 v88, -v88, v89
v_mul_f32 v120, v88, v120
v_mul_f32 v121, v88, v121
v_mul_f32 v122, v88, v122
v_mul_f32 v123, v88, v123
v_fmac_f32 v120, v48, v89
v_fmac_f32 v121, v49, v89
v_fmac_f32 v122, v50, v89
v_fmac_f32 v123, v51, v89
v_mov_b32 v48, s50
v_mov_b32 v49, s50
v_mov_b32 v50, s50
v_mov_b32 v51, s50
v_cvt_pk_bf16_f32 v115, v58, v59
v_and_b32 v116, v26, v114
v_and_b32 v117, v27, v115
v_mfma_f32_16x16x16_bf16 v[68:71], v[24:25], v[114:115], 0
v_xor_b32 v118, v116, v114
v_xor_b32 v119, v117, v115
v_mfma_f32_16x16x16_bf16 v[64:67], v[98:99], v[116:117], 0
buffer_load_dword v127, v3, s[4:7], s36 offen offset:2304 sc1
v_mfma_f32_16x16x16_bf16 v[64:67], v[92:93], v[118:119], v[64:67]
s_waitcnt vmcnt(5)
ds_read_b128 v[116:119], v15 offset:64
v_mfma_f32_16x16x32_bf16 v[56:59], a[0:3], v[28:31], 0
buffer_load_dwordx4 a[4:7], v0, s[4:7], s42 offen offset:1024
v_cvt_pk_bf16_f32 v92, v120, v121
v_cvt_pk_bf16_f32 v93, v122, v123
ds_write_b64 v16, v[92:93] offset:512
v_rcp_f32 v68, v68
s_waitcnt vmcnt(5)
v_mfma_f32_16x16x32_bf16 v[56:59], a[48:51], v[100:103], v[56:59]
s_add_u32 s66, s42, 0x1000
buffer_load_dwordx4 a[20:23], v0, s[4:7], s66 offen offset:1024
v_mul_f32 v64, v64, v68
v_mul_f32 v65, v65, v68
v_mul_f32 v66, v66, v68
v_mul_f32 v67, v67, v68
v_mfma_f32_16x16x32_bf16 v[68:71], a[36:39], v[28:31], 0
v_cvt_pk_bf16_f32 v60, v64, v65
v_cvt_pk_bf16_f32 v61, v66, v67
v_mfma_f32_16x16x32_bf16 v[64:67], a[24:27], v[28:31], 0
s_waitcnt lgkmcnt(1)
s_add_u32 s79, s31, 0xb0b000
v_mul_f32 v116, v88, v116
v_mfma_f32_16x16x32_bf16 v[64:67], a[72:75], v[100:103], v[64:67]
s_waitcnt vmcnt(5)
v_mul_f32 v117, v88, v117
v_mul_f32 v118, v88, v118
v_mfma_f32_16x16x32_bf16 v[68:71], a[84:87], v[100:103], v[68:71]
buffer_store_dwordx2 v[60:61], v0, s[4:7], s79 offen
s_add_u32 s64, s42, 0x2000
v_mfma_f32_16x16x32_bf16 v[60:63], a[12:15], v[28:31], 0
ds_read_b64_tr_b16 v[92:93], v17 offset:512
v_mul_f32 v119, v88, v119
v_mfma_f32_16x16x32_bf16 v[60:63], a[60:63], v[100:103], v[60:63]
buffer_load_dwordx4 a[8:11], v0, s[4:7], s42 offen offset:2048
v_mfma_f32_16x16x32_bf16 v[56:59], a[96:99], v[104:107], v[56:59]
buffer_load_dwordx4 a[16:19], v0, s[4:7], s66 offen offset:0
s_waitcnt vmcnt(7)
v_mfma_f32_16x16x32_bf16 v[60:63], a[108:111], v[104:107], v[60:63]
buffer_load_dwordx4 a[28:31], v0, s[4:7], s66 offen offset:3072
v_mfma_f32_16x16x32_bf16 v[64:67], a[120:123], v[104:107], v[64:67]
buffer_load_dwordx4 a[32:35], v0, s[4:7], s64 offen offset:0
v_mfma_f32_16x16x32_bf16 v[68:71], a[132:135], v[104:107], v[68:71]
buffer_load_dwordx4 a[40:43], v0, s[4:7], s64 offen offset:2048
s_add_u32 s63, s42, 0x3000
v_mfma_f32_16x16x32_bf16 v[56:59], a[144:147], v[108:111], v[56:59]
buffer_load_dwordx4 a[44:47], v0, s[4:7], s64 offen offset:3072
v_mfma_f32_16x16x32_bf16 v[60:63], a[156:159], v[108:111], v[60:63]
buffer_load_dwordx4 a[52:55], v0, s[4:7], s63 offen offset:1024
v_mfma_f32_16x16x32_bf16 v[64:67], a[168:171], v[108:111], v[64:67]
buffer_load_dwordx4 a[56:59], v0, s[4:7], s63 offen offset:2048
s_add_u32 s65, s42, 0x4000
v_mfma_f32_16x16x32_bf16 v[68:71], a[180:183], v[108:111], v[68:71]
s_nop 0
ds_write_b128 v18, v[56:59] offset:0
s_nop 0
ds_write_b128 v19, v[60:63] offset:0
s_nop 0
ds_write_b128 v18, v[64:67] offset:128
s_nop 1
ds_write_b128 v19, v[68:71] offset:128
v_fmac_f32 v116, v44, v89
buffer_load_dwordx4 a[64:67], v0, s[4:7], s65 offen offset:0
v_fmac_f32 v117, v45, v89
v_fmac_f32 v118, v46, v89
v_fmac_f32 v119, v47, v89
v_cvt_pk_bf16_f32 v90, v116, v117
v_cvt_pk_bf16_f32 v91, v118, v119
v_mfma_f32_16x16x16_bf16 v[44:47], v[96:97], v[94:95], v[32:35]
s_nop 0
v_mfma_f32_16x16x16_bf16 v[40:43], v[90:91], v[94:95], v[48:51]
ds_read_b128 v[88:91], v15 offset:192
s_waitcnt lgkmcnt(1)
s_barrier
ds_read_b128 v[56:59], v20 offset:0
ds_read_b128 v[60:63], v20 offset:4096
ds_read_b128 v[64:67], v20 offset:8192
ds_read_b128 v[68:71], v20 offset:12288
s_nop 0
v_cndmask_b32_e64 v40, v44, v40, s[92:93]
v_cndmask_b32_e64 v41, v45, v41, s[94:95]
v_cndmask_b32_e64 v42, v46, v42, s[96:97]
v_cndmask_b32_e64 v43, v47, v43, s[98:99]
v_max3_f32 v112, v40, v41, v42
v_max_f32 v112, v112, v43
v_mov_b32 v113, v112
s_nop 1
v_permlane32_swap_b32 v112, v113
v_max_f32 v112, v112, v113
v_mov_b32 v113, v112
s_waitcnt vmcnt(12)
v_cmp_eq_u32_e64 s[58:59], v126, v127
v_permlane16_swap_b32 v112, v113
v_max_f32 v112, v112, v113
v_and_b32 v113, s49, v10
v_sub_f32 v40, v40, v112
v_sub_f32 v41, v41, v112
v_sub_f32 v42, v42, v112
v_sub_f32 v43, v43, v112
v_lshlrev_b32 v112, 16, v10
v_exp_f32 v40, v40
s_cmp_eq_u64 s[58:59], s[56:57]
s_cbranch_scc0 CHK_42
CRET_42:
s_add_u32 s69, s72, 0xb16000
buffer_load_dwordx4 v[72:75], v0, s[4:7], s69 offen offset:0 sc1
s_waitcnt lgkmcnt(2)
v_add_f32 v56, v56, v60
buffer_load_dwordx4 v[76:79], v0, s[4:7], s69 offen offset:1024 sc1
s_waitcnt lgkmcnt(0)
v_add_f32 v64, v64, v68
buffer_load_dwordx4 v[80:83], v0, s[4:7], s69 offen offset:2048 sc1
v_add_f32 v112, v112, v56
s_waitcnt vmcnt(12)
s_cbranch_vccnz SIG_38
buffer_store_dword v126, v2, s[4:7], s36 offen offset:2176
SRET_38:
v_add_f32 v57, v57, v61
buffer_load_dwordx4 v[84:87], v0, s[4:7], s69 offen offset:3072 sc1
v_add_f32 v58, v58, v62
v_add_f32 v59, v59, v63
v_add_f32 v112, v112, v64
v_add_f32 v65, v65, v69
v_add_f32 v113, v113, v57
v_add_f32 v66, v66, v70
v_add_f32 v67, v67, v71
v_add_f32 v113, v113, v65
v_cvt_pk_bf16_f32 v10, v112, v113
v_exp_f32 v41, v41
v_exp_f32 v42, v42
v_exp_f32 v43, v43
v_cvt_pk_bf16_f32 v114, v40, v41
v_cvt_pk_bf16_f32 v115, v42, v43
v_and_b32 v116, v26, v114
v_and_b32 v117, v27, v115
v_mfma_f32_16x16x16_bf16 v[52:55], v[24:25], v[114:115], 0
v_xor_b32 v118, v116, v114
v_lshlrev_b32 v114, 16, v11
v_add_f32 v114, v114, v58
v_add_f32 v114, v114, v66
v_mfma_f32_16x16x16_bf16 v[48:51], v[92:93], v[116:117], 0
ds_read_b128 v[92:95], v15 offset:256
v_add_f32 v116, v112, v113
v_xor_b32 v119, v117, v115
v_and_b32 v115, s49, v11
v_add_f32 v115, v115, v59
v_add_f32 v115, v115, v67
v_mul_f32 v117, v112, v112
v_lshlrev_b32 v112, 16, v8
v_fmac_f32 v117, v113, v113
v_and_b32 v113, s49, v8
v_fmac_f32 v117, v114, v114
v_fmac_f32 v117, v115, v115
v_cvt_pk_bf16_f32 v11, v114, v115
v_mfma_f32_16x16x16_bf16 v[48:51], v[98:99], v[118:119], v[48:51]
s_add_u32 s68, s29, 0x80c000
buffer_store_dwordx2 v[10:11], v21, s[4:7], s68 offen
v_add_f32 v118, v114, v115
ds_read_b128 v[96:99], v15 offset:320
v_lshlrev_b32 v114, 16, v9
v_and_b32 v115, s49, v9
v_add_f32 v116, v116, v118
v_rcp_f32 v52, v52
s_nop 0
v_add_f32_dpp v116, v116, v116 row_ror:8 row_mask:0xf bank_mask:0xf
v_mul_f32 v48, v48, v52
v_mul_f32 v49, v49, v52
v_add_f32_dpp v116, v117, v117 row_ror:8 row_mask:0xf bank_mask:0xc
v_mul_f32 v50, v50, v52
v_mul_f32 v51, v51, v52
v_add_f32_dpp v116, v116, v116 row_half_mirror row_mask:0xf bank_mask:0xf
v_cvt_pk_bf16_f32 v44, v48, v49
v_cvt_pk_bf16_f32 v45, v50, v51
s_add_u32 s62, s31, 0xb00000
buffer_store_dwordx2 v[44:45], v0, s[4:7], s62 offen
v_add_f32_dpp v116, v116, v116 quad_perm:[2,3,0,1] row_mask:0xf bank_mask:0xf
s_nop 1
v_add_f32_dpp v116, v116, v116 quad_perm:[1,0,3,2] row_mask:0xf bank_mask:0xf
s_add_u32 s78, s35, 0x520000
buffer_store_dword v116, v22, s[4:7], s78 offen offset:3072
buffer_load_dword v23, v3, s[4:7], s36 offen offset:2176 sc1
s_waitcnt vmcnt(8)
v_mfma_f32_16x16x32_bf16 v[40:43], a[0:3], v[72:75], 0
s_add_u32 s67, s42, 0x4000
buffer_load_dwordx4 a[68:71], v0, s[4:7], s67 offen offset:1024
v_mfma_f32_16x16x32_bf16 v[44:47], a[12:15], v[72:75], 0
buffer_load_dwordx4 a[76:79], v0, s[4:7], s67 offen offset:3072
v_mfma_f32_16x16x32_bf16 v[48:51], a[24:27], v[72:75], 0
v_mfma_f32_16x16x32_bf16 v[52:55], a[36:39], v[72:75], 0
s_waitcnt vmcnt(9)
s_add_u32 s79, s42, 0x5000
buffer_load_dwordx4 a[80:83], v0, s[4:7], s79 offen offset:0
v_mfma_f32_16x16x32_bf16 v[40:43], a[48:51], v[76:79], v[40:43]
v_mfma_f32_16x16x32_bf16 v[44:47], a[60:63], v[76:79], v[44:47]
buffer_load_dwordx4 a[88:91], v0, s[4:7], s79 offen offset:2048
v_mfma_f32_16x16x32_bf16 v[48:51], a[72:75], v[76:79], v[48:51]
v_mfma_f32_16x16x32_bf16 v[52:55], a[84:87], v[76:79], v[52:55]
s_waitcnt vmcnt(10)
buffer_load_dwordx4 a[92:95], v0, s[4:7], s79 offen offset:3072
v_mfma_f32_16x16x32_bf16 v[40:43], a[96:99], v[80:83], v[40:43]
s_add_u32 s66, s42, 0x6000
buffer_load_dwordx4 a[100:103], v0, s[4:7], s66 offen offset:1024
v_mfma_f32_16x16x32_bf16 v[44:47], a[108:111], v[80:83], v[44:47]
v_mfma_f32_16x16x32_bf16 v[48:51], a[120:123], v[80:83], v[48:51]
buffer_load_dwordx4 a[104:107], v0, s[4:7], s66 offen offset:2048
s_waitcnt vmcnt(11)
s_waitcnt vmcnt(8)
v_mfma_f32_16x16x32_bf16 v[52:55], a[132:135], v[80:83], v[52:55]
s_cbranch_vccnz SIG_41
buffer_store_dword v126, v2, s[4:7], s36 offen offset:2944
SRET_41:
s_cbranch_vccnz SIG_39
buffer_store_dword v126, v2, s[4:7], s36 offen offset:2048
SRET_39:
v_mfma_f32_16x16x32_bf16 v[40:43], a[144:147], v[84:87], v[40:43]
s_add_u32 s64, s42, 0x7000
buffer_load_dwordx4 a[112:115], v0, s[4:7], s64 offen offset:0
v_mfma_f32_16x16x32_bf16 v[44:47], a[156:159], v[84:87], v[44:47]
v_mfma_f32_16x16x32_bf16 v[48:51], a[168:171], v[84:87], v[48:51]
buffer_load_dwordx4 a[116:119], v0, s[4:7], s64 offen offset:1024
v_mfma_f32_16x16x32_bf16 v[52:55], a[180:183], v[84:87], v[52:55]
s_nop 1
ds_write_b128 v18, v[40:43] offset:16384
s_nop 1
ds_write_b128 v19, v[44:47] offset:16384
ds_write_b128 v18, v[48:51] offset:16512
s_nop 0
ds_write_b128 v19, v[52:55] offset:16512
s_waitcnt vmcnt(11)
v_cmp_eq_u32_e64 s[76:77], v126, v23
s_waitcnt lgkmcnt(0)
s_barrier
ds_read_b128 v[40:43], v20 offset:16384
s_cmp_eq_u64 s[76:77], s[56:57]
s_cbranch_scc0 CHK_44
CRET_44:
ds_read_b128 v[44:47], v20 offset:20480
s_add_u32 s63, s72, 0xb0b000
ds_read_b128 v[48:51], v20 offset:24576
ds_read_b128 v[52:55], v20 offset:28672
buffer_load_dwordx4 v[28:31], v0, s[4:7], s63 offen offset:0 sc1
buffer_load_dwordx4 v[100:103], v0, s[4:7], s63 offen offset:1024 sc1
buffer_load_dwordx4 v[104:107], v0, s[4:7], s63 offen offset:2048 sc1
buffer_load_dwordx4 v[108:111], v0, s[4:7], s63 offen offset:3072 sc1
s_waitcnt lgkmcnt(2)
v_add_f32 v40, v40, v44
v_add_f32 v112, v112, v40
v_add_f32 v41, v41, v45
v_add_f32 v42, v42, v46
v_add_f32 v43, v43, v47
v_add_f32 v113, v113, v41
v_add_f32 v114, v114, v42
v_add_f32 v115, v115, v43
s_waitcnt lgkmcnt(0)
v_add_f32 v48, v48, v52
v_add_f32 v112, v112, v48
buffer_load_dword v39, v3, s[4:7], s36 offen offset:2048 sc1
v_add_f32 v49, v49, v53
v_add_f32 v50, v50, v54
v_add_f32 v51, v51, v55
v_add_f32 v113, v113, v49
v_add_f32 v114, v114, v50
v_add_f32 v115, v115, v51
v_mul_f32 v117, v112, v112
v_add_f32 v116, v112, v113
v_add_f32 v118, v114, v115
v_fmac_f32 v117, v113, v113
v_add_f32 v116, v116, v118
v_fmac_f32 v117, v114, v114
v_fmac_f32 v117, v115, v115
v_add_f32_dpp v116, v116, v116 row_ror:8 row_mask:0xf bank_mask:0xf
v_cvt_pk_bf16_f32 v8, v112, v113
v_lshlrev_b32 v112, 16, v6
v_and_b32 v113, s49, v6
v_add_f32_dpp v116, v117, v117 row_ror:8 row_mask:0xf bank_mask:0xc
buffer_load_dword v127, v3, s[4:7], s36 offen offset:2944 sc1
s_nop 0
v_add_f32_dpp v116, v116, v116 row_half_mirror row_mask:0xf bank_mask:0xf
v_cvt_pk_bf16_f32 v9, v114, v115
s_add_u32 s65, s29, 0x808000
buffer_store_dwordx2 v[8:9], v21, s[4:7], s65 offen
v_lshlrev_b32 v114, 16, v7
v_and_b32 v115, s49, v7
v_add_f32_dpp v116, v116, v116 quad_perm:[2,3,0,1] row_mask:0xf bank_mask:0xf
s_nop 1
v_add_f32_dpp v116, v116, v116 quad_perm:[1,0,3,2] row_mask:0xf bank_mask:0xf
s_add_u32 s69, s35, 0x520000
buffer_store_dword v116, v22, s[4:7], s69 offen offset:2048
s_waitcnt vmcnt(7)
v_mfma_f32_16x16x32_bf16 v[56:59], a[0:3], v[28:31], 0
s_add_u32 s68, s42, 0x7000
buffer_load_dwordx4 a[124:127], v0, s[4:7], s68 offen offset:3072
v_mfma_f32_16x16x32_bf16 v[60:63], a[12:15], v[28:31], 0
v_mfma_f32_16x16x32_bf16 v[64:67], a[24:27], v[28:31], 0
v_mfma_f32_16x16x32_bf16 v[68:71], a[36:39], v[28:31], 0
s_waitcnt vmcnt(7)
v_mfma_f32_16x16x32_bf16 v[56:59], a[48:51], v[100:103], v[56:59]
v_mfma_f32_16x16x32_bf16 v[60:63], a[60:63], v[100:103], v[60:63]
v_mfma_f32_16x16x32_bf16 v[64:67], a[72:75], v[100:103], v[64:67]
v_mfma_f32_16x16x32_bf16 v[68:71], a[84:87], v[100:103], v[68:71]
s_waitcnt vmcnt(6)
v_mfma_f32_16x16x32_bf16 v[56:59], a[96:99], v[104:107], v[56:59]
s_add_u32 s62, s42, 0x8000
buffer_load_dwordx4 a[128:131], v0, s[4:7], s62 offen offset:0
v_mfma_f32_16x16x32_bf16 v[60:63], a[108:111], v[104:107], v[60:63]
v_mfma_f32_16x16x32_bf16 v[64:67], a[120:123], v[104:107], v[64:67]
v_mfma_f32_16x16x32_bf16 v[68:71], a[132:135], v[104:107], v[68:71]
s_waitcnt vmcnt(5)
v_cmp_eq_u32_e64 s[58:59], v126, v39
v_mfma_f32_16x16x32_bf16 v[56:59], a[144:147], v[108:111], v[56:59]
s_waitcnt vmcnt(4)
s_waitcnt vmcnt(2)
s_cbranch_vccnz SIG_43
buffer_store_dword v126, v2, s[4:7], s36 offen offset:2816
SRET_43:
v_mfma_f32_16x16x32_bf16 v[60:63], a[156:159], v[108:111], v[60:63]
v_cmp_eq_u32_e64 s[76:77], v126, v127
v_mfma_f32_16x16x32_bf16 v[64:67], a[168:171], v[108:111], v[64:67]
s_cmp_eq_u64 s[58:59], s[56:57]
s_cbranch_scc0 CHK_48
CRET_48:
v_mfma_f32_16x16x32_bf16 v[68:71], a[180:183], v[108:111], v[68:71]
ds_write_b128 v18, v[56:59] offset:0
s_add_u32 s78, s72, 0xb00000
s_cmp_eq_u64 s[76:77], s[56:57]
s_cbranch_scc0 CHK_46
CRET_46:
ds_write_b128 v19, v[60:63] offset:0
s_add_u32 s67, s30, 0x80c000
s_add_u32 m0, s38, 0x20000
ds_write_b128 v18, v[64:67] offset:128
ds_write_b128 v19, v[68:71] offset:128
buffer_load_dwordx4 v[28:31], v0, s[4:7], s78 offen offset:0 sc1
buffer_load_dwordx4 v[100:103], v0, s[4:7], s78 offen offset:1024 sc1
buffer_load_dwordx4 v[104:107], v0, s[4:7], s78 offen offset:2048 sc1
buffer_load_dwordx4 v[108:111], v0, s[4:7], s78 offen offset:3072 sc1
buffer_load_dwordx4 v0, s[4:7], s67 offen offset:0 sc1 lds
buffer_load_dwordx4 v0, s[4:7], s67 offen offset:1024 sc1 lds
buffer_load_dwordx4 v0, s[4:7], s67 offen offset:2048 sc1 lds
buffer_load_dwordx4 v0, s[4:7], s67 offen offset:3072 sc1 lds
s_waitcnt lgkmcnt(0)
s_barrier
ds_read_b128 v[56:59], v20 offset:0
ds_read_b128 v[60:63], v20 offset:4096
ds_read_b128 v[64:67], v20 offset:8192
ds_read_b128 v[68:71], v20 offset:12288
s_waitcnt lgkmcnt(2)
v_add_f32 v56, v56, v60
v_add_f32 v112, v112, v56
v_add_f32 v57, v57, v61
v_add_f32 v58, v58, v62
v_add_f32 v59, v59, v63
v_add_f32 v113, v113, v57
v_add_f32 v114, v114, v58
v_add_f32 v115, v115, v59
s_waitcnt lgkmcnt(0)
v_add_f32 v64, v64, v68
v_add_f32 v112, v112, v64
v_add_f32 v65, v65, v69
v_add_f32 v66, v66, v70
v_add_f32 v67, v67, v71
v_add_f32 v113, v113, v65
v_add_f32 v114, v114, v66
v_add_f32 v115, v115, v67
v_mul_f32 v117, v112, v112
v_add_f32 v116, v112, v113
v_add_f32 v118, v114, v115
v_fmac_f32 v117, v113, v113
v_add_f32 v116, v116, v118
v_fmac_f32 v117, v114, v114
v_fmac_f32 v117, v115, v115
v_add_f32_dpp v116, v116, v116 row_ror:8 row_mask:0xf bank_mask:0xf
v_cvt_pk_bf16_f32 v6, v112, v113
v_cvt_pk_bf16_f32 v7, v114, v115
s_add_u32 s79, s29, 0x804000
buffer_store_dwordx2 v[6:7], v21, s[4:7], s79 offen
v_add_f32_dpp v116, v117, v117 row_ror:8 row_mask:0xf bank_mask:0xc
v_lshlrev_b32 v112, 16, v4
v_and_b32 v113, s49, v4
v_add_f32_dpp v116, v116, v116 row_half_mirror row_mask:0xf bank_mask:0xf
v_lshlrev_b32 v114, 16, v5
buffer_load_dword v23, v3, s[4:7], s36 offen offset:2816 sc1
v_add_f32_dpp v116, v116, v116 quad_perm:[2,3,0,1] row_mask:0xf bank_mask:0xf
v_and_b32 v115, s49, v5
s_nop 0
v_add_f32_dpp v116, v116, v116 quad_perm:[1,0,3,2] row_mask:0xf bank_mask:0xf
s_add_u32 s66, s35, 0x520000
buffer_store_dword v116, v22, s[4:7], s66 offen offset:1024
s_waitcnt vmcnt(10)
v_mfma_f32_16x16x32_bf16 v[56:59], a[0:3], v[28:31], 0
s_add_u32 s64, s42, 0x8000
buffer_load_dwordx4 a[136:139], v0, s[4:7], s64 offen offset:2048
v_mfma_f32_16x16x32_bf16 v[60:63], a[12:15], v[28:31], 0
s_waitcnt vmcnt(10)
v_mfma_f32_16x16x32_bf16 v[64:67], a[24:27], v[28:31], 0
buffer_load_dwordx4 a[140:143], v0, s[4:7], s64 offen offset:3072
v_mfma_f32_16x16x32_bf16 v[68:71], a[36:39], v[28:31], 0
v_mfma_f32_16x16x32_bf16 v[56:59], a[48:51], v[100:103], v[56:59]
v_mfma_f32_16x16x32_bf16 v[60:63], a[60:63], v[100:103], v[60:63]
s_waitcnt vmcnt(10)
s_add_u32 s63, s42, 0x9000
buffer_load_dwordx4 a[148:151], v0, s[4:7], s63 offen offset:1024
v_mfma_f32_16x16x32_bf16 v[64:67], a[72:75], v[100:103], v[64:67]
v_mfma_f32_16x16x32_bf16 v[68:71], a[84:87], v[100:103], v[68:71]
ds_read_b128 v[100:103], v15 offset:384
v_mfma_f32_16x16x32_bf16 v[56:59], a[96:99], v[104:107], v[56:59]
buffer_load_dwordx4 a[152:155], v0, s[4:7], s63 offen offset:2048
s_waitcnt vmcnt(11)
v_mfma_f32_16x16x32_bf16 v[60:63], a[108:111], v[104:107], v[60:63]
v_mfma_f32_16x16x32_bf16 v[64:67], a[120:123], v[104:107], v[64:67]
s_add_u32 s65, s42, 0xa000
buffer_load_dwordx4 a[160:163], v0, s[4:7], s65 offen offset:0
v_mfma_f32_16x16x32_bf16 v[68:71], a[132:135], v[104:107], v[68:71]
v_mfma_f32_16x16x32_bf16 v[56:59], a[144:147], v[108:111], v[56:59]
v_mfma_f32_16x16x32_bf16 v[60:63], a[156:159], v[108:111], v[60:63]
buffer_load_dwordx4 a[164:167], v0, s[4:7], s65 offen offset:1024
v_mfma_f32_16x16x32_bf16 v[64:67], a[168:171], v[108:111], v[64:67]
v_mfma_f32_16x16x32_bf16 v[68:71], a[180:183], v[108:111], v[68:71]
s_nop 3
ds_write_b128 v18, v[56:59] offset:16384
ds_write_b128 v19, v[60:63] offset:16384
s_nop 0
ds_write_b128 v18, v[64:67] offset:16512
ds_write_b128 v19, v[68:71] offset:16512
s_waitcnt vmcnt(9)
s_barrier
s_add_u32 s69, s35, 0x520000
ds_read_b128 v[72:75], v12 offset:32768
s_waitcnt vmcnt(7)
s_waitcnt vmcnt(6)
s_cbranch_vccnz SIG_45
buffer_store_dword v126, v2, s[4:7], s36 offen offset:2688
SRET_45:
ds_read_b128 v[76:79], v13 offset:32768
s_waitcnt lgkmcnt(2)
ds_read_b128 v[80:83], v12 offset:33792
s_barrier
ds_read_b128 v[84:87], v13 offset:33792
buffer_load_dwordx4 v[52:55], v14, s[4:7], s69 offen offset:3072 sc1
ds_read_b128 v[56:59], v20 offset:16384
ds_read_b128 v[60:63], v20 offset:20480
ds_read_b128 v[64:67], v20 offset:24576
ds_read_b128 v[68:71], v20 offset:28672
v_cmp_eq_u32_e64 s[58:59], v126, v23
s_waitcnt lgkmcnt(7)
v_mfma_f32_16x16x32_bf16 v[40:43], a[192:195], v[72:75], 0
v_mfma_f32_16x16x32_bf16 v[44:47], a[196:199], v[72:75], 0
s_waitcnt lgkmcnt(6)
s_cmp_eq_u64 s[58:59], s[56:57]
s_cbranch_scc0 CHK_47
CRET_47:
v_mfma_f32_16x16x32_bf16 v[48:51], a[200:203], v[72:75], 0
ds_read_b128 v[72:75], v12 offset:34816
s_add_u32 s68, s30, 0x808000
s_add_u32 m0, s38, 0x18000
v_mfma_f32_16x16x32_bf16 v[40:43], a[204:207], v[76:79], v[40:43]
buffer_load_dwordx4 v0, s[4:7], s68 offen offset:0 sc1 lds
s_waitcnt lgkmcnt(6)
v_mfma_f32_16x16x32_bf16 v[44:47], a[208:211], v[76:79], v[44:47]
buffer_load_dwordx4 v0, s[4:7], s68 offen offset:1024 sc1 lds
v_mfma_f32_16x16x32_bf16 v[48:51], a[212:215], v[76:79], v[48:51]
s_waitcnt lgkmcnt(3)
ds_read_b128 v[76:79], v13 offset:34816
v_mfma_f32_16x16x32_bf16 v[40:43], a[216:219], v[80:83], v[40:43]
buffer_load_dwordx4 v0, s[4:7], s68 offen offset:2048 sc1 lds
v_mfma_f32_16x16x32_bf16 v[44:47], a[220:223], v[80:83], v[44:47]
s_waitcnt lgkmcnt(2)
v_add_f32 v56, v56, v60
v_add_f32 v64, v64, v68
v_mfma_f32_16x16x32_bf16 v[48:51], a[224:227], v[80:83], v[48:51]
ds_read_b128 v[80:83], v12 offset:35840
v_add_f32 v112, v112, v56
v_mfma_f32_16x16x32_bf16 v[40:43], a[228:231], v[84:87], v[40:43]
buffer_load_dwordx4 v0, s[4:7], s68 offen offset:3072 sc1 lds
v_mfma_f32_16x16x32_bf16 v[44:47], a[232:235], v[84:87], v[44:47]
s_waitcnt lgkmcnt(2)
v_add_f32 v57, v57, v61
v_add_f32 v58, v58, v62
v_mfma_f32_16x16x32_bf16 v[48:51], a[236:239], v[84:87], v[48:51]
ds_read_b128 v[84:87], v13 offset:35840
v_add_f32 v59, v59, v63
v_mfma_f32_16x16x32_bf16 v[40:43], a[240:243], v[72:75], v[40:43]
v_add_f32 v112, v112, v64
v_add_f32 v65, v65, v69
v_mfma_f32_16x16x32_bf16 v[44:47], a[244:247], v[72:75], v[44:47]
s_waitcnt lgkmcnt(2)
v_add_f32 v113, v113, v57
v_add_f32 v66, v66, v70
v_mfma_f32_16x16x32_bf16 v[48:51], a[248:251], v[72:75], v[48:51]
ds_read_b128 v[72:75], v12 offset:36864
v_add_f32 v114, v114, v58
v_mfma_f32_16x16x32_bf16 v[40:43], a[252:255], v[76:79], v[40:43]
v_add_f32 v67, v67, v71
v_add_f32 v115, v115, v59
v_mfma_f32_16x16x32_bf16 v[44:47], v[128:131], v[76:79], v[44:47]
s_waitcnt lgkmcnt(2)
v_add_f32 v113, v113, v65
v_add_f32 v114, v114, v66
v_mfma_f32_16x16x32_bf16 v[48:51], v[132:135], v[76:79], v[48:51]
ds_read_b128 v[76:79], v13 offset:36864
v_add_f32 v115, v115, v67
v_mfma_f32_16x16x32_bf16 v[40:43], v[136:139], v[80:83], v[40:43]
v_mul_f32 v117, v112, v112
v_add_f32 v116, v112, v113
v_mfma_f32_16x16x32_bf16 v[44:47], v[140:143], v[80:83], v[44:47]
s_waitcnt lgkmcnt(2)
v_add_f32 v118, v114, v115
v_fmac_f32 v117, v113, v113
v_mfma_f32_16x16x32_bf16 v[48:51], v[144:147], v[80:83], v[48:51]
ds_read_b128 v[80:83], v12 offset:37888
v_add_f32 v116, v116, v118
v_mfma_f32_16x16x32_bf16 v[40:43], v[148:151], v[84:87], v[40:43]
v_fmac_f32 v117, v114, v114
v_fmac_f32 v117, v115, v115
v_mfma_f32_16x16x32_bf16 v[44:47], v[152:155], v[84:87], v[44:47]
s_waitcnt lgkmcnt(2)
v_add_f32_dpp v116, v116, v116 row_ror:8 row_mask:0xf bank_mask:0xf
v_cvt_pk_bf16_f32 v4, v112, v113
v_mfma_f32_16x16x32_bf16 v[48:51], v[156:159], v[84:87], v[48:51]
ds_read_b128 v[84:87], v13 offset:37888
v_add_f32_dpp v116, v117, v117 row_ror:8 row_mask:0xf bank_mask:0xc
v_mfma_f32_16x16x32_bf16 v[40:43], v[160:163], v[72:75], v[40:43]
s_nop 0
v_add_f32_dpp v116, v116, v116 row_half_mirror row_mask:0xf bank_mask:0xf
v_cvt_pk_bf16_f32 v5, v114, v115
v_mfma_f32_16x16x32_bf16 v[44:47], v[164:167], v[72:75], v[44:47]
s_waitcnt lgkmcnt(2)
v_add_f32_dpp v116, v116, v116 quad_perm:[2,3,0,1] row_mask:0xf bank_mask:0xf
s_add_u32 s62, s29, 0x800000
v_mfma_f32_16x16x32_bf16 v[48:51], v[168:171], v[72:75], v[48:51]
ds_read_b128 v[72:75], v12 offset:38912
v_add_f32_dpp v116, v116, v116 quad_perm:[1,0,3,2] row_mask:0xf bank_mask:0xf
v_mfma_f32_16x16x32_bf16 v[40:43], v[172:175], v[76:79], v[40:43]
s_add_u32 s78, s35, 0x520000
buffer_store_dwordx2 v[4:5], v21, s[4:7], s62 offen
s_waitcnt lgkmcnt(2)
v_mfma_f32_16x16x32_bf16 v[44:47], v[176:179], v[76:79], v[44:47]
buffer_store_dword v116, v22, s[4:7], s78 offen offset:0
buffer_load_dword v39, v3, s[4:7], s36 offen offset:2688 sc1
v_mfma_f32_16x16x32_bf16 v[48:51], v[180:183], v[76:79], v[48:51]
ds_read_b128 v[76:79], v13 offset:38912
ds_read_b128 v[112:115], v15 offset:448
v_mfma_f32_16x16x32_bf16 v[40:43], v[184:187], v[80:83], v[40:43]
ds_read_b128 v[116:119], v15 offset:512
s_waitcnt lgkmcnt(4)
v_mfma_f32_16x16x32_bf16 v[44:47], v[188:191], v[80:83], v[44:47]
v_mfma_f32_16x16x32_bf16 v[48:51], v[192:195], v[80:83], v[48:51]
ds_read_b128 v[80:83], v12 offset:39936
v_mfma_f32_16x16x32_bf16 v[40:43], v[196:199], v[84:87], v[40:43]
s_waitcnt vmcnt(7)
v_add_f32 v52, v52, v54
v_add_f32 v53, v53, v55
v_mfma_f32_16x16x32_bf16 v[44:47], v[200:203], v[84:87], v[44:47]
s_waitcnt lgkmcnt(4)
v_mfma_f32_16x16x32_bf16 v[48:51], v[204:207], v[84:87], v[48:51]
ds_read_b128 v[84:87], v13 offset:39936
v_mfma_f32_16x16x32_bf16 v[40:43], v[208:211], v[72:75], v[40:43]
v_mfma_f32_16x16x32_bf16 v[44:47], v[212:215], v[72:75], v[44:47]
s_waitcnt lgkmcnt(4)
v_mfma_f32_16x16x32_bf16 v[48:51], v[216:219], v[72:75], v[48:51]
v_mfma_f32_16x16x32_bf16 v[40:43], v[220:223], v[76:79], v[40:43]
v_mfma_f32_16x16x32_bf16 v[44:47], v[224:227], v[76:79], v[44:47]
s_waitcnt lgkmcnt(1)
v_mfma_f32_16x16x32_bf16 v[48:51], v[228:231], v[76:79], v[48:51]
v_mfma_f32_16x16x32_bf16 v[40:43], v[232:235], v[80:83], v[40:43]
v_mfma_f32_16x16x32_bf16 v[44:47], v[236:239], v[80:83], v[44:47]
s_waitcnt lgkmcnt(0)
v_mfma_f32_16x16x32_bf16 v[48:51], v[240:243], v[80:83], v[48:51]
v_mfma_f32_16x16x32_bf16 v[40:43], v[244:247], v[84:87], v[40:43]
v_mfma_f32_16x16x32_bf16 v[44:47], v[248:251], v[84:87], v[44:47]
v_mfma_f32_16x16x32_bf16 v[48:51], v[252:255], v[84:87], v[48:51]
v_mfma_f32_16x16x4_f32 v[104:107], v36, v52, 0
s_waitcnt vmcnt(3)
s_barrier
v_mfma_f32_16x16x4_f32 v[108:111], v36, v53, 0
s_add_u32 s67, s35, 0x520000
ds_read_b128 v[72:75], v12 offset:0
ds_read_b128 v[76:79], v13 offset:0
ds_read_b128 v[80:83], v12 offset:1024
ds_read_b128 v[84:87], v13 offset:1024
buffer_load_dwordx4 v[68:71], v14, s[4:7], s67 offen offset:2048 sc1
s_nop 3
v_fma_f32 v108, -v104, v104, v108
v_max_f32 v108, 0, v108
v_add_f32 v108, s45, v108
v_rsq_f32 v108, v108
s_nop 0
v_mul_f32 v108, s44, v108
v_mul_f32_e64 v104, -v104, v108
v_fma_f32 v120, v104, v88, v100
v_fma_f32 v121, v104, v89, v101
v_fma_f32 v122, v104, v90, v102
v_fma_f32 v40, v40, v108, v120
v_fma_f32 v41, v41, v108, v121
s_waitcnt vmcnt(2)
s_cbranch_vccnz SIG_49
buffer_store_dword v126, v2, s[4:7], s36 offen offset:2560
SRET_49:
v_fma_f32 v42, v42, v108, v122
s_waitcnt lgkmcnt(3)
v_mfma_f32_16x16x32_bf16 v[56:59], a[192:195], v[72:75], 0
s_add_u32 s79, s42, 0xa000
v_fma_f32 v123, v104, v91, v103
v_fma_f32 v37, v104, v92, v112
v_mfma_f32_16x16x32_bf16 v[60:63], a[196:199], v[72:75], 0
s_waitcnt lgkmcnt(2)
v_fma_f32 v125, v104, v94, v114
v_fma_f32 v120, v104, v95, v115
v_mfma_f32_16x16x32_bf16 v[64:67], a[200:203], v[72:75], 0
ds_read_b128 v[72:75], v12 offset:2048
v_fma_f32 v124, v104, v93, v113
v_mfma_f32_16x16x32_bf16 v[56:59], a[204:207], v[76:79], v[56:59]
buffer_load_dwordx4 a[172:175], v0, s[4:7], s79 offen offset:3072
s_waitcnt lgkmcnt(2)
v_mfma_f32_16x16x32_bf16 v[60:63], a[208:211], v[76:79], v[60:63]
v_fma_f32 v121, v104, v96, v116
v_fma_f32 v122, v104, v97, v117
v_mfma_f32_16x16x32_bf16 v[64:67], a[212:215], v[76:79], v[64:67]
ds_read_b128 v[76:79], v13 offset:2048
v_fma_f32 v43, v43, v108, v123
v_mfma_f32_16x16x32_bf16 v[56:59], a[216:219], v[80:83], v[56:59]
v_fma_f32 v44, v44, v108, v37
v_fma_f32 v46, v46, v108, v125
v_mfma_f32_16x16x32_bf16 v[60:63], a[220:223], v[80:83], v[60:63]
s_waitcnt vmcnt(3)
v_cmp_eq_u32_e64 s[76:77], v126, v39
v_fma_f32 v47, v47, v108, v120
v_mfma_f32_16x16x32_bf16 v[64:67], a[224:227], v[80:83], v[64:67]
s_waitcnt lgkmcnt(2)
ds_read_b128 v[80:83], v12 offset:3072
v_mfma_f32_16x16x32_bf16 v[56:59], a[228:231], v[84:87], v[56:59]
v_fma_f32 v45, v45, v108, v124
v_fma_f32 v48, v48, v108, v121
v_mfma_f32_16x16x32_bf16 v[60:63], a[232:235], v[84:87], v[60:63]
s_waitcnt lgkmcnt(2)
s_cmp_eq_u64 s[76:77], s[56:57]
s_cbranch_scc0 CHK_51
CRET_51:
v_mfma_f32_16x16x32_bf16 v[64:67], a[236:239], v[84:87], v[64:67]
ds_read_b128 v[84:87], v13 offset:3072
s_add_u32 s66, s30, 0x804000
s_add_u32 m0, s38, 0x1c000
v_mfma_f32_16x16x32_bf16 v[56:59], a[240:243], v[72:75], v[56:59]
buffer_load_dwordx4 v0, s[4:7], s66 offen offset:0 sc1 lds
s_waitcnt lgkmcnt(2)
v_mfma_f32_16x16x32_bf16 v[60:63], a[244:247], v[72:75], v[60:63]
buffer_load_dwordx4 v0, s[4:7], s66 offen offset:1024 sc1 lds
v_mfma_f32_16x16x32_bf16 v[64:67], a[248:251], v[72:75], v[64:67]
ds_read_b128 v[72:75], v12 offset:4096
buffer_load_dwordx4 v0, s[4:7], s66 offen offset:2048 sc1 lds
v_mfma_f32_16x16x32_bf16 v[56:59], a[252:255], v[76:79], v[56:59]
buffer_load_dwordx4 v0, s[4:7], s66 offen offset:3072 sc1 lds
s_waitcnt lgkmcnt(2)
v_mfma_f32_16x16x32_bf16 v[60:63], v[128:131], v[76:79], v[60:63]
buffer_load_dwordx4 a[0:3], v0, s[4:7], s42 offen offset:0
v_mfma_f32_16x16x32_bf16 v[64:67], v[132:135], v[76:79], v[64:67]
ds_read_b128 v[76:79], v13 offset:4096
v_fma_f32 v49, v49, v108, v122
v_mfma_f32_16x16x32_bf16 v[56:59], v[136:139], v[80:83], v[56:59]
v_fmaak_f32 v125, v41, v41, 0x409d30fc
v_fmaak_f32 v120, v42, v42, 0x409d30fc
v_mfma_f32_16x16x32_bf16 v[60:63], v[140:143], v[80:83], v[60:63]
s_waitcnt lgkmcnt(2)
v_fmaak_f32 v124, v40, v40, 0x409d30fc
v_fmaak_f32 v121, v43, v43, 0x409d30fc
v_mfma_f32_16x16x32_bf16 v[64:67], v[144:147], v[80:83], v[64:67]
ds_read_b128 v[80:83], v12 offset:5120
v_fmaak_f32 v122, v44, v44, 0x409d30fc
v_mfma_f32_16x16x32_bf16 v[56:59], v[148:151], v[84:87], v[56:59]
v_mul_f32 v125, v41, v125
v_mul_f32 v120, v42, v120
v_mfma_f32_16x16x32_bf16 v[60:63], v[152:155], v[84:87], v[60:63]
s_waitcnt lgkmcnt(2)
v_mul_f32 v124, v40, v124
v_mul_f32 v121, v43, v121
v_mfma_f32_16x16x32_bf16 v[64:67], v[156:159], v[84:87], v[64:67]
ds_read_b128 v[84:87], v13 offset:5120
v_mul_f32 v122, v44, v122
v_mfma_f32_16x16x32_bf16 v[56:59], v[160:163], v[72:75], v[56:59]
buffer_load_dwordx4 a[12:15], v0, s[4:7], s42 offen offset:3072
v_mfma_f32_16x16x32_bf16 v[60:63], v[164:167], v[72:75], v[60:63]
s_waitcnt lgkmcnt(2)
v_exp_f32_e64 v125, -v125
v_mfma_f32_16x16x32_bf16 v[64:67], v[168:171], v[72:75], v[64:67]
ds_read_b128 v[72:75], v12 offset:6144
v_exp_f32_e64 v120, -v120
v_mfma_f32_16x16x32_bf16 v[56:59], v[172:175], v[76:79], v[56:59]
v_exp_f32_e64 v124, -v124
v_mfma_f32_16x16x32_bf16 v[60:63], v[176:179], v[76:79], v[60:63]
s_waitcnt lgkmcnt(2)
v_exp_f32_e64 v121, -v121
v_mfma_f32_16x16x32_bf16 v[64:67], v[180:183], v[76:79], v[64:67]
ds_read_b128 v[76:79], v13 offset:6144
v_exp_f32_e64 v122, -v122
v_mfma_f32_16x16x32_bf16 v[56:59], v[184:187], v[80:83], v[56:59]
v_fma_f32 v125, v125, s44, s44
v_fma_f32 v120, v120, s44, s44
v_mfma_f32_16x16x32_bf16 v[60:63], v[188:191], v[80:83], v[60:63]
s_waitcnt lgkmcnt(2)
v_fma_f32 v124, v124, s44, s44
v_fma_f32 v121, v121, s44, s44
v_mfma_f32_16x16x32_bf16 v[64:67], v[192:195], v[80:83], v[64:67]
ds_read_b128 v[80:83], v12 offset:7168
v_fma_f32 v122, v122, s44, s44
v_mfma_f32_16x16x32_bf16 v[56:59], v[196:199], v[84:87], v[56:59]
s_waitcnt vmcnt(8)
v_rcp_f32 v125, v125
v_mfma_f32_16x16x32_bf16 v[60:63], v[200:203], v[84:87], v[60:63]
s_waitcnt lgkmcnt(2)
v_rcp_f32 v120, v120
v_mfma_f32_16x16x32_bf16 v[64:67], v[204:207], v[84:87], v[64:67]
ds_read_b128 v[84:87], v13 offset:7168
buffer_load_dword v127, v3, s[4:7], s36 offen offset:2560 sc1
v_mfma_f32_16x16x32_bf16 v[56:59], v[208:211], v[72:75], v[56:59]
s_add_u32 s64, s42, 0x1000
v_rcp_f32 v124, v124
v_mfma_f32_16x16x32_bf16 v[60:63], v[212:215], v[72:75], v[60:63]
s_waitcnt lgkmcnt(2)
v_rcp_f32 v121, v121
v_mfma_f32_16x16x32_bf16 v[64:67], v[216:219], v[72:75], v[64:67]
buffer_load_dwordx4 a[24:27], v0, s[4:7], s64 offen offset:2048
v_mfma_f32_16x16x32_bf16 v[56:59], v[220:223], v[76:79], v[56:59]
v_rcp_f32 v122, v122
v_mfma_f32_16x16x32_bf16 v[60:63], v[224:227], v[76:79], v[60:63]
s_waitcnt lgkmcnt(1)
v_fma_f32 v123, v104, v98, v118
v_fma_f32 v37, v104, v99, v119
v_mfma_f32_16x16x32_bf16 v[64:67], v[228:231], v[76:79], v[64:67]
v_fma_f32 v50, v50, v108, v123
v_fma_f32 v51, v51, v108, v37
v_mfma_f32_16x16x32_bf16 v[56:59], v[232:235], v[80:83], v[56:59]
v_mul_f32 v41, v41, v125
v_mul_f32 v42, v42, v120
v_mfma_f32_16x16x32_bf16 v[60:63], v[236:239], v[80:83], v[60:63]
s_waitcnt lgkmcnt(0)
v_mul_f32 v40, v40, v124
v_mul_f32 v43, v43, v121
v_mfma_f32_16x16x32_bf16 v[64:67], v[240:243], v[80:83], v[64:67]
v_mul_f32 v44, v44, v122
v_fmaak_f32 v125, v48, v48, 0x409d30fc
v_mfma_f32_16x16x32_bf16 v[56:59], v[244:247], v[84:87], v[56:59]
v_fmaak_f32 v120, v49, v49, 0x409d30fc
v_fmaak_f32 v123, v45, v45, 0x409d30fc
v_mfma_f32_16x16x32_bf16 v[60:63], v[248:251], v[84:87], v[60:63]
v_fmaak_f32 v37, v46, v46, 0x409d30fc
v_fmaak_f32 v124, v47, v47, 0x409d30fc
v_mfma_f32_16x16x32_bf16 v[64:67], v[252:255], v[84:87], v[64:67]
v_fmaak_f32 v121, v50, v50, 0x409d30fc
v_fmaak_f32 v122, v51, v51, 0x409d30fc
v_mul_f32 v125, v48, v125
v_mul_f32 v120, v49, v120
v_mul_f32 v123, v45, v123
v_mul_f32 v37, v46, v37
v_mul_f32 v124, v47, v124
v_mul_f32 v121, v50, v121
v_mul_f32 v122, v51, v122
v_exp_f32_e64 v125, -v125
v_exp_f32_e64 v120, -v120
v_exp_f32_e64 v123, -v123
v_exp_f32_e64 v37, -v37
v_exp_f32_e64 v124, -v124
v_exp_f32_e64 v121, -v121
v_exp_f32_e64 v122, -v122
v_fma_f32 v125, v125, s44, s44
v_fma_f32 v120, v120, s44, s44
v_fma_f32 v123, v123, s44, s44
v_fma_f32 v37, v37, s44, s44
v_fma_f32 v124, v124, s44, s44
v_fma_f32 v121, v121, s44, s44
v_fma_f32 v122, v122, s44, s44
v_rcp_f32 v125, v125
v_rcp_f32 v120, v120
v_rcp_f32 v123, v123
v_rcp_f32 v37, v37
v_rcp_f32 v124, v124
v_rcp_f32 v121, v121
v_rcp_f32 v122, v122
v_mul_f32 v48, v48, v125
v_mul_f32 v49, v49, v120
v_mul_f32 v45, v45, v123
v_mul_f32 v46, v46, v37
v_mul_f32 v47, v47, v124
v_mul_f32 v50, v50, v121
v_mul_f32 v51, v51, v122
v_cvt_pk_bf16_f32 v48, v48, v49
v_cvt_pk_bf16_f32 v52, v40, v41
v_cvt_pk_bf16_f32 v53, v42, v43
v_cvt_pk_bf16_f32 v54, v44, v45
s_waitcnt vmcnt(4)
s_barrier
v_cvt_pk_bf16_f32 v55, v46, v47
s_add_u32 s63, s32, 0xb21000
buffer_store_dwordx4 v[52:55], v0, s[4:7], s63 offen
s_add_u32 s65, s35, 0x520000
v_cvt_pk_bf16_f32 v49, v50, v51
s_add_u32 s69, s33, 0xb21000
buffer_store_dwordx2 v[48:49], v1, s[4:7], s69 offen
ds_read_b128 v[72:75], v12 offset:16384
ds_read_b128 v[76:79], v13 offset:16384
ds_read_b128 v[80:83], v12 offset:17408
ds_read_b128 v[84:87], v13 offset:17408
v_add_f32 v68, v68, v70
v_add_f32 v69, v69, v71
s_nop 0
v_mfma_f32_16x16x4_f32 v[104:107], v36, v68, 0
buffer_load_dwordx4 v[52:55], v14, s[4:7], s65 offen offset:1024 sc1
v_mfma_f32_16x16x4_f32 v[108:111], v36, v69, 0
s_waitcnt vmcnt(4)
v_cmp_eq_u32_e64 s[58:59], v126, v127
s_waitcnt lgkmcnt(3)
v_mfma_f32_16x16x32_bf16 v[40:43], a[192:195], v[72:75], 0
s_add_u32 s68, s42, 0x2000
buffer_load_dwordx4 a[36:39], v0, s[4:7], s68 offen offset:1024
s_waitcnt lgkmcnt(2)
v_mfma_f32_16x16x32_bf16 v[44:47], a[196:199], v[72:75], 0
s_cmp_eq_u64 s[58:59], s[56:57]
s_cbranch_scc0 CHK_53
CRET_53:
v_mfma_f32_16x16x32_bf16 v[48:51], a[200:203], v[72:75], 0
s_add_u32 s62, s30, 0x800000
s_add_u32 m0, s38, 0x20000
ds_read_b128 v[72:75], v12 offset:18432
buffer_load_dwordx4 v0, s[4:7], s62 offen offset:0 sc1 lds
buffer_load_dwordx4 v0, s[4:7], s62 offen offset:1024 sc1 lds
buffer_load_dwordx4 v0, s[4:7], s62 offen offset:2048 sc1 lds
buffer_load_dwordx4 v0, s[4:7], s62 offen offset:3072 sc1 lds
v_mfma_f32_16x16x32_bf16 v[40:43], a[204:207], v[76:79], v[40:43]
v_fma_f32 v108, -v104, v104, v108
v_max_f32 v108, 0, v108
v_mfma_f32_16x16x32_bf16 v[44:47], a[208:211], v[76:79], v[44:47]
s_waitcnt lgkmcnt(1)
v_add_f32 v108, s45, v108
v_rsq_f32 v108, v108
v_mfma_f32_16x16x32_bf16 v[48:51], a[212:215], v[76:79], v[48:51]
ds_read_b128 v[76:79], v13 offset:18432
v_mul_f32 v108, s44, v108
v_mfma_f32_16x16x32_bf16 v[40:43], a[216:219], v[80:83], v[40:43]
v_mul_f32_e64 v104, -v104, v108
v_fma_f32 v123, v104, v88, v100
v_mfma_f32_16x16x32_bf16 v[44:47], a[220:223], v[80:83], v[44:47]
v_fma_f32 v37, v104, v89, v101
v_fma_f32 v124, v104, v90, v102
v_mfma_f32_16x16x32_bf16 v[48:51], a[224:227], v[80:83], v[48:51]
ds_read_b128 v[80:83], v12 offset:19456
v_fma_f32 v56, v56, v108, v123
v_mfma_f32_16x16x32_bf16 v[40:43], a[228:231], v[84:87], v[40:43]
v_fma_f32 v57, v57, v108, v37
v_fma_f32 v58, v58, v108, v124
v_mfma_f32_16x16x32_bf16 v[44:47], a[232:235], v[84:87], v[44:47]
s_waitcnt lgkmcnt(2)
v_fma_f32 v125, v104, v91, v103
v_fma_f32 v120, v104, v92, v112
v_mfma_f32_16x16x32_bf16 v[48:51], a[236:239], v[84:87], v[48:51]
ds_read_b128 v[84:87], v13 offset:19456
v_fma_f32 v122, v104, v94, v114
v_mfma_f32_16x16x32_bf16 v[40:43], a[240:243], v[72:75], v[40:43]
v_fma_f32 v123, v104, v95, v115
v_fma_f32 v121, v104, v93, v113
v_mfma_f32_16x16x32_bf16 v[44:47], a[244:247], v[72:75], v[44:47]
s_waitcnt lgkmcnt(2)
v_fma_f32 v37, v104, v96, v116
v_fma_f32 v124, v104, v97, v117
v_mfma_f32_16x16x32_bf16 v[48:51], a[248:251], v[72:75], v[48:51]
ds_read_b128 v[72:75], v12 offset:20480
v_fma_f32 v59, v59, v108, v125
v_mfma_f32_16x16x32_bf16 v[40:43], a[252:255], v[76:79], v[40:43]
v_fma_f32 v60, v60, v108, v120
v_fma_f32 v62, v62, v108, v122
v_mfma_f32_16x16x32_bf16 v[44:47], v[128:131], v[76:79], v[44:47]
s_waitcnt lgkmcnt(2)
v_fma_f32 v63, v63, v108, v123
v_fma_f32 v61, v61, v108, v121
v_mfma_f32_16x16x32_bf16 v[48:51], v[132:135], v[76:79], v[48:51]
s_waitcnt vmcnt(6)
s_cbranch_vccnz SIG_50
buffer_store_dword v126, v2, s[4:7], s36 offen offset:3456
SRET_50:
s_add_u32 s78, s42, 0x3000
ds_read_b128 v[76:79], v13 offset:20480
v_mfma_f32_16x16x32_bf16 v[40:43], v[136:139], v[80:83], v[40:43]
buffer_load_dwordx4 a[48:51], v0, s[4:7], s78 offen offset:0
s_waitcnt lgkmcnt(2)
v_mfma_f32_16x16x32_bf16 v[44:47], v[140:143], v[80:83], v[44:47]
v_fma_f32 v64, v64, v108, v37
v_fma_f32 v65, v65, v108, v124
v_mfma_f32_16x16x32_bf16 v[48:51], v[144:147], v[80:83], v[48:51]
ds_read_b128 v[80:83], v12 offset:21504
v_fmaak_f32 v122, v57, v57, 0x409d30fc
v_mfma_f32_16x16x32_bf16 v[40:43], v[148:151], v[84:87], v[40:43]
v_fmaak_f32 v123, v58, v58, 0x409d30fc
v_fmaak_f32 v121, v56, v56, 0x409d30fc
v_mfma_f32_16x16x32_bf16 v[44:47], v[152:155], v[84:87], v[44:47]
s_waitcnt lgkmcnt(2)
v_fmaak_f32 v37, v59, v59, 0x409d30fc
v_fmaak_f32 v124, v60, v60, 0x409d30fc
v_mfma_f32_16x16x32_bf16 v[48:51], v[156:159], v[84:87], v[48:51]
ds_read_b128 v[84:87], v13 offset:21504
v_mul_f32 v122, v57, v122
v_mul_f32 v123, v58, v123
v_mul_f32 v121, v56, v121
v_mul_f32 v37, v59, v37
v_mul_f32 v124, v60, v124
v_exp_f32_e64 v122, -v122
v_exp_f32_e64 v123, -v123
v_exp_f32_e64 v121, -v121
v_exp_f32_e64 v37, -v37
v_exp_f32_e64 v124, -v124
v_mfma_f32_16x16x32_bf16 v[40:43], v[160:163], v[72:75], v[40:43]
v_fma_f32 v122, v122, s44, s44
v_fma_f32 v123, v123, s44, s44
v_mfma_f32_16x16x32_bf16 v[44:47], v[164:167], v[72:75], v[44:47]
s_waitcnt vmcnt(7)
v_fma_f32 v121, v121, s44, s44
v_fma_f32 v37, v37, s44, s44
v_mfma_f32_16x16x32_bf16 v[48:51], v[168:171], v[72:75], v[48:51]
s_waitcnt lgkmcnt(2)
v_fma_f32 v124, v124, s44, s44
v_rcp_f32 v122, v122
v_rcp_f32 v123, v123
v_rcp_f32 v121, v121
v_rcp_f32 v37, v37
v_rcp_f32 v124, v124
v_mfma_f32_16x16x32_bf16 v[40:43], v[172:175], v[76:79], v[40:43]
ds_read_b128 v[72:75], v12 offset:22528
s_waitcnt lgkmcnt(1)
v_fma_f32 v125, v104, v98, v118
v_mfma_f32_16x16x32_bf16 v[44:47], v[176:179], v[76:79], v[44:47]
v_fma_f32 v120, v104, v99, v119
v_fma_f32 v66, v66, v108, v125
v_mfma_f32_16x16x32_bf16 v[48:51], v[180:183], v[76:79], v[48:51]
ds_read_b128 v[76:79], v13 offset:22528
v_fma_f32 v67, v67, v108, v120
v_mul_f32 v57, v57, v122
v_mul_f32 v58, v58, v123
v_mul_f32 v56, v56, v121
v_mul_f32 v59, v59, v37
v_mul_f32 v60, v60, v124
v_fmaak_f32 v122, v64, v64, 0x409d30fc
v_fmaak_f32 v123, v65, v65, 0x409d30fc
v_fmaak_f32 v125, v61, v61, 0x409d30fc
v_fmaak_f32 v120, v62, v62, 0x409d30fc
v_fmaak_f32 v121, v63, v63, 0x409d30fc
v_fmaak_f32 v37, v66, v66, 0x409d30fc
v_fmaak_f32 v124, v67, v67, 0x409d30fc
v_mul_f32 v122, v64, v122
v_mul_f32 v123, v65, v123
v_mfma_f32_16x16x32_bf16 v[40:43], v[184:187], v[80:83], v[40:43]
v_mul_f32 v125, v61, v125
v_mul_f32 v120, v62, v120
v_mfma_f32_16x16x32_bf16 v[44:47], v[188:191], v[80:83], v[44:47]
v_mul_f32 v121, v63, v121
v_mul_f32 v37, v66, v37
v_mfma_f32_16x16x32_bf16 v[48:51], v[192:195], v[80:83], v[48:51]
ds_read_b128 v[80:83], v12 offset:23552
v_mul_f32 v124, v67, v124
v_exp_f32_e64 v122, -v122
v_exp_f32_e64 v123, -v123
v_exp_f32_e64 v125, -v125
v_exp_f32_e64 v120, -v120
v_exp_f32_e64 v121, -v121
v_exp_f32_e64 v37, -v37
v_exp_f32_e64 v124, -v124
v_fma_f32 v122, v122, s44, s44
v_fma_f32 v123, v123, s44, s44
v_mfma_f32_16x16x32_bf16 v[40:43], v[196:199], v[84:87], v[40:43]
buffer_load_dwordx4 a[60:63], v0, s[4:7], s78 offen offset:3072
s_waitcnt lgkmcnt(1)
v_mfma_f32_16x16x32_bf16 v[44:47], v[200:203], v[84:87], v[44:47]
v_fma_f32 v125, v125, s44, s44
v_fma_f32 v120, v120, s44, s44
v_mfma_f32_16x16x32_bf16 v[48:51], v[204:207], v[84:87], v[48:51]
ds_read_b128 v[84:87], v13 offset:23552
v_fma_f32 v121, v121, s44, s44
v_fma_f32 v37, v37, s44, s44
v_fma_f32 v124, v124, s44, s44
v_rcp_f32 v122, v122
v_rcp_f32 v123, v123
v_rcp_f32 v125, v125
v_rcp_f32 v120, v120
v_rcp_f32 v121, v121
v_rcp_f32 v37, v37
v_rcp_f32 v124, v124
v_mul_f32 v64, v64, v122
v_mul_f32 v65, v65, v123
v_mul_f32 v61, v61, v125
v_mul_f32 v62, v62, v120
v_mul_f32 v63, v63, v121
v_mul_f32 v66, v66, v37
v_mul_f32 v67, v67, v124
v_cvt_pk_bf16_f32 v64, v64, v65
v_cvt_pk_bf16_f32 v68, v56, v57
v_cvt_pk_bf16_f32 v69, v58, v59
v_cvt_pk_bf16_f32 v70, v60, v61
v_cvt_pk_bf16_f32 v71, v62, v63
v_cvt_pk_bf16_f32 v65, v66, v67
v_mfma_f32_16x16x32_bf16 v[40:43], v[208:211], v[72:75], v[40:43]
s_waitcnt vmcnt(3) lgkmcnt(0)
s_barrier
v_mfma_f32_16x16x32_bf16 v[44:47], v[212:215], v[72:75], v[44:47]
s_add_u32 s67, s32, 0xb16000
s_add_u32 s79, s33, 0xb16000
buffer_store_dwordx4 v[68:71], v0, s[4:7], s67 offen
s_add_u32 s66, s35, 0x520000
buffer_store_dwordx2 v[64:65], v1, s[4:7], s79 offen
v_mfma_f32_16x16x32_bf16 v[48:51], v[216:219], v[72:75], v[48:51]
ds_read_b128 v[72:75], v12 offset:32768
buffer_load_dwordx4 v[68:71], v14, s[4:7], s66 offen offset:0 sc1
v_mfma_f32_16x16x32_bf16 v[40:43], v[220:223], v[76:79], v[40:43]
v_add_f32 v52, v52, v54
v_add_f32 v53, v53, v55
v_mfma_f32_16x16x32_bf16 v[44:47], v[224:227], v[76:79], v[44:47]
v_mfma_f32_16x16x32_bf16 v[48:51], v[228:231], v[76:79], v[48:51]
ds_read_b128 v[76:79], v13 offset:32768
v_mfma_f32_16x16x32_bf16 v[40:43], v[232:235], v[80:83], v[40:43]
v_mfma_f32_16x16x32_bf16 v[44:47], v[236:239], v[80:83], v[44:47]
v_mfma_f32_16x16x32_bf16 v[48:51], v[240:243], v[80:83], v[48:51]
ds_read_b128 v[80:83], v12 offset:33792
v_mfma_f32_16x16x32_bf16 v[40:43], v[244:247], v[84:87], v[40:43]
s_waitcnt lgkmcnt(2)
v_mfma_f32_16x16x32_bf16 v[56:59], a[192:195], v[72:75], 0
s_add_u32 s64, s42, 0x4000
buffer_load_dwordx4 a[72:75], v0, s[4:7], s64 offen offset:2048
v_mfma_f32_16x16x32_bf16 v[60:63], a[196:199], v[72:75], 0
buffer_load_dword v23, v3, s[4:7], s36 offen offset:3456 sc1
v_mfma_f32_16x16x32_bf16 v[64:67], a[200:203], v[72:75], 0
ds_read_b128 v[72:75], v12 offset:34816
s_waitcnt lgkmcnt(2)
s_add_u32 s63, s42, 0x5000
v_mfma_f32_16x16x32_bf16 v[56:59], a[204:207], v[76:79], v[56:59]
buffer_load_dwordx4 a[84:87], v0, s[4:7], s63 offen offset:1024
v_mfma_f32_16x16x32_bf16 v[60:63], a[208:211], v[76:79], v[60:63]
v_mfma_f32_16x16x32_bf16 v[64:67], a[212:215], v[76:79], v[64:67]
ds_read_b128 v[76:79], v13 offset:34816
s_waitcnt lgkmcnt(2)
s_add_u32 s69, s42, 0x6000
v_mfma_f32_16x16x32_bf16 v[56:59], a[216:219], v[80:83], v[56:59]
buffer_load_dwordx4 a[96:99], v0, s[4:7], s69 offen offset:0
v_mfma_f32_16x16x32_bf16 v[60:63], a[220:223], v[80:83], v[60:63]
v_mfma_f32_16x16x32_bf16 v[64:67], a[224:227], v[80:83], v[64:67]
ds_read_b128 v[80:83], v12 offset:35840
buffer_load_dwordx4 a[108:111], v0, s[4:7], s69 offen offset:3072
v_mfma_f32_16x16x32_bf16 v[44:47], v[248:251], v[84:87], v[44:47]
v_mfma_f32_16x16x32_bf16 v[48:51], v[252:255], v[84:87], v[48:51]
ds_read_b128 v[84:87], v13 offset:33792
v_mfma_f32_16x16x4_f32 v[104:107], v36, v52, 0
v_mfma_f32_16x16x4_f32 v[108:111], v36, v53, 0
s_waitcnt lgkmcnt(0)
v_mfma_f32_16x16x32_bf16 v[56:59], a[228:231], v[84:87], v[56:59]
v_mfma_f32_16x16x32_bf16 v[60:63], a[232:235], v[84:87], v[60:63]
v_mfma_f32_16x16x32_bf16 v[64:67], a[236:239], v[84:87], v[64:67]
ds_read_b128 v[84:87], v13 offset:35840
s_add_u32 s65, s42, 0x7000
buffer_load_dwordx4 a[120:123], v0, s[4:7], s65 offen offset:2048
s_waitcnt vmcnt(7)
v_mfma_f32_16x16x32_bf16 v[56:59], a[240:243], v[72:75], v[56:59]
s_cbranch_vccnz SIG_52
buffer_store_dword v126, v2, s[4:7], s36 offen offset:3328
SRET_52:
v_mfma_f32_16x16x32_bf16 v[60:63], a[244:247], v[72:75], v[60:63]
v_fma_f32 v108, -v104, v104, v108
v_max_f32 v108, 0, v108
v_mfma_f32_16x16x32_bf16 v[64:67], a[248:251], v[72:75], v[64:67]
ds_read_b128 v[72:75], v12 offset:36864
s_add_u32 s68, s42, 0x8000
v_add_f32 v108, s45, v108
v_mfma_f32_16x16x32_bf16 v[56:59], a[252:255], v[76:79], v[56:59]
buffer_load_dwordx4 a[132:135], v0, s[4:7], s68 offen offset:1024
v_mfma_f32_16x16x32_bf16 v[60:63], v[128:131], v[76:79], v[60:63]
s_add_u32 s62, s42, 0x9000
v_rsq_f32 v108, v108
v_mfma_f32_16x16x32_bf16 v[64:67], v[132:135], v[76:79], v[64:67]
ds_read_b128 v[76:79], v13 offset:36864
v_mul_f32 v108, s44, v108
v_mfma_f32_16x16x32_bf16 v[56:59], v[136:139], v[80:83], v[56:59]
buffer_load_dwordx4 a[144:147], v0, s[4:7], s62 offen offset:0
s_waitcnt lgkmcnt(2)
v_mfma_f32_16x16x32_bf16 v[60:63], v[140:143], v[80:83], v[60:63]
buffer_load_dwordx4 a[156:159], v0, s[4:7], s62 offen offset:3072
v_mfma_f32_16x16x32_bf16 v[64:67], v[144:147], v[80:83], v[64:67]
ds_read_b128 v[80:83], v12 offset:37888
v_mul_f32_e64 v104, -v104, v108
v_mfma_f32_16x16x32_bf16 v[56:59], v[148:151], v[84:87], v[56:59]
v_fma_f32 v125, v104, v88, v100
v_fma_f32 v120, v104, v89, v101
v_mfma_f32_16x16x32_bf16 v[60:63], v[152:155], v[84:87], v[60:63]
s_waitcnt vmcnt(10)
v_fma_f32 v121, v104, v90, v102
v_fma_f32 v40, v40, v108, v125
v_mfma_f32_16x16x32_bf16 v[64:67], v[156:159], v[84:87], v[64:67]
s_waitcnt lgkmcnt(2)
ds_read_b128 v[84:87], v13 offset:37888
s_add_u32 s78, s42, 0xa000
v_mfma_f32_16x16x32_bf16 v[56:59], v[160:163], v[72:75], v[56:59]
buffer_load_dwordx4 a[168:171], v0, s[4:7], s78 offen offset:2048
v_mfma_f32_16x16x32_bf16 v[60:63], v[164:167], v[72:75], v[60:63]
s_waitcnt lgkmcnt(2)
v_fma_f32 v41, v41, v108, v120
v_fma_f32 v42, v42, v108, v121
v_mfma_f32_16x16x32_bf16 v[64:67], v[168:171], v[72:75], v[64:67]
ds_read_b128 v[72:75], v12 offset:38912
v_fma_f32 v122, v104, v91, v103
v_mfma_f32_16x16x32_bf16 v[56:59], v[172:175], v[76:79], v[56:59]
v_fma_f32 v123, v104, v92, v112
v_fma_f32 v124, v104, v94, v114
v_mfma_f32_16x16x32_bf16 v[60:63], v[176:179], v[76:79], v[60:63]
s_waitcnt lgkmcnt(2)
v_fma_f32 v125, v104, v95, v115
v_fma_f32 v37, v104, v93, v113
v_mfma_f32_16x16x32_bf16 v[64:67], v[180:183], v[76:79], v[64:67]
ds_read_b128 v[76:79], v13 offset:38912
v_fma_f32 v120, v104, v96, v116
v_mfma_f32_16x16x32_bf16 v[56:59], v[184:187], v[80:83], v[56:59]
v_fma_f32 v121, v104, v97, v117
v_fma_f32 v43, v43, v108, v122
v_mfma_f32_16x16x32_bf16 v[60:63], v[188:191], v[80:83], v[60:63]
s_waitcnt lgkmcnt(2)
v_fma_f32 v44, v44, v108, v123
v_fma_f32 v46, v46, v108, v124
v_mfma_f32_16x16x32_bf16 v[64:67], v[192:195], v[80:83], v[64:67]
ds_read_b128 v[80:83], v12 offset:39936
v_fma_f32 v47, v47, v108, v125
v_mfma_f32_16x16x32_bf16 v[56:59], v[196:199], v[84:87], v[56:59]
s_waitcnt vmcnt(9)
v_fma_f32 v45, v45, v108, v37
v_fma_f32 v48, v48, v108, v120
v_mfma_f32_16x16x32_bf16 v[60:63], v[200:203], v[84:87], v[60:63]
s_waitcnt lgkmcnt(2)
v_fma_f32 v49, v49, v108, v121
v_fmaak_f32 v124, v41, v41, 0x409d30fc
v_mfma_f32_16x16x32_bf16 v[64:67], v[204:207], v[84:87], v[64:67]
ds_read_b128 v[84:87], v13 offset:39936
v_fmaak_f32 v125, v42, v42, 0x409d30fc
v_mfma_f32_16x16x32_bf16 v[56:59], v[208:211], v[72:75], v[56:59]
v_fmaak_f32 v37, v40, v40, 0x409d30fc
v_fmaak_f32 v120, v43, v43, 0x409d30fc
v_mfma_f32_16x16x32_bf16 v[60:63], v[212:215], v[72:75], v[60:63]
s_waitcnt lgkmcnt(2)
v_fmaak_f32 v121, v44, v44, 0x409d30fc
v_mul_f32 v124, v41, v124
v_mfma_f32_16x16x32_bf16 v[64:67], v[216:219], v[72:75], v[64:67]
v_mul_f32 v125, v42, v125
v_mul_f32 v37, v40, v37
v_mfma_f32_16x16x32_bf16 v[56:59], v[220:223], v[76:79], v[56:59]
v_mul_f32 v120, v43, v120
v_mul_f32 v121, v44, v121
v_mfma_f32_16x16x32_bf16 v[60:63], v[224:227], v[76:79], v[60:63]
s_waitcnt lgkmcnt(1)
v_exp_f32_e64 v124, -v124
v_mfma_f32_16x16x32_bf16 v[64:67], v[228:231], v[76:79], v[64:67]
v_exp_f32_e64 v125, -v125
v_mfma_f32_16x16x32_bf16 v[56:59], v[232:235], v[80:83], v[56:59]
v_exp_f32_e64 v37, -v37
v_mfma_f32_16x16x32_bf16 v[60:63], v[236:239], v[80:83], v[60:63]
s_waitcnt lgkmcnt(0)
v_exp_f32_e64 v120, -v120
v_mfma_f32_16x16x32_bf16 v[64:67], v[240:243], v[80:83], v[64:67]
v_exp_f32_e64 v121, -v121
v_mfma_f32_16x16x32_bf16 v[56:59], v[244:247], v[84:87], v[56:59]
v_fma_f32 v124, v124, s44, s44
v_fma_f32 v125, v125, s44, s44
v_mfma_f32_16x16x32_bf16 v[60:63], v[248:251], v[84:87], v[60:63]
v_fma_f32 v37, v37, s44, s44
v_fma_f32 v120, v120, s44, s44
v_mfma_f32_16x16x32_bf16 v[64:67], v[252:255], v[84:87], v[64:67]
v_fma_f32 v121, v121, s44, s44
v_rcp_f32 v124, v124
v_rcp_f32 v125, v125
v_rcp_f32 v37, v37
buffer_load_dword v39, v3, s[4:7], s36 offen offset:3328 sc1
v_rcp_f32 v120, v120
v_rcp_f32 v121, v121
v_fma_f32 v122, v104, v98, v118
v_fma_f32 v123, v104, v99, v119
v_fma_f32 v50, v50, v108, v122
v_fma_f32 v51, v51, v108, v123
v_mul_f32 v41, v41, v124
v_mul_f32 v42, v42, v125
v_mul_f32 v40, v40, v37
v_mul_f32 v43, v43, v120
v_mul_f32 v44, v44, v121
v_fmaak_f32 v124, v48, v48, 0x409d30fc
v_fmaak_f32 v125, v49, v49, 0x409d30fc
v_fmaak_f32 v122, v45, v45, 0x409d30fc
v_fmaak_f32 v123, v46, v46, 0x409d30fc
v_fmaak_f32 v37, v47, v47, 0x409d30fc
v_fmaak_f32 v120, v50, v50, 0x409d30fc
v_fmaak_f32 v121, v51, v51, 0x409d30fc
v_mul_f32 v124, v48, v124
v_mul_f32 v125, v49, v125
v_mul_f32 v122, v45, v122
v_mul_f32 v123, v46, v123
v_mul_f32 v37, v47, v37
v_mul_f32 v120, v50, v120
v_mul_f32 v121, v51, v121
v_exp_f32_e64 v124, -v124
v_exp_f32_e64 v125, -v125
v_exp_f32_e64 v122, -v122
v_exp_f32_e64 v123, -v123
v_exp_f32_e64 v37, -v37
v_exp_f32_e64 v120, -v120
v_exp_f32_e64 v121, -v121
v_fma_f32 v124, v124, s44, s44
v_fma_f32 v125, v125, s44, s44
v_fma_f32 v122, v122, s44, s44
v_fma_f32 v123, v123, s44, s44
v_fma_f32 v37, v37, s44, s44
v_fma_f32 v120, v120, s44, s44
v_fma_f32 v121, v121, s44, s44
v_rcp_f32 v124, v124
v_rcp_f32 v125, v125
v_rcp_f32 v122, v122
v_rcp_f32 v123, v123
v_rcp_f32 v37, v37
v_rcp_f32 v120, v120
v_rcp_f32 v121, v121
v_mul_f32 v48, v48, v124
v_mul_f32 v49, v49, v125
v_mul_f32 v45, v45, v122
v_mul_f32 v46, v46, v123
v_mul_f32 v47, v47, v37
v_mul_f32 v50, v50, v120
v_mul_f32 v51, v51, v121
v_cvt_pk_bf16_f32 v48, v48, v49
v_cvt_pk_bf16_f32 v52, v40, v41
v_cvt_pk_bf16_f32 v53, v42, v43
v_cvt_pk_bf16_f32 v54, v44, v45
v_cvt_pk_bf16_f32 v55, v46, v47
s_add_u32 s67, s32, 0xb0b000
buffer_store_dwordx4 v[52:55], v0, s[4:7], s67 offen
v_cvt_pk_bf16_f32 v49, v50, v51
s_add_u32 s79, s33, 0xb0b000
buffer_store_dwordx2 v[48:49], v1, s[4:7], s79 offen
v_cmp_eq_u32_e64 s[76:77], v126, v23
v_add_f32 v68, v68, v70
v_add_f32 v69, v69, v71
s_nop 0
v_mfma_f32_16x16x4_f32 v[104:107], v36, v68, 0
s_cmp_eq_u64 s[76:77], s[56:57]
s_cbranch_scc0 CHK_56
CRET_56:
s_add_u32 s66, s34, 0xb21000
buffer_load_dwordx4 v[72:75], v0, s[4:7], s66 offen offset:0 sc1
buffer_load_dwordx4 v[76:79], v0, s[4:7], s66 offen offset:1024 sc1
buffer_load_dwordx4 v[80:83], v0, s[4:7], s66 offen offset:2048 sc1
v_mfma_f32_16x16x4_f32 v[108:111], v36, v69, 0
buffer_load_dwordx4 v[84:87], v0, s[4:7], s66 offen offset:3072 sc1
s_nop 1
v_and_b32 v105, s49, v10
v_lshlrev_b32 v106, 16, v11
v_and_b32 v107, s49, v11
s_nop 3
v_fma_f32 v108, -v104, v104, v108
v_max_f32 v108, 0, v108
v_add_f32 v108, s45, v108
v_rsq_f32 v108, v108
s_nop 0
v_mul_f32 v108, s44, v108
v_mul_f32_e64 v104, -v104, v108
v_fma_f32 v122, v104, v88, v100
v_fma_f32 v123, v104, v89, v101
v_fma_f32 v37, v104, v90, v102
v_fma_f32 v56, v56, v108, v122
v_fma_f32 v57, v57, v108, v123
v_fma_f32 v58, v58, v108, v37
v_fma_f32 v124, v104, v91, v103
s_add_u32 s64, s34, 0xb22000
buffer_load_dwordx4 v[88:91], v0, s[4:7], s64 offen offset:0 sc1
buffer_load_dwordx4 v[100:103], v0, s[4:7], s64 offen offset:3072 sc1
v_fma_f32 v125, v104, v92, v112
v_fma_f32 v121, v104, v94, v114
v_fma_f32 v122, v104, v95, v115
v_fma_f32 v120, v104, v93, v113
s_add_u32 s63, s34, 0xb23000
buffer_load_dwordx4 v[92:95], v0, s[4:7], s64 offen offset:1024 sc1
s_waitcnt vmcnt(9)
v_fma_f32 v123, v104, v96, v116
buffer_load_dwordx4 v[112:115], v0, s[4:7], s63 offen offset:0 sc1
v_fma_f32 v37, v104, v97, v117
v_fma_f32 v59, v59, v108, v124
v_fma_f32 v60, v60, v108, v125
v_fma_f32 v62, v62, v108, v121
v_fma_f32 v63, v63, v108, v122
v_fma_f32 v61, v61, v108, v120
v_fma_f32 v64, v64, v108, v123
v_fma_f32 v65, v65, v108, v37
v_fmaak_f32 v121, v57, v57, 0x409d30fc
v_fmaak_f32 v122, v58, v58, 0x409d30fc
v_fmaak_f32 v120, v56, v56, 0x409d30fc
v_fmaak_f32 v123, v59, v59, 0x409d30fc
v_fmaak_f32 v37, v60, v60, 0x409d30fc
v_mul_f32 v121, v57, v121
v_mul_f32 v122, v58, v122
v_mul_f32 v120, v56, v120
v_mul_f32 v123, v59, v123
v_mul_f32 v37, v60, v37
v_exp_f32_e64 v121, -v121
v_exp_f32_e64 v122, -v122
v_exp_f32_e64 v120, -v120
v_exp_f32_e64 v123, -v123
v_exp_f32_e64 v37, -v37
v_fma_f32 v121, v121, s44, s44
v_fma_f32 v122, v122, s44, s44
v_fma_f32 v120, v120, s44, s44
v_fma_f32 v123, v123, s44, s44
v_fma_f32 v37, v37, s44, s44
v_rcp_f32 v121, v121
v_rcp_f32 v122, v122
v_rcp_f32 v120, v120
v_rcp_f32 v123, v123
v_rcp_f32 v37, v37
v_fma_f32 v124, v104, v98, v118
v_fma_f32 v125, v104, v99, v119
buffer_load_dwordx4 v[96:99], v0, s[4:7], s64 offen offset:2048 sc1
s_waitcnt vmcnt(9)
buffer_load_dwordx4 v[116:119], v0, s[4:7], s63 offen offset:1024 sc1
v_fma_f32 v66, v66, v108, v124
s_cbranch_vccnz SIG_54
buffer_store_dword v126, v2, s[4:7], s36 offen offset:3200
SRET_54:
v_fma_f32 v67, v67, v108, v125
v_mul_f32 v57, v57, v121
v_mul_f32 v58, v58, v122
v_mul_f32 v56, v56, v120
v_mul_f32 v59, v59, v123
v_mul_f32 v60, v60, v37
v_fmaak_f32 v121, v64, v64, 0x409d30fc
v_fmaak_f32 v122, v65, v65, 0x409d30fc
v_fmaak_f32 v124, v61, v61, 0x409d30fc
v_fmaak_f32 v125, v62, v62, 0x409d30fc
v_fmaak_f32 v120, v63, v63, 0x409d30fc
v_fmaak_f32 v123, v66, v66, 0x409d30fc
v_fmaak_f32 v37, v67, v67, 0x409d30fc
v_mul_f32 v121, v64, v121
v_mul_f32 v122, v65, v122
v_mul_f32 v124, v61, v124
v_mul_f32 v125, v62, v125
v_mul_f32 v120, v63, v120
v_mul_f32 v123, v66, v123
v_mul_f32 v37, v67, v37
v_exp_f32_e64 v121, -v121
v_exp_f32_e64 v122, -v122
v_exp_f32_e64 v124, -v124
v_exp_f32_e64 v125, -v125
v_exp_f32_e64 v120, -v120
v_exp_f32_e64 v123, -v123
v_exp_f32_e64 v37, -v37
v_fma_f32 v121, v121, s44, s44
v_fma_f32 v122, v122, s44, s44
v_fma_f32 v124, v124, s44, s44
v_fma_f32 v125, v125, s44, s44
v_fma_f32 v120, v120, s44, s44
v_fma_f32 v123, v123, s44, s44
v_fma_f32 v37, v37, s44, s44
v_rcp_f32 v121, v121
v_rcp_f32 v122, v122
v_rcp_f32 v124, v124
v_rcp_f32 v125, v125
v_rcp_f32 v120, v120
v_rcp_f32 v123, v123
v_rcp_f32 v37, v37
v_mul_f32 v64, v64, v121
v_mul_f32 v65, v65, v122
v_mul_f32 v61, v61, v124
v_mul_f32 v62, v62, v125
v_mul_f32 v63, v63, v120
v_mul_f32 v66, v66, v123
v_mul_f32 v67, v67, v37
v_cvt_pk_bf16_f32 v64, v64, v65
v_cvt_pk_bf16_f32 v68, v56, v57
v_cvt_pk_bf16_f32 v69, v58, v59
v_cvt_pk_bf16_f32 v70, v60, v61
v_cvt_pk_bf16_f32 v71, v62, v63
v_cvt_pk_bf16_f32 v65, v66, v67
s_waitcnt vmcnt(10)
v_mfma_f32_16x16x32_bf16 v[40:43], a[0:3], v[72:75], 0
buffer_load_dwordx4 v[120:123], v0, s[4:7], s63 offen offset:2048 sc1
s_waitcnt vmcnt(10)
s_add_u32 s69, s32, 0xb00000
v_mfma_f32_16x16x32_bf16 v[44:47], a[4:7], v[72:75], 0
s_add_u32 s65, s33, 0xb00000
buffer_store_dwordx4 v[68:71], v0, s[4:7], s69 offen
buffer_store_dwordx2 v[64:65], v1, s[4:7], s65 offen
v_mfma_f32_16x16x32_bf16 v[48:51], a[8:11], v[72:75], 0
v_cmp_eq_u32_e64 s[58:59], v126, v39
v_lshlrev_b32 v104, 16, v10
v_mfma_f32_16x16x32_bf16 v[52:55], a[12:15], v[72:75], 0
v_mfma_f32_16x16x32_bf16 v[40:43], a[16:19], v[76:79], v[40:43]
v_mfma_f32_16x16x32_bf16 v[44:47], a[20:23], v[76:79], v[44:47]
s_waitcnt vmcnt(11)
s_cmp_eq_u64 s[58:59], s[56:57]
s_cbranch_scc0 CHK_57
CRET_57:
v_mfma_f32_16x16x32_bf16 v[48:51], a[24:27], v[76:79], v[48:51]
s_add_u32 s68, s34, 0xb16000
buffer_load_dwordx4 v[72:75], v0, s[4:7], s68 offen offset:0 sc1
v_mfma_f32_16x16x32_bf16 v[52:55], a[28:31], v[76:79], v[52:55]
buffer_load_dwordx4 v[76:79], v0, s[4:7], s68 offen offset:1024 sc1
v_mfma_f32_16x16x32_bf16 v[40:43], a[32:35], v[80:83], v[40:43]
v_mfma_f32_16x16x32_bf16 v[44:47], a[36:39], v[80:83], v[44:47]
s_waitcnt vmcnt(12)
v_mfma_f32_16x16x32_bf16 v[48:51], a[40:43], v[80:83], v[48:51]
v_mfma_f32_16x16x32_bf16 v[52:55], a[44:47], v[80:83], v[52:55]
buffer_load_dwordx4 v[80:83], v0, s[4:7], s68 offen offset:2048 sc1
v_mfma_f32_16x16x32_bf16 v[40:43], a[48:51], v[84:87], v[40:43]
v_mfma_f32_16x16x32_bf16 v[44:47], a[52:55], v[84:87], v[44:47]
s_waitcnt vmcnt(12)
v_mfma_f32_16x16x32_bf16 v[48:51], a[56:59], v[84:87], v[48:51]
buffer_load_dword v127, v3, s[4:7], s36 offen offset:3200 sc1
v_mfma_f32_16x16x32_bf16 v[52:55], a[60:63], v[84:87], v[52:55]
buffer_load_dwordx4 v[84:87], v0, s[4:7], s68 offen offset:3072 sc1
v_mfma_f32_16x16x32_bf16 v[40:43], a[64:67], v[88:91], v[40:43]
v_mfma_f32_16x16x32_bf16 v[44:47], a[68:71], v[88:91], v[44:47]
s_waitcnt vmcnt(12)
v_mfma_f32_16x16x32_bf16 v[48:51], a[72:75], v[88:91], v[48:51]
v_mfma_f32_16x16x32_bf16 v[52:55], a[76:79], v[88:91], v[52:55]
s_add_u32 s62, s34, 0xb17000
buffer_load_dwordx4 v[88:91], v0, s[4:7], s62 offen offset:0 sc1
v_mfma_f32_16x16x32_bf16 v[40:43], a[80:83], v[92:95], v[40:43]
v_mfma_f32_16x16x32_bf16 v[44:47], a[84:87], v[92:95], v[44:47]
s_waitcnt vmcnt(11)
v_mfma_f32_16x16x32_bf16 v[48:51], a[88:91], v[92:95], v[48:51]
v_mfma_f32_16x16x32_bf16 v[52:55], a[92:95], v[92:95], v[52:55]
buffer_load_dwordx4 v[92:95], v0, s[4:7], s62 offen offset:1024 sc1
v_mfma_f32_16x16x32_bf16 v[40:43], a[96:99], v[96:99], v[40:43]
v_mfma_f32_16x16x32_bf16 v[44:47], a[100:103], v[96:99], v[44:47]
v_mfma_f32_16x16x32_bf16 v[48:51], a[104:107], v[96:99], v[48:51]
v_mfma_f32_16x16x32_bf16 v[52:55], a[108:111], v[96:99], v[52:55]
buffer_load_dwordx4 v[96:99], v0, s[4:7], s62 offen offset:2048 sc1
v_mfma_f32_16x16x32_bf16 v[40:43], a[112:115], v[100:103], v[40:43]
v_mfma_f32_16x16x32_bf16 v[44:47], a[116:119], v[100:103], v[44:47]
v_mfma_f32_16x16x32_bf16 v[48:51], a[120:123], v[100:103], v[48:51]
v_mfma_f32_16x16x32_bf16 v[52:55], a[124:127], v[100:103], v[52:55]
buffer_load_dwordx4 v[100:103], v0, s[4:7], s62 offen offset:3072 sc1
v_mfma_f32_16x16x32_bf16 v[40:43], a[128:131], v[112:115], v[40:43]
v_mfma_f32_16x16x32_bf16 v[44:47], a[132:135], v[112:115], v[44:47]
s_waitcnt vmcnt(13)
v_mfma_f32_16x16x32_bf16 v[48:51], a[136:139], v[112:115], v[48:51]
v_mfma_f32_16x16x32_bf16 v[52:55], a[140:143], v[112:115], v[52:55]
s_add_u32 s78, s34, 0xb18000
buffer_load_dwordx4 v[112:115], v0, s[4:7], s78 offen offset:0 sc1
s_waitcnt vmcnt(10)
s_cbranch_vccnz SIG_55
buffer_store_dword v126, v2, s[4:7], s36 offen offset:3072
SRET_55:
v_mfma_f32_16x16x32_bf16 v[40:43], a[144:147], v[116:119], v[40:43]
v_mfma_f32_16x16x32_bf16 v[44:47], a[148:151], v[116:119], v[44:47]
v_mfma_f32_16x16x32_bf16 v[48:51], a[152:155], v[116:119], v[48:51]
v_mfma_f32_16x16x32_bf16 v[52:55], a[156:159], v[116:119], v[52:55]
buffer_load_dwordx4 v[116:119], v0, s[4:7], s78 offen offset:1024 sc1
v_mfma_f32_16x16x32_bf16 v[40:43], a[160:163], v[120:123], v[40:43]
v_mfma_f32_16x16x32_bf16 v[44:47], a[164:167], v[120:123], v[44:47]
v_mfma_f32_16x16x32_bf16 v[48:51], a[168:171], v[120:123], v[48:51]
v_mfma_f32_16x16x32_bf16 v[52:55], a[172:175], v[120:123], v[52:55]
buffer_load_dwordx4 v[120:123], v0, s[4:7], s78 offen offset:2048 sc1
s_nop 3
ds_write_b128 v18, v[40:43] offset:0
s_waitcnt vmcnt(12)
ds_write_b128 v19, v[44:47] offset:0
ds_write_b128 v18, v[48:51] offset:128
ds_write_b128 v19, v[52:55] offset:128
v_mfma_f32_16x16x32_bf16 v[56:59], a[0:3], v[72:75], 0
v_mfma_f32_16x16x32_bf16 v[60:63], a[4:7], v[72:75], 0
s_waitcnt vmcnt(11)
v_mfma_f32_16x16x32_bf16 v[64:67], a[8:11], v[72:75], 0
s_waitcnt vmcnt(9)
v_cmp_eq_u32_e64 s[76:77], v126, v127
v_mfma_f32_16x16x32_bf16 v[68:71], a[12:15], v[72:75], 0
v_mfma_f32_16x16x32_bf16 v[56:59], a[16:19], v[76:79], v[56:59]
v_mfma_f32_16x16x32_bf16 v[60:63], a[20:23], v[76:79], v[60:63]
s_cmp_eq_u64 s[76:77], s[56:57]
s_cbranch_scc0 CHK_58
CRET_58:
v_mfma_f32_16x16x32_bf16 v[64:67], a[24:27], v[76:79], v[64:67]
s_add_u32 s67, s34, 0xb0b000
buffer_load_dwordx4 v[72:75], v0, s[4:7], s67 offen offset:0 sc1
s_waitcnt lgkmcnt(0)
s_barrier
v_mfma_f32_16x16x32_bf16 v[68:71], a[28:31], v[76:79], v[68:71]
buffer_load_dwordx4 v[76:79], v0, s[4:7], s67 offen offset:1024 sc1
v_mfma_f32_16x16x32_bf16 v[56:59], a[32:35], v[80:83], v[56:59]
ds_read_b128 v[40:43], v20 offset:0
s_waitcnt vmcnt(10)
ds_read_b128 v[44:47], v20 offset:4096
ds_read_b128 v[48:51], v20 offset:8192
ds_read_b128 v[52:55], v20 offset:12288
v_mfma_f32_16x16x32_bf16 v[60:63], a[36:39], v[80:83], v[60:63]
v_mfma_f32_16x16x32_bf16 v[64:67], a[40:43], v[80:83], v[64:67]
v_mfma_f32_16x16x32_bf16 v[68:71], a[44:47], v[80:83], v[68:71]
buffer_load_dwordx4 v[80:83], v0, s[4:7], s67 offen offset:2048 sc1
v_mfma_f32_16x16x32_bf16 v[56:59], a[48:51], v[84:87], v[56:59]
v_mfma_f32_16x16x32_bf16 v[60:63], a[52:55], v[84:87], v[60:63]
s_waitcnt vmcnt(10)
v_mfma_f32_16x16x32_bf16 v[64:67], a[56:59], v[84:87], v[64:67]
v_mfma_f32_16x16x32_bf16 v[68:71], a[60:63], v[84:87], v[68:71]
buffer_load_dwordx4 v[84:87], v0, s[4:7], s67 offen offset:3072 sc1
s_waitcnt lgkmcnt(2)
v_add_f32 v40, v40, v44
v_add_f32 v41, v41, v45
v_add_f32 v42, v42, v46
v_add_f32 v43, v43, v47
v_add_f32 v104, v104, v40
v_add_f32 v105, v105, v41
v_add_f32 v106, v106, v42
v_add_f32 v107, v107, v43
s_waitcnt lgkmcnt(0)
v_add_f32 v48, v48, v52
v_add_f32 v49, v49, v53
v_add_f32 v50, v50, v54
v_add_f32 v51, v51, v55
v_add_f32 v104, v104, v48
v_add_f32 v105, v105, v49
v_add_f32 v106, v106, v50
v_add_f32 v107, v107, v51
v_mfma_f32_16x16x32_bf16 v[56:59], a[64:67], v[88:91], v[56:59]
buffer_load_dword v23, v3, s[4:7], s36 offen offset:3072 sc1
s_waitcnt vmcnt(11)
v_cvt_pk_bf16_f32 v10, v104, v105
v_lshlrev_b32 v104, 16, v8
v_and_b32 v105, s49, v8
v_mfma_f32_16x16x32_bf16 v[60:63], a[68:71], v[88:91], v[60:63]
v_cvt_pk_bf16_f32 v11, v106, v107
v_lshlrev_b32 v106, 16, v9
v_and_b32 v107, s49, v9
v_mfma_f32_16x16x32_bf16 v[64:67], a[72:75], v[88:91], v[64:67]
s_add_u32 s79, s43, 0x18000
buffer_store_dwordx2 v[10:11], v38, s[12:15], s79 offen
v_mfma_f32_16x16x32_bf16 v[68:71], a[76:79], v[88:91], v[68:71]
s_add_u32 s66, s34, 0xb0c000
buffer_load_dwordx4 v[88:91], v0, s[4:7], s66 offen offset:0 sc1
v_mfma_f32_16x16x32_bf16 v[56:59], a[80:83], v[92:95], v[56:59]
v_mfma_f32_16x16x32_bf16 v[60:63], a[84:87], v[92:95], v[60:63]
s_waitcnt vmcnt(12)
v_mfma_f32_16x16x32_bf16 v[64:67], a[88:91], v[92:95], v[64:67]
v_mfma_f32_16x16x32_bf16 v[68:71], a[92:95], v[92:95], v[68:71]
buffer_load_dwordx4 v[92:95], v0, s[4:7], s66 offen offset:1024 sc1
v_mfma_f32_16x16x32_bf16 v[56:59], a[96:99], v[96:99], v[56:59]
v_mfma_f32_16x16x32_bf16 v[60:63], a[100:103], v[96:99], v[60:63]
s_waitcnt vmcnt(12)
v_mfma_f32_16x16x32_bf16 v[64:67], a[104:107], v[96:99], v[64:67]
v_mfma_f32_16x16x32_bf16 v[68:71], a[108:111], v[96:99], v[68:71]
buffer_load_dwordx4 v[96:99], v0, s[4:7], s66 offen offset:2048 sc1
v_mfma_f32_16x16x32_bf16 v[56:59], a[112:115], v[100:103], v[56:59]
v_mfma_f32_16x16x32_bf16 v[60:63], a[116:119], v[100:103], v[60:63]
s_waitcnt vmcnt(12)
v_mfma_f32_16x16x32_bf16 v[64:67], a[120:123], v[100:103], v[64:67]
v_mfma_f32_16x16x32_bf16 v[68:71], a[124:127], v[100:103], v[68:71]
buffer_load_dwordx4 v[100:103], v0, s[4:7], s66 offen offset:3072 sc1
v_mfma_f32_16x16x32_bf16 v[56:59], a[128:131], v[112:115], v[56:59]
v_mfma_f32_16x16x32_bf16 v[60:63], a[132:135], v[112:115], v[60:63]
s_waitcnt vmcnt(11)
v_mfma_f32_16x16x32_bf16 v[64:67], a[136:139], v[112:115], v[64:67]
v_mfma_f32_16x16x32_bf16 v[68:71], a[140:143], v[112:115], v[68:71]
s_add_u32 s64, s34, 0xb0d000
buffer_load_dwordx4 v[112:115], v0, s[4:7], s64 offen offset:0 sc1
v_mfma_f32_16x16x32_bf16 v[56:59], a[144:147], v[116:119], v[56:59]
v_mfma_f32_16x16x32_bf16 v[60:63], a[148:151], v[116:119], v[60:63]
s_waitcnt vmcnt(11)
v_mfma_f32_16x16x32_bf16 v[64:67], a[152:155], v[116:119], v[64:67]
s_waitcnt vmcnt(10)
v_mfma_f32_16x16x32_bf16 v[68:71], a[156:159], v[116:119], v[68:71]
buffer_load_dwordx4 v[116:119], v0, s[4:7], s64 offen offset:1024 sc1
v_mfma_f32_16x16x32_bf16 v[56:59], a[160:163], v[120:123], v[56:59]
v_mfma_f32_16x16x32_bf16 v[60:63], a[164:167], v[120:123], v[60:63]
v_mfma_f32_16x16x32_bf16 v[64:67], a[168:171], v[120:123], v[64:67]
v_mfma_f32_16x16x32_bf16 v[68:71], a[172:175], v[120:123], v[68:71]
buffer_load_dwordx4 v[120:123], v0, s[4:7], s64 offen offset:2048 sc1
v_mfma_f32_16x16x32_bf16 v[40:43], a[0:3], v[72:75], 0
s_nop 2
ds_write_b128 v18, v[56:59] offset:16384
s_waitcnt vmcnt(11)
ds_write_b128 v19, v[60:63] offset:16384
ds_write_b128 v18, v[64:67] offset:16512
ds_write_b128 v19, v[68:71] offset:16512
v_mfma_f32_16x16x32_bf16 v[44:47], a[4:7], v[72:75], 0
v_mfma_f32_16x16x32_bf16 v[48:51], a[8:11], v[72:75], 0
v_mfma_f32_16x16x32_bf16 v[52:55], a[12:15], v[72:75], 0
s_waitcnt vmcnt(8)
v_cmp_eq_u32_e64 s[58:59], v126, v23
v_mfma_f32_16x16x32_bf16 v[40:43], a[16:19], v[76:79], v[40:43]
v_mfma_f32_16x16x32_bf16 v[44:47], a[20:23], v[76:79], v[44:47]
v_mfma_f32_16x16x32_bf16 v[48:51], a[24:27], v[76:79], v[48:51]
s_cmp_eq_u64 s[58:59], s[56:57]
s_cbranch_scc0 CHK_59
CRET_59:
v_mfma_f32_16x16x32_bf16 v[52:55], a[28:31], v[76:79], v[52:55]
s_waitcnt lgkmcnt(0)
s_barrier
v_mfma_f32_16x16x32_bf16 v[40:43], a[32:35], v[80:83], v[40:43]
s_add_u32 s63, s34, 0xb00000
buffer_load_dwordx4 v[72:75], v0, s[4:7], s63 offen offset:0 sc1
ds_read_b128 v[56:59], v20 offset:16384
ds_read_b128 v[60:63], v20 offset:20480
ds_read_b128 v[64:67], v20 offset:24576
ds_read_b128 v[68:71], v20 offset:28672
buffer_load_dwordx4 v[76:79], v0, s[4:7], s63 offen offset:1024 sc1
v_mfma_f32_16x16x32_bf16 v[44:47], a[36:39], v[80:83], v[44:47]
v_mfma_f32_16x16x32_bf16 v[48:51], a[40:43], v[80:83], v[48:51]
v_mfma_f32_16x16x32_bf16 v[52:55], a[44:47], v[80:83], v[52:55]
buffer_load_dwordx4 v[80:83], v0, s[4:7], s63 offen offset:2048 sc1
v_mfma_f32_16x16x32_bf16 v[40:43], a[48:51], v[84:87], v[40:43]
v_mfma_f32_16x16x32_bf16 v[44:47], a[52:55], v[84:87], v[44:47]
s_waitcnt vmcnt(9)
v_mfma_f32_16x16x32_bf16 v[48:51], a[56:59], v[84:87], v[48:51]
v_mfma_f32_16x16x32_bf16 v[52:55], a[60:63], v[84:87], v[52:55]
s_waitcnt lgkmcnt(2)
v_add_f32 v56, v56, v60
v_add_f32 v57, v57, v61
v_add_f32 v58, v58, v62
v_add_f32 v59, v59, v63
v_add_f32 v104, v104, v56
v_add_f32 v105, v105, v57
v_add_f32 v106, v106, v58
s_waitcnt lgkmcnt(0)
v_add_f32 v64, v64, v68
v_add_f32 v65, v65, v69
v_add_f32 v66, v66, v70
v_add_f32 v67, v67, v71
v_add_f32 v107, v107, v59
v_add_f32 v104, v104, v64
v_add_f32 v105, v105, v65
v_add_f32 v106, v106, v66
v_add_f32 v107, v107, v67
v_mfma_f32_16x16x32_bf16 v[40:43], a[64:67], v[88:91], v[40:43]
buffer_load_dwordx4 v[84:87], v0, s[4:7], s63 offen offset:3072 sc1
s_waitcnt vmcnt(9)
v_mfma_f32_16x16x32_bf16 v[44:47], a[68:71], v[88:91], v[44:47]
v_cvt_pk_bf16_f32 v8, v104, v105
v_cvt_pk_bf16_f32 v9, v106, v107
v_mfma_f32_16x16x32_bf16 v[48:51], a[72:75], v[88:91], v[48:51]
s_add_u32 s69, s43, 0x10000
buffer_store_dwordx2 v[8:9], v38, s[12:15], s69 offen
v_mfma_f32_16x16x32_bf16 v[52:55], a[76:79], v[88:91], v[52:55]
s_add_u32 s65, s34, 0xb01000
buffer_load_dwordx4 v[88:91], v0, s[4:7], s65 offen offset:0 sc1
v_mfma_f32_16x16x32_bf16 v[40:43], a[80:83], v[92:95], v[40:43]
v_lshlrev_b32 v104, 16, v6
v_and_b32 v105, s49, v6
v_mfma_f32_16x16x32_bf16 v[44:47], a[84:87], v[92:95], v[44:47]
s_waitcnt vmcnt(10)
v_lshlrev_b32 v106, 16, v7
v_and_b32 v107, s49, v7
v_mfma_f32_16x16x32_bf16 v[48:51], a[88:91], v[92:95], v[48:51]
v_mfma_f32_16x16x32_bf16 v[52:55], a[92:95], v[92:95], v[52:55]
buffer_load_dwordx4 v[92:95], v0, s[4:7], s65 offen offset:1024 sc1
v_mfma_f32_16x16x32_bf16 v[40:43], a[96:99], v[96:99], v[40:43]
v_mfma_f32_16x16x32_bf16 v[44:47], a[100:103], v[96:99], v[44:47]
s_waitcnt vmcnt(10)
v_mfma_f32_16x16x32_bf16 v[48:51], a[104:107], v[96:99], v[48:51]
v_mfma_f32_16x16x32_bf16 v[52:55], a[108:111], v[96:99], v[52:55]
buffer_load_dwordx4 v[96:99], v0, s[4:7], s65 offen offset:2048 sc1
v_mfma_f32_16x16x32_bf16 v[40:43], a[112:115], v[100:103], v[40:43]
v_mfma_f32_16x16x32_bf16 v[44:47], a[116:119], v[100:103], v[44:47]
s_waitcnt vmcnt(10)
v_mfma_f32_16x16x32_bf16 v[48:51], a[120:123], v[100:103], v[48:51]
v_mfma_f32_16x16x32_bf16 v[52:55], a[124:127], v[100:103], v[52:55]
buffer_load_dwordx4 v[100:103], v0, s[4:7], s65 offen offset:3072 sc1
v_mfma_f32_16x16x32_bf16 v[40:43], a[128:131], v[112:115], v[40:43]
v_mfma_f32_16x16x32_bf16 v[44:47], a[132:135], v[112:115], v[44:47]
s_waitcnt vmcnt(10)
v_mfma_f32_16x16x32_bf16 v[48:51], a[136:139], v[112:115], v[48:51]
v_mfma_f32_16x16x32_bf16 v[52:55], a[140:143], v[112:115], v[52:55]
s_add_u32 s68, s34, 0xb02000
buffer_load_dwordx4 v[112:115], v0, s[4:7], s68 offen offset:0 sc1
v_mfma_f32_16x16x32_bf16 v[40:43], a[144:147], v[116:119], v[40:43]
v_mfma_f32_16x16x32_bf16 v[44:47], a[148:151], v[116:119], v[44:47]
s_waitcnt vmcnt(10)
v_mfma_f32_16x16x32_bf16 v[48:51], a[152:155], v[116:119], v[48:51]
v_mfma_f32_16x16x32_bf16 v[52:55], a[156:159], v[116:119], v[52:55]
buffer_load_dwordx4 v[116:119], v0, s[4:7], s68 offen offset:1024 sc1
v_mfma_f32_16x16x32_bf16 v[40:43], a[160:163], v[120:123], v[40:43]
s_waitcnt vmcnt(10)
v_mfma_f32_16x16x32_bf16 v[44:47], a[164:167], v[120:123], v[44:47]
v_mfma_f32_16x16x32_bf16 v[48:51], a[168:171], v[120:123], v[48:51]
v_mfma_f32_16x16x32_bf16 v[52:55], a[172:175], v[120:123], v[52:55]
buffer_load_dwordx4 v[120:123], v0, s[4:7], s68 offen offset:2048 sc1
v_mfma_f32_16x16x32_bf16 v[56:59], a[0:3], v[72:75], 0
s_nop 1
ds_write_b128 v18, v[40:43] offset:0
s_waitcnt vmcnt(10)
v_mfma_f32_16x16x32_bf16 v[60:63], a[4:7], v[72:75], 0
ds_write_b128 v19, v[44:47] offset:0
v_mfma_f32_16x16x32_bf16 v[64:67], a[8:11], v[72:75], 0
ds_write_b128 v18, v[48:51] offset:128
v_mfma_f32_16x16x32_bf16 v[68:71], a[12:15], v[72:75], 0
ds_write_b128 v19, v[52:55] offset:128
v_mfma_f32_16x16x32_bf16 v[56:59], a[16:19], v[76:79], v[56:59]
v_mfma_f32_16x16x32_bf16 v[60:63], a[20:23], v[76:79], v[60:63]
s_waitcnt vmcnt(9)
v_mfma_f32_16x16x32_bf16 v[64:67], a[24:27], v[76:79], v[64:67]
v_mfma_f32_16x16x32_bf16 v[68:71], a[28:31], v[76:79], v[68:71]
v_mfma_f32_16x16x32_bf16 v[56:59], a[32:35], v[80:83], v[56:59]
v_mfma_f32_16x16x32_bf16 v[60:63], a[36:39], v[80:83], v[60:63]
s_waitcnt vmcnt(8)
v_mfma_f32_16x16x32_bf16 v[64:67], a[40:43], v[80:83], v[64:67]
s_waitcnt lgkmcnt(0)
s_barrier
v_mfma_f32_16x16x32_bf16 v[68:71], a[44:47], v[80:83], v[68:71]
v_mfma_f32_16x16x32_bf16 v[56:59], a[48:51], v[84:87], v[56:59]
ds_read_b128 v[40:43], v20 offset:0
s_waitcnt vmcnt(6)
ds_read_b128 v[44:47], v20 offset:4096
v_mfma_f32_16x16x32_bf16 v[60:63], a[52:55], v[84:87], v[60:63]
ds_read_b128 v[48:51], v20 offset:8192
ds_read_b128 v[52:55], v20 offset:12288
v_mfma_f32_16x16x32_bf16 v[64:67], a[56:59], v[84:87], v[64:67]
v_mfma_f32_16x16x32_bf16 v[68:71], a[60:63], v[84:87], v[68:71]
v_mfma_f32_16x16x32_bf16 v[56:59], a[64:67], v[88:91], v[56:59]
v_mfma_f32_16x16x32_bf16 v[60:63], a[68:71], v[88:91], v[60:63]
s_waitcnt vmcnt(5)
v_mfma_f32_16x16x32_bf16 v[64:67], a[72:75], v[88:91], v[64:67]
v_mfma_f32_16x16x32_bf16 v[68:71], a[76:79], v[88:91], v[68:71]
v_mfma_f32_16x16x32_bf16 v[56:59], a[80:83], v[92:95], v[56:59]
s_waitcnt lgkmcnt(2)
v_add_f32 v40, v40, v44
v_mfma_f32_16x16x32_bf16 v[60:63], a[84:87], v[92:95], v[60:63]
s_waitcnt vmcnt(4)
v_add_f32 v41, v41, v45
v_add_f32 v42, v42, v46
v_mfma_f32_16x16x32_bf16 v[64:67], a[88:91], v[92:95], v[64:67]
s_waitcnt lgkmcnt(0)
v_add_f32 v43, v43, v47
v_add_f32 v48, v48, v52
v_mfma_f32_16x16x32_bf16 v[68:71], a[92:95], v[92:95], v[68:71]
v_add_f32 v104, v104, v40
v_add_f32 v49, v49, v53
v_mfma_f32_16x16x32_bf16 v[56:59], a[96:99], v[96:99], v[56:59]
v_add_f32 v105, v105, v41
v_add_f32 v50, v50, v54
v_mfma_f32_16x16x32_bf16 v[60:63], a[100:103], v[96:99], v[60:63]
s_waitcnt vmcnt(3)
v_add_f32 v106, v106, v42
v_add_f32 v51, v51, v55
v_mfma_f32_16x16x32_bf16 v[64:67], a[104:107], v[96:99], v[64:67]
v_add_f32 v107, v107, v43
v_add_f32 v104, v104, v48
v_mfma_f32_16x16x32_bf16 v[68:71], a[108:111], v[96:99], v[68:71]
v_add_f32 v105, v105, v49
v_add_f32 v106, v106, v50
v_mfma_f32_16x16x32_bf16 v[56:59], a[112:115], v[100:103], v[56:59]
v_add_f32 v107, v107, v51
v_cvt_pk_bf16_f32 v6, v104, v105
v_mfma_f32_16x16x32_bf16 v[60:63], a[116:119], v[100:103], v[60:63]
s_waitcnt vmcnt(2)
v_cvt_pk_bf16_f32 v7, v106, v107
s_add_u32 s62, s43, 0x8000
v_mfma_f32_16x16x32_bf16 v[64:67], a[120:123], v[100:103], v[64:67]
buffer_store_dwordx2 v[6:7], v38, s[12:15], s62 offen
v_mfma_f32_16x16x32_bf16 v[68:71], a[124:127], v[100:103], v[68:71]
v_lshlrev_b32 v104, 16, v4
v_and_b32 v105, s49, v4
v_mfma_f32_16x16x32_bf16 v[56:59], a[128:131], v[112:115], v[56:59]
v_lshlrev_b32 v106, 16, v5
v_and_b32 v107, s49, v5
v_mfma_f32_16x16x32_bf16 v[60:63], a[132:135], v[112:115], v[60:63]
s_waitcnt vmcnt(2)
v_mfma_f32_16x16x32_bf16 v[64:67], a[136:139], v[112:115], v[64:67]
v_mfma_f32_16x16x32_bf16 v[68:71], a[140:143], v[112:115], v[68:71]
v_mfma_f32_16x16x32_bf16 v[56:59], a[144:147], v[116:119], v[56:59]
v_mfma_f32_16x16x32_bf16 v[60:63], a[148:151], v[116:119], v[60:63]
s_waitcnt vmcnt(1)
v_mfma_f32_16x16x32_bf16 v[64:67], a[152:155], v[116:119], v[64:67]
v_mfma_f32_16x16x32_bf16 v[68:71], a[156:159], v[116:119], v[68:71]
v_mfma_f32_16x16x32_bf16 v[56:59], a[160:163], v[120:123], v[56:59]
v_mfma_f32_16x16x32_bf16 v[60:63], a[164:167], v[120:123], v[60:63]
v_mfma_f32_16x16x32_bf16 v[64:67], a[168:171], v[120:123], v[64:67]
v_mfma_f32_16x16x32_bf16 v[68:71], a[172:175], v[120:123], v[68:71]
s_nop 4
ds_write_b128 v18, v[56:59] offset:16384
ds_write_b128 v19, v[60:63] offset:16384
ds_write_b128 v18, v[64:67] offset:16512
ds_write_b128 v19, v[68:71] offset:16512
s_waitcnt lgkmcnt(0)
s_barrier
ds_read_b128 v[56:59], v20 offset:16384
ds_read_b128 v[60:63], v20 offset:20480
ds_read_b128 v[64:67], v20 offset:24576
ds_read_b128 v[68:71], v20 offset:28672
s_waitcnt lgkmcnt(2)
v_add_f32 v56, v56, v60
v_add_f32 v57, v57, v61
v_add_f32 v58, v58, v62
v_add_f32 v59, v59, v63
v_add_f32 v104, v104, v56
v_add_f32 v105, v105, v57
v_add_f32 v106, v106, v58
v_add_f32 v107, v107, v59
s_waitcnt lgkmcnt(0)
v_add_f32 v64, v64, v68
v_add_f32 v65, v65, v69
v_add_f32 v66, v66, v70
v_add_f32 v67, v67, v71
v_add_f32 v104, v104, v64
v_add_f32 v105, v105, v65
v_add_f32 v106, v106, v66
v_add_f32 v107, v107, v67
v_cvt_pk_bf16_f32 v4, v104, v105
v_cvt_pk_bf16_f32 v5, v106, v107
s_add_u32 s78, s43, 0x0
buffer_store_dwordx2 v[4:5], v38, s[12:15], s78 offen
K1_end:
s_endpgm
NC:
s_mov_b32 s60, 0
NCL:
buffer_load_dword v126, v101, s[16:19], 0 offen sc1
s_waitcnt vmcnt(0)
v_cmp_ne_u32_e64 vcc, 0, v126
s_cmp_eq_u64 vcc, -1
s_cbranch_scc1 NCR
s_add_u32 s60, s60, 1
s_cmp_lt_u32 s60, 0x80000
s_cbranch_scc1 NCL
s_branch K1_end
HS:
s_mov_b32 s60, 0
v_and_b32 v102, 0x70, v0
HSL:
buffer_load_dword v99, v3, s[4:7], s61 offen offset:128 sc1
buffer_load_dword v101, v102, s[4:7], s61 offen offset:256 sc1
s_waitcnt vmcnt(0)
v_cmp_eq_u32_e64 vcc, v103, v99
s_cmp_eq_u64 vcc, -1
s_cbranch_scc1 HSF
v_cmp_eq_u32_e64 vcc, v103, v101
s_cmp_eq_u64 vcc, -1
s_cbranch_scc1 HSF
v_and_b32 v101, -8, v101
v_cmp_eq_u32_e64 vcc, v126, v101
s_cmp_eq_u64 vcc, -1
s_cbranch_scc1 HSS
s_add_u32 s60, s60, 1
s_cmp_lt_u32 s60, 0x80000
s_cbranch_scc1 HSL
s_branch K1_end
HSS:
s_mov_b64 vcc, 1
s_mov_b32 s56, 0
s_mov_b32 s57, 1
s_branch HSR
CHK_0:
s_mov_b32 s60, 0
CHKL_0:
buffer_load_dword v39, v146, s[4:7], s82 offen sc1
s_waitcnt vmcnt(0)
v_cmp_eq_u32_e64 s[58:59], v126, v39
s_cmp_eq_u64 s[58:59], -1
s_cbranch_scc1 CHKO_0
s_add_u32 s60, s60, 1
s_cmp_lt_u32 s60, 0x80000
s_cbranch_scc1 CHKL_0
s_branch K1_end
CHKO_0:
s_branch CRET_0
SIG_1:
buffer_wbl2 sc1
s_waitcnt vmcnt(0)
buffer_store_dword v126, v2, s[4:7], s36 offen offset:384 sc1
s_branch SRET_1
SIG_2:
buffer_wbl2 sc1
s_waitcnt vmcnt(0)
buffer_store_dword v126, v2, s[4:7], s36 offen offset:256 sc1
s_branch SRET_2
SIG_3:
buffer_wbl2 sc1
s_waitcnt vmcnt(0)
buffer_store_dword v126, v2, s[4:7], s36 offen offset:128 sc1
s_branch SRET_3
SIG_4:
buffer_wbl2 sc1
s_waitcnt vmcnt(0)
buffer_store_dword v126, v2, s[4:7], s36 offen offset:0 sc1
s_branch SRET_4
CHK_5:
s_mov_b32 s60, 0
CHKL_5:
buffer_load_dword v23, v3, s[4:7], s36 offen offset:384 sc1
s_waitcnt vmcnt(0)
v_cmp_eq_u32_e64 s[76:77], v126, v23
s_cmp_eq_u64 s[76:77], -1
s_cbranch_scc1 CHKO_5
s_add_u32 s60, s60, 1
s_cmp_lt_u32 s60, 0x80000
s_cbranch_scc1 CHKL_5
s_branch K1_end
CHKO_5:
s_cbranch_vccz CRET_5
buffer_inv sc1
s_waitcnt vmcnt(0)
s_branch CRET_5
SIG_6:
buffer_wbl2 sc1
s_waitcnt vmcnt(0)
buffer_store_dword v126, v2, s[4:7], s36 offen offset:896 sc1
s_branch SRET_6
CHK_7:
s_mov_b32 s60, 0
CHKL_7:
buffer_load_dword v127, v3, s[4:7], s36 offen offset:256 sc1
s_waitcnt vmcnt(0)
v_cmp_eq_u32_e64 s[58:59], v126, v127
s_cmp_eq_u64 s[58:59], -1
s_cbranch_scc1 CHKO_7
s_add_u32 s60, s60, 1
s_cmp_lt_u32 s60, 0x80000
s_cbranch_scc1 CHKL_7
s_branch K1_end
CHKO_7:
s_cbranch_vccz CRET_7
buffer_inv sc1
s_waitcnt vmcnt(0)
s_branch CRET_7
SIG_8:
buffer_wbl2 sc1
s_waitcnt vmcnt(0)
buffer_store_dword v126, v2, s[4:7], s36 offen offset:768 sc1
s_branch SRET_8
CHK_9:
s_mov_b32 s60, 0
CHKL_9:
buffer_load_dword v39, v3, s[4:7], s36 offen offset:128 sc1
s_waitcnt vmcnt(0)
v_cmp_eq_u32_e64 s[76:77], v126, v39
s_cmp_eq_u64 s[76:77], -1
s_cbranch_scc1 CHKO_9
s_add_u32 s60, s60, 1
s_cmp_lt_u32 s60, 0x80000
s_cbranch_scc1 CHKL_9
s_branch K1_end
CHKO_9:
s_cbranch_vccz CRET_9
buffer_inv sc1
s_waitcnt vmcnt(0)
s_branch CRET_9
SIG_10:
buffer_wbl2 sc1
s_waitcnt vmcnt(0)
buffer_store_dword v126, v2, s[4:7], s36 offen offset:640 sc1
s_branch SRET_10
CHK_11:
s_mov_b32 s60, 0
CHKL_11:
buffer_load_dword v127, v3, s[4:7], s36 offen offset:896 sc1
s_waitcnt vmcnt(0)
v_cmp_eq_u32_e64 s[76:77], v126, v127
s_cmp_eq_u64 s[76:77], -1
s_cbranch_scc1 CHKO_11
s_add_u32 s60, s60, 1
s_cmp_lt_u32 s60, 0x80000
s_cbranch_scc1 CHKL_11
s_branch K1_end
CHKO_11:
s_cbranch_vccz CRET_11
buffer_inv sc1
s_waitcnt vmcnt(0)
s_branch CRET_11
CHK_12:
s_mov_b32 s60, 0
CHKL_12:
buffer_load_dword v39, v3, s[4:7], s36 offen offset:768 sc1
s_waitcnt vmcnt(0)
v_cmp_eq_u32_e64 s[58:59], v126, v39
s_cmp_eq_u64 s[58:59], -1
s_cbranch_scc1 CHKO_12
s_add_u32 s60, s60, 1
s_cmp_lt_u32 s60, 0x80000
s_cbranch_scc1 CHKL_12
s_branch K1_end
CHKO_12:
s_cbranch_vccz CRET_12
buffer_inv sc1
s_waitcnt vmcnt(0)
s_branch CRET_12
CHK_13:
s_mov_b32 s60, 0
CHKL_13:
buffer_load_dword v23, v3, s[4:7], s36 offen offset:0 sc1
s_waitcnt vmcnt(0)
v_cmp_eq_u32_e64 s[58:59], v126, v23
s_cmp_eq_u64 s[58:59], -1
s_cbranch_scc1 CHKO_13
s_add_u32 s60, s60, 1
s_cmp_lt_u32 s60, 0x80000
s_cbranch_scc1 CHKL_13
s_branch K1_end
CHKO_13:
s_cbranch_vccz CRET_13
buffer_inv sc1
s_waitcnt vmcnt(0)
s_branch CRET_13
SIG_14:
buffer_wbl2 sc1
s_waitcnt vmcnt(0)
buffer_store_dword v126, v2, s[4:7], s36 offen offset:512 sc1
s_branch SRET_14
SIG_15:
buffer_wbl2 sc1
s_waitcnt vmcnt(0)
buffer_store_dword v126, v2, s[4:7], s36 offen offset:1408 sc1
s_branch SRET_15
CHK_16:
s_mov_b32 s60, 0
CHKL_16:
buffer_load_dword v127, v3, s[4:7], s36 offen offset:640 sc1
s_waitcnt vmcnt(0)
v_cmp_eq_u32_e64 s[76:77], v126, v127
s_cmp_eq_u64 s[76:77], -1
s_cbranch_scc1 CHKO_16
s_add_u32 s60, s60, 1
s_cmp_lt_u32 s60, 0x80000
s_cbranch_scc1 CHKL_16
s_branch K1_end
CHKO_16:
s_cbranch_vccz CRET_16
buffer_inv sc1
s_waitcnt vmcnt(0)
s_branch CRET_16
SIG_17:
buffer_wbl2 sc1
s_waitcnt vmcnt(0)
buffer_store_dword v126, v2, s[4:7], s36 offen offset:1280 sc1
s_branch SRET_17
CHK_18:
s_mov_b32 s60, 0
CHKL_18:
buffer_load_dword v39, v3, s[4:7], s36 offen offset:512 sc1
s_waitcnt vmcnt(0)
v_cmp_eq_u32_e64 s[58:59], v126, v39
s_cmp_eq_u64 s[58:59], -1
s_cbranch_scc1 CHKO_18
s_add_u32 s60, s60, 1
s_cmp_lt_u32 s60, 0x80000
s_cbranch_scc1 CHKL_18
s_branch K1_end
CHKO_18:
s_cbranch_vccz CRET_18
buffer_inv sc1
s_waitcnt vmcnt(0)
s_branch CRET_18
SIG_19:
buffer_wbl2 sc1
s_waitcnt vmcnt(0)
buffer_store_dword v126, v2, s[4:7], s36 offen offset:1152 sc1
s_branch SRET_19
SIG_20:
buffer_wbl2 sc1
s_waitcnt vmcnt(0)
buffer_store_dword v126, v2, s[4:7], s36 offen offset:1024 sc1
s_branch SRET_20
CHK_21:
s_mov_b32 s60, 0
CHKL_21:
buffer_load_dword v127, v37, s[4:7], s52 offen sc1
s_waitcnt vmcnt(0)
v_cmp_eq_u32_e64 s[76:77], v126, v127
s_cmp_eq_u64 s[76:77], -1
s_cbranch_scc1 CHKO_21
s_add_u32 s60, s60, 1
s_cmp_lt_u32 s60, 0x80000
s_cbranch_scc1 CHKL_21
s_branch K1_end
CHKO_21:
s_branch CRET_21
CHK_22:
s_mov_b32 s60, 0
CHKL_22:
buffer_load_dword v127, v3, s[4:7], s36 offen offset:1408 sc1
s_waitcnt vmcnt(0)
v_cmp_eq_u32_e64 s[76:77], v126, v127
s_cmp_eq_u64 s[76:77], -1
s_cbranch_scc1 CHKO_22
s_add_u32 s60, s60, 1
s_cmp_lt_u32 s60, 0x80000
s_cbranch_scc1 CHKL_22
s_branch K1_end
CHKO_22:
s_cbranch_vccz CRET_22
buffer_inv sc1
s_waitcnt vmcnt(0)
s_branch CRET_22
SIG_23:
buffer_wbl2 sc1
s_waitcnt vmcnt(0)
buffer_store_dword v126, v2, s[4:7], s36 offen offset:1920 sc1
s_branch SRET_23
CHK_24:
s_mov_b32 s60, 0
CHKL_24:
buffer_load_dword v39, v3, s[4:7], s36 offen offset:1280 sc1
s_waitcnt vmcnt(0)
v_cmp_eq_u32_e64 s[58:59], v126, v39
s_cmp_eq_u64 s[58:59], -1
s_cbranch_scc1 CHKO_24
s_add_u32 s60, s60, 1
s_cmp_lt_u32 s60, 0x80000
s_cbranch_scc1 CHKL_24
s_branch K1_end
CHKO_24:
s_cbranch_vccz CRET_24
buffer_inv sc1
s_waitcnt vmcnt(0)
s_branch CRET_24
SIG_25:
buffer_wbl2 sc1
s_waitcnt vmcnt(0)
buffer_store_dword v126, v2, s[4:7], s36 offen offset:1792 sc1
s_branch SRET_25
CHK_26:
s_mov_b32 s60, 0
CHKL_26:
buffer_load_dword v23, v3, s[4:7], s36 offen offset:1152 sc1
s_waitcnt vmcnt(0)
v_cmp_eq_u32_e64 s[58:59], v126, v23
s_cmp_eq_u64 s[58:59], -1
s_cbranch_scc1 CHKO_26
s_add_u32 s60, s60, 1
s_cmp_lt_u32 s60, 0x80000
s_cbranch_scc1 CHKL_26
s_branch K1_end
CHKO_26:
s_cbranch_vccz CRET_26
buffer_inv sc1
s_waitcnt vmcnt(0)
s_branch CRET_26
SIG_27:
buffer_wbl2 sc1
s_waitcnt vmcnt(0)
buffer_store_dword v126, v2, s[4:7], s36 offen offset:1664 sc1
s_branch SRET_27
CHK_28:
s_mov_b32 s60, 0
CHKL_28:
buffer_load_dword v39, v3, s[4:7], s36 offen offset:1024 sc1
s_waitcnt vmcnt(0)
v_cmp_eq_u32_e64 s[76:77], v126, v39
s_cmp_eq_u64 s[76:77], -1
s_cbranch_scc1 CHKO_28
s_add_u32 s60, s60, 1
s_cmp_lt_u32 s60, 0x80000
s_cbranch_scc1 CHKL_28
s_branch K1_end
CHKO_28:
s_cbranch_vccz CRET_28
buffer_inv sc1
s_waitcnt vmcnt(0)
s_branch CRET_28
SIG_30:
buffer_wbl2 sc1
s_waitcnt vmcnt(0)
buffer_store_dword v126, v2, s[4:7], s36 offen offset:1536 sc1
s_branch SRET_30
CHK_31:
s_mov_b32 s60, 0
CHKL_31:
buffer_load_dword v127, v3, s[4:7], s36 offen offset:1920 sc1
s_waitcnt vmcnt(0)
v_cmp_eq_u32_e64 s[58:59], v126, v127
s_cmp_eq_u64 s[58:59], -1
s_cbranch_scc1 CHKO_31
s_add_u32 s60, s60, 1
s_cmp_lt_u32 s60, 0x80000
s_cbranch_scc1 CHKL_31
s_branch K1_end
CHKO_31:
s_cbranch_vccz CRET_31
buffer_inv sc1
s_waitcnt vmcnt(0)
s_branch CRET_31
CHK_32:
s_mov_b32 s60, 0
CHKL_32:
buffer_load_dword v23, v3, s[4:7], s36 offen offset:1792 sc1
s_waitcnt vmcnt(0)
v_cmp_eq_u32_e64 s[76:77], v126, v23
s_cmp_eq_u64 s[76:77], -1
s_cbranch_scc1 CHKO_32
s_add_u32 s60, s60, 1
s_cmp_lt_u32 s60, 0x80000
s_cbranch_scc1 CHKL_32
s_branch K1_end
CHKO_32:
s_cbranch_vccz CRET_32
buffer_inv sc1
s_waitcnt vmcnt(0)
s_branch CRET_32
CHK_33:
s_mov_b32 s60, 0
CHKL_33:
buffer_load_dword v39, v3, s[4:7], s36 offen offset:1664 sc1
s_waitcnt vmcnt(0)
v_cmp_eq_u32_e64 s[58:59], v126, v39
s_cmp_eq_u64 s[58:59], -1
s_cbranch_scc1 CHKO_33
s_add_u32 s60, s60, 1
s_cmp_lt_u32 s60, 0x80000
s_cbranch_scc1 CHKL_33
s_branch K1_end
CHKO_33:
s_cbranch_vccz CRET_33
buffer_inv sc1
s_waitcnt vmcnt(0)
s_branch CRET_33
SIG_34:
buffer_wbl2 sc1
s_waitcnt vmcnt(0)
buffer_store_dword v126, v2, s[4:7], s36 offen offset:2432 sc1
s_branch SRET_34
CHK_35:
s_mov_b32 s60, 0
CHKL_35:
buffer_load_dword v23, v3, s[4:7], s36 offen offset:1536 sc1
s_waitcnt vmcnt(0)
v_cmp_eq_u32_e64 s[58:59], v126, v23
s_cmp_eq_u64 s[58:59], -1
s_cbranch_scc1 CHKO_35
s_add_u32 s60, s60, 1
s_cmp_lt_u32 s60, 0x80000
s_cbranch_scc1 CHKL_35
s_branch K1_end
CHKO_35:
s_cbranch_vccz CRET_35
buffer_inv sc1
s_waitcnt vmcnt(0)
s_branch CRET_35
CHK_36:
s_mov_b32 s60, 0
CHKL_36:
buffer_load_dword v127, v37, s[4:7], s37 offen sc1
s_waitcnt vmcnt(0)
v_cmp_eq_u32_e64 s[76:77], v126, v127
s_cmp_eq_u64 s[76:77], -1
s_cbranch_scc1 CHKO_36
s_add_u32 s60, s60, 1
s_cmp_lt_u32 s60, 0x80000
s_cbranch_scc1 CHKL_36
s_branch K1_end
CHKO_36:
s_branch CRET_36
SIG_37:
buffer_wbl2 sc1
s_waitcnt vmcnt(0)
buffer_store_dword v126, v2, s[4:7], s36 offen offset:2304 sc1
s_branch SRET_37
SIG_38:
buffer_wbl2 sc1
s_waitcnt vmcnt(0)
buffer_store_dword v126, v2, s[4:7], s36 offen offset:2176 sc1
s_branch SRET_38
SIG_39:
buffer_wbl2 sc1
s_waitcnt vmcnt(0)
buffer_store_dword v126, v2, s[4:7], s36 offen offset:2048 sc1
s_branch SRET_39
CHK_40:
s_mov_b32 s60, 0
CHKL_40:
buffer_load_dword v39, v3, s[4:7], s36 offen offset:2432 sc1
s_waitcnt vmcnt(0)
v_cmp_eq_u32_e64 s[76:77], v126, v39
s_cmp_eq_u64 s[76:77], -1
s_cbranch_scc1 CHKO_40
s_add_u32 s60, s60, 1
s_cmp_lt_u32 s60, 0x80000
s_cbranch_scc1 CHKL_40
s_branch K1_end
CHKO_40:
s_cbranch_vccz CRET_40
buffer_inv sc1
s_waitcnt vmcnt(0)
s_branch CRET_40
SIG_41:
buffer_wbl2 sc1
s_waitcnt vmcnt(0)
buffer_store_dword v126, v2, s[4:7], s36 offen offset:2944 sc1
s_branch SRET_41
CHK_42:
s_mov_b32 s60, 0
CHKL_42:
buffer_load_dword v127, v3, s[4:7], s36 offen offset:2304 sc1
s_waitcnt vmcnt(0)
v_cmp_eq_u32_e64 s[58:59], v126, v127
s_cmp_eq_u64 s[58:59], -1
s_cbranch_scc1 CHKO_42
s_add_u32 s60, s60, 1
s_cmp_lt_u32 s60, 0x80000
s_cbranch_scc1 CHKL_42
s_branch K1_end
CHKO_42:
s_cbranch_vccz CRET_42
buffer_inv sc1
s_waitcnt vmcnt(0)
s_branch CRET_42
SIG_43:
buffer_wbl2 sc1
s_waitcnt vmcnt(0)
buffer_store_dword v126, v2, s[4:7], s36 offen offset:2816 sc1
s_branch SRET_43
CHK_44:
s_mov_b32 s60, 0
CHKL_44:
buffer_load_dword v23, v3, s[4:7], s36 offen offset:2176 sc1
s_waitcnt vmcnt(0)
v_cmp_eq_u32_e64 s[76:77], v126, v23
s_cmp_eq_u64 s[76:77], -1
s_cbranch_scc1 CHKO_44
s_add_u32 s60, s60, 1
s_cmp_lt_u32 s60, 0x80000
s_cbranch_scc1 CHKL_44
s_branch K1_end
CHKO_44:
s_cbranch_vccz CRET_44
buffer_inv sc1
s_waitcnt vmcnt(0)
s_branch CRET_44
SIG_45:
buffer_wbl2 sc1
s_waitcnt vmcnt(0)
buffer_store_dword v126, v2, s[4:7], s36 offen offset:2688 sc1
s_branch SRET_45
CHK_46:
s_mov_b32 s60, 0
CHKL_46:
buffer_load_dword v127, v3, s[4:7], s36 offen offset:2944 sc1
s_waitcnt vmcnt(0)
v_cmp_eq_u32_e64 s[76:77], v126, v127
s_cmp_eq_u64 s[76:77], -1
s_cbranch_scc1 CHKO_46
s_add_u32 s60, s60, 1
s_cmp_lt_u32 s60, 0x80000
s_cbranch_scc1 CHKL_46
s_branch K1_end
CHKO_46:
s_cbranch_vccz CRET_46
buffer_inv sc1
s_waitcnt vmcnt(0)
s_branch CRET_46
CHK_47:
s_mov_b32 s60, 0
CHKL_47:
buffer_load_dword v23, v3, s[4:7], s36 offen offset:2816 sc1
s_waitcnt vmcnt(0)
v_cmp_eq_u32_e64 s[58:59], v126, v23
s_cmp_eq_u64 s[58:59], -1
s_cbranch_scc1 CHKO_47
s_add_u32 s60, s60, 1
s_cmp_lt_u32 s60, 0x80000
s_cbranch_scc1 CHKL_47
s_branch K1_end
CHKO_47:
s_cbranch_vccz CRET_47
buffer_inv sc1
s_waitcnt vmcnt(0)
s_branch CRET_47
CHK_48:
s_mov_b32 s60, 0
CHKL_48:
buffer_load_dword v39, v3, s[4:7], s36 offen offset:2048 sc1
s_waitcnt vmcnt(0)
v_cmp_eq_u32_e64 s[58:59], v126, v39
s_cmp_eq_u64 s[58:59], -1
s_cbranch_scc1 CHKO_48
s_add_u32 s60, s60, 1
s_cmp_lt_u32 s60, 0x80000
s_cbranch_scc1 CHKL_48
s_branch K1_end
CHKO_48:
s_cbranch_vccz CRET_48
buffer_inv sc1
s_waitcnt vmcnt(0)
s_branch CRET_48
SIG_49:
buffer_wbl2 sc1
s_waitcnt vmcnt(0)
buffer_store_dword v126, v2, s[4:7], s36 offen offset:2560 sc1
s_branch SRET_49
SIG_50:
buffer_wbl2 sc1
s_waitcnt vmcnt(0)
buffer_store_dword v126, v2, s[4:7], s36 offen offset:3456 sc1
s_branch SRET_50
CHK_51:
s_mov_b32 s60, 0
CHKL_51:
buffer_load_dword v39, v3, s[4:7], s36 offen offset:2688 sc1
s_waitcnt vmcnt(0)
v_cmp_eq_u32_e64 s[76:77], v126, v39
s_cmp_eq_u64 s[76:77], -1
s_cbranch_scc1 CHKO_51
s_add_u32 s60, s60, 1
s_cmp_lt_u32 s60, 0x80000
s_cbranch_scc1 CHKL_51
s_branch K1_end
CHKO_51:
s_cbranch_vccz CRET_51
buffer_inv sc1
s_waitcnt vmcnt(0)
s_branch CRET_51
SIG_52:
buffer_wbl2 sc1
s_waitcnt vmcnt(0)
buffer_store_dword v126, v2, s[4:7], s36 offen offset:3328 sc1
s_branch SRET_52
CHK_53:
s_mov_b32 s60, 0
CHKL_53:
buffer_load_dword v127, v3, s[4:7], s36 offen offset:2560 sc1
s_waitcnt vmcnt(0)
v_cmp_eq_u32_e64 s[58:59], v126, v127
s_cmp_eq_u64 s[58:59], -1
s_cbranch_scc1 CHKO_53
s_add_u32 s60, s60, 1
s_cmp_lt_u32 s60, 0x80000
s_cbranch_scc1 CHKL_53
s_branch K1_end
CHKO_53:
s_cbranch_vccz CRET_53
buffer_inv sc1
s_waitcnt vmcnt(0)
s_branch CRET_53
SIG_54:
buffer_wbl2 sc1
s_waitcnt vmcnt(0)
buffer_store_dword v126, v2, s[4:7], s36 offen offset:3200 sc1
s_branch SRET_54
SIG_55:
buffer_wbl2 sc1
s_waitcnt vmcnt(0)
buffer_store_dword v126, v2, s[4:7], s36 offen offset:3072 sc1
s_branch SRET_55
CHK_56:
s_mov_b32 s60, 0
CHKL_56:
buffer_load_dword v23, v3, s[4:7], s36 offen offset:3456 sc1
s_waitcnt vmcnt(0)
v_cmp_eq_u32_e64 s[76:77], v126, v23
s_cmp_eq_u64 s[76:77], -1
s_cbranch_scc1 CHKO_56
s_add_u32 s60, s60, 1
s_cmp_lt_u32 s60, 0x80000
s_cbranch_scc1 CHKL_56
s_branch K1_end
CHKO_56:
s_cbranch_vccz CRET_56
buffer_inv sc1
s_waitcnt vmcnt(0)
s_branch CRET_56
CHK_57:
s_mov_b32 s60, 0
CHKL_57:
buffer_load_dword v39, v3, s[4:7], s36 offen offset:3328 sc1
s_waitcnt vmcnt(0)
v_cmp_eq_u32_e64 s[58:59], v126, v39
s_cmp_eq_u64 s[58:59], -1
s_cbranch_scc1 CHKO_57
s_add_u32 s60, s60, 1
s_cmp_lt_u32 s60, 0x80000
s_cbranch_scc1 CHKL_57
s_branch K1_end
CHKO_57:
s_cbranch_vccz CRET_57
buffer_inv sc1
s_waitcnt vmcnt(0)
s_branch CRET_57
CHK_58:
s_mov_b32 s60, 0
CHKL_58:
buffer_load_dword v127, v3, s[4:7], s36 offen offset:3200 sc1
s_waitcnt vmcnt(0)
v_cmp_eq_u32_e64 s[76:77], v126, v127
s_cmp_eq_u64 s[76:77], -1
s_cbranch_scc1 CHKO_58
s_add_u32 s60, s60, 1
s_cmp_lt_u32 s60, 0x80000
s_cbranch_scc1 CHKL_58
s_branch K1_end
CHKO_58:
s_cbranch_vccz CRET_58
buffer_inv sc1
s_waitcnt vmcnt(0)
s_branch CRET_58
CHK_59:
s_mov_b32 s60, 0
CHKL_59:
buffer_load_dword v23, v3, s[4:7], s36 offen offset:3072 sc1
s_waitcnt vmcnt(0)
v_cmp_eq_u32_e64 s[58:59], v126, v23
s_cmp_eq_u64 s[58:59], -1
s_cbranch_scc1 CHKO_59
s_add_u32 s60, s60, 1
s_cmp_lt_u32 s60, 0x80000
s_cbranch_scc1 CHKL_59
s_branch K1_end
CHKO_59:
s_cbranch_vccz CRET_59
buffer_inv sc1
s_waitcnt vmcnt(0)
s_branch CRET_59
K1_last:
s_endpgm
.section .rodata,"a"
.p2align 6
.amdhsa_kernel interleave_layers__sliding_local_dilated__dense_activation_gelu__prompt_kernel
  .amdhsa_next_free_vgpr 512
  .amdhsa_next_free_sgpr 102
  .amdhsa_accum_offset 256
  .amdhsa_group_segment_fixed_size 0
  .amdhsa_kernarg_size 88
  .amdhsa_user_sgpr_count 2
  .amdhsa_user_sgpr_kernarg_segment_ptr 1
  .amdhsa_system_sgpr_workgroup_id_x 1
.end_amdhsa_kernel
```
